```python
import torch

def _softmax(x, axis=-1):
    return torch.softmax(x, dim=axis)
def _gelu(x):
    return torch.nn.functional.gelu(x, approximate="tanh")
def _silu(x):
    return torch.nn.functional.silu(x)
def _sigmoid(x):
    return torch.sigmoid(x)
def _layernorm(x, axis=-1, eps=1e-5):
    m = x.mean(dim=axis, keepdim=True)
    v = x.var(dim=axis, keepdim=True, unbiased=False)
    return (x - m) / torch.sqrt(v + eps)
def _scatter_add(tgt, idx, src, axis=0):
    return tgt.clone().index_add_(axis, idx, src)
def _segment_sum(src, seg, n):
    out = torch.zeros((n,) + src.shape[1:], dtype=src.dtype)
    return out.index_add_(0, seg, src)
def _pad(x, pw):
    flat = tuple(v for pair in reversed(pw) for v in pair)
    return torch.nn.functional.pad(x, flat)

kernel_name = 'gated_mix__grouped_kv_mqa__glu_gated_swiglu__prompt'

def setup_inputs():

    _w = (lambda a: (lambda t: t.to(torch.bfloat16) if t.is_floating_point() else t)(torch.as_tensor(a)))
    def _A_setup():
        B, S, D, H = 1, 2048, 640, 32
        Dh = D // H
        return {
            "x": _w((lambda *s: torch.randn(*s, dtype=torch.bfloat16) * 0.05)(B, S, D)),
            "wq": _w((lambda *s: torch.randn(*s, dtype=torch.bfloat16) * 0.8)(D, H * Dh)),
            "wk": _w((lambda *s: torch.randn(*s, dtype=torch.bfloat16) * 0.8)(D, Dh)),
            "wv": _w((lambda *s: torch.randn(*s, dtype=torch.bfloat16) * 0.05)(D, Dh)),
            "wo": _w((lambda *s: torch.randn(*s, dtype=torch.bfloat16) * 0.05)(H * Dh, D)),
        }
    _A_in = _A_setup()

    def _B_setup():
        B, S, D, F = 1, 2048, 640, 1536
        return {
            "x": _w((lambda *s: torch.randn(*s, dtype=torch.bfloat16) * 0.05)(B, S, D)),
            "w1": _w((lambda *s: torch.randn(*s, dtype=torch.bfloat16) * 0.8)(D, F) * (2.0 / D) ** 0.5),
            "w3": _w((lambda *s: torch.randn(*s, dtype=torch.bfloat16) * 0.8)(D, F) * (2.0 / D) ** 0.5),
            "w2": _w((lambda *s: torch.randn(*s, dtype=torch.bfloat16) * 0.8)(F, D) * (2.0 / F) ** 0.5),
        }
    _B_in = _B_setup()

    return {
        "A_x": _A_in["x"],
        "A_wq": _A_in["wq"],
        "A_wk": _A_in["wk"],
        "A_wv": _A_in["wv"],
        "A_wo": _A_in["wo"],
        "B_x": _B_in["x"],
        "B_w1": _B_in["w1"],
        "B_w3": _B_in["w3"],
        "B_w2": _B_in["w2"],
        "gate_w": _w((lambda *s: torch.randn(*s, dtype=torch.bfloat16) * 0.05)(640) * 16.0),
    }

def reference(A_x, A_wq, A_wk, A_wv, A_wo, B_x, B_w1, B_w3, B_w2, gate_w):
    def _A_ref(x, wq, wk, wv, wo):
        B, S, D = x.shape
        H = 32
        Dh = D // H
        q = (lambda x, *d: x.permute(*d))((x @ wq).reshape(B, S, H, Dh), 0, 2, 1, 3)
        k = x @ wk
        v = x @ wv
        scores = torch.einsum("bhqd,bkd->bhqk", q, k) * (Dh ** -0.5)
        p = _softmax(scores, axis=-1)
        o = torch.einsum("bhqk,bkd->bhqd", p, v)
        return (lambda x, *d: x.permute(*d))(o, 0, 2, 1, 3).reshape(B, S, H * Dh) @ wo

    def _B_ref(x, w1, w3, w2):
        gate = torch.einsum("bsd,df->bsf", x, w1)
        up = torch.einsum("bsd,df->bsf", x, w3)
        h = _silu(gate) * up
        out = torch.einsum("bsf,fd->bsd", h, w2)
        return out

    x = A_x
    g = _sigmoid((x * gate_w).sum(-1, keepdims=True))
    a = _A_ref(x, A_wq, A_wk, A_wv, A_wo)
    b = _B_ref(x, B_w1, B_w3, B_w2)
    return g * a + (1 - g) * b
```

```asm
; @launch grid=(512,1,1) block=(512,1,1) lds=81920
.amdgcn_target "amdgcn-amd-amdhsa--gfx950"
.text
.globl gated_mix__grouped_kv_mqa__glu_gated_swiglu__prompt_kernel
.p2align 8
.type gated_mix__grouped_kv_mqa__glu_gated_swiglu__prompt_kernel,@function
gated_mix__grouped_kv_mqa__glu_gated_swiglu__prompt_kernel:
  s_cmp_ge_u32 s2, 512
  s_cbranch_scc1 done
  s_load_dwordx2 s[82:83], s[0:1], 0
  s_load_dwordx2 s[84:85], s[0:1], 8
  s_load_dwordx2 s[86:87], s[0:1], 16
  s_load_dwordx2 s[88:89], s[0:1], 24
  s_load_dwordx2 s[90:91], s[0:1], 32
  s_load_dwordx2 s[92:93], s[0:1], 48
  s_load_dwordx2 s[94:95], s[0:1], 56
  s_load_dwordx2 s[96:97], s[0:1], 64
  s_load_dwordx2 s[98:99], s[0:1], 72
  s_load_dwordx2 s[100:101], s[0:1], 80
  s_load_dwordx2 s[52:53], s[0:1], 88
  s_load_dwordx2 s[54:55], s[0:1], 96
  s_cmp_ge_u32 s2, 256
  s_cbranch_scc1 grole
  s_setprio 3
  v_and_b32 v1, 63, v0
  v_lshrrev_b32 v15, 6, v0
  s_nop 0
  v_readfirstlane_b32 s20, v15
  s_bfe_u32 s26, s2, 0x10002
  s_lshl_b32 s26, s26, 4
  s_lshr_b32 s27, s2, 5
  s_lshl_b32 s27, s27, 1
  s_add_u32 s21, s26, s27
  s_bfe_u32 s26, s2, 0x10003
  s_add_u32 s21, s21, s26
  s_and_b32 s26, s2, 3
  s_lshl_b32 s26, s26, 1
  s_bfe_u32 s27, s2, 0x10004
  s_add_u32 s22, s26, s27
  s_and_b32 s23, s20, 1
  s_lshr_b32 s24, s20, 1
  s_waitcnt lgkmcnt(0)
  s_mov_b32 s4, s82
  s_mov_b32 s5, s83
  s_mov_b32 s6, 0x280000
  s_mov_b32 s7, 0x00020000
  s_mov_b32 s8, s84
  s_mov_b32 s9, s85
  s_mov_b32 s10, 0xc8000
  s_mov_b32 s11, 0x00020000
  s_mov_b32 s12, s54
  s_mov_b32 s13, s55
  s_mov_b32 s14, 0x10000000
  s_mov_b32 s15, 0x00020000
  s_mov_b32 s44, s98
  s_mov_b32 s45, s99
  s_mov_b32 s46, 0x500
  s_mov_b32 s47, 0x00020000
  s_and_b32 s26, s22, 1
  s_cmp_eq_u32 s26, 0
  s_cselect_b32 s16, s86, s88
  s_cselect_b32 s17, s87, s89
  s_mov_b32 s18, 25600
  s_mov_b32 s19, 0x00020000
  s_lshr_b32 s26, s22, 1
  s_lshl_b32 s26, s26, 4
  s_lshl_b32 s29, s21, 6
  s_add_u32 s29, s29, s26
  s_and_b32 s26, s20, 3
  s_lshl_b32 s27, s26, 2
  v_lshrrev_b32 v96, 4, v1
  v_add_u32 v96, s27, v96
  v_xor_b32 v97, v96, v1
  v_and_b32 v97, 15, v97
  v_lshlrev_b32 v97, 4, v97
  v_add_u32 v96, s29, v96
  s_movk_i32 s27, 1280
  v_mul_lo_u32 v96, v96, s27
  v_add_u32 v96, v96, v97
  s_lshr_b32 s27, s20, 2
  s_lshl_b32 s28, s27, 12
  s_lshl_b32 s26, s26, 10
  s_add_u32 s28, s28, s26
  s_lshl_b32 s27, s27, 8
  s_add_u32 m0, s28, 18432
  s_add_u32 s33, s27, 0
  buffer_load_dwordx4 v96, s[4:7], s33 offen lds
  s_add_u32 m0, s28, 26624
  s_add_u32 s33, s27, 512
  buffer_load_dwordx4 v96, s[4:7], s33 offen lds
  s_cmp_ge_u32 s20, 4
  s_cbranch_scc1 skipx_1
  s_add_u32 m0, s28, 34816
  s_add_u32 s33, s27, 1024
  buffer_load_dwordx4 v96, s[4:7], s33 offen lds
skipx_1:
  v_lshlrev_b32 v97, 4, v1
  s_lshl_b32 s26, s20, 10
  s_add_u32 m0, s26, 38912
  s_add_u32 s33, s26, 0
  buffer_load_dwordx4 v97, s[16:19], s33 offen lds
  s_add_u32 m0, s26, 47104
  s_add_u32 s33, s26, 8192
  buffer_load_dwordx4 v97, s[16:19], s33 offen lds
  s_add_u32 m0, s26, 55296
  s_add_u32 s33, s26, 16384
  buffer_load_dwordx4 v97, s[16:19], s33 offen lds
  s_cmp_lg_u32 s20, 0
  s_cbranch_scc1 skipw_2
  s_add_u32 m0, s26, 63488
  s_add_u32 s33, s26, 24576
  buffer_load_dwordx4 v97, s[16:19], s33 offen lds
skipw_2:
  s_sub_u32 s26, s20, 1
  s_cmp_ge_u32 s26, 2
  s_cbranch_scc1 skipg_3
  s_lshl_b32 s26, s26, 10
  s_add_u32 m0, s26, 64512
  s_nop 0
  buffer_load_dwordx4 v97, s[44:47], s26 offen lds
skipg_3:
  v_lshrrev_b32 v120, 3, v1
  s_lshl_b32 s26, s20, 3
  v_add_u32 v120, s26, v120
  v_lshrrev_b32 v121, 1, v120
  v_xor_b32 v121, v121, v1
  v_and_b32 v121, 7, v121
  s_lshl_b32 s26, s21, 6
  v_add_u32 v120, s26, v120
  s_movk_i32 s27, 1280
  v_mul_lo_u32 v120, v120, s27
  v_lshlrev_b32 v121, 4, v121
  v_add_u32 v117, v120, v121
  s_add_u32 s26, s20, 0
  s_lshl_b32 s26, s26, 6
  v_add_u32 v120, s26, v1
  s_movk_i32 s28, 6554
  v_mul_lo_u32 v121, v120, s28
  v_lshrrev_b32 v121, 16, v121
  v_mul_u32_u24 v122, 10, v121
  v_sub_u32 v122, v120, v122
  v_mul_lo_u32 v121, v121, s27
  v_lshlrev_b32 v122, 4, v122
  v_add_u32 v121, v121, v122
  s_mul_i32 s26, s22, 160
  v_add_u32 v118, s26, v121
  s_add_u32 s26, s20, 8
  s_lshl_b32 s26, s26, 6
  v_add_u32 v120, s26, v1
  s_movk_i32 s28, 6554
  v_mul_lo_u32 v121, v120, s28
  v_lshrrev_b32 v121, 16, v121
  v_mul_u32_u24 v122, 10, v121
  v_sub_u32 v122, v120, v122
  v_mul_lo_u32 v121, v121, s27
  v_lshlrev_b32 v122, 4, v122
  v_add_u32 v121, v121, v122
  s_mul_i32 s26, s22, 160
  v_add_u32 v119, s26, v121
  v_and_b32 v120, 31, v1
  v_lshrrev_b32 v121, 5, v1
  v_lshrrev_b32 v122, 1, v120
  v_and_b32 v122, 7, v122
  v_xor_b32 v122, v122, v121
  s_lshl_b32 s26, s23, 5
  v_add_u32 v120, s26, v120
  v_lshlrev_b32 v120, 7, v120
  v_xor_b32 v121, 0, v122
  v_lshlrev_b32 v121, 4, v121
  v_add_u32 v112, v120, v121
  v_xor_b32 v121, 2, v122
  v_lshlrev_b32 v121, 4, v121
  v_add_u32 v113, v120, v121
  v_xor_b32 v121, 4, v122
  v_lshlrev_b32 v121, 4, v121
  v_add_u32 v114, v120, v121
  v_xor_b32 v121, 6, v122
  v_lshlrev_b32 v121, 4, v121
  v_add_u32 v115, v120, v121
  v_lshrrev_b32 v120, 5, v1
  v_lshlrev_b32 v120, 3, v120
  v_bfe_u32 v121, v1, 2, 2
  v_add_u32 v120, v120, v121
  v_mul_u32_u24 v120, 160, v120
  v_bfe_u32 v121, v1, 4, 1
  v_lshlrev_b32 v121, 5, v121
  v_add_u32 v120, v120, v121
  v_and_b32 v121, 3, v1
  v_lshlrev_b32 v121, 3, v121
  v_add_u32 v120, v120, v121
  s_mul_i32 s26, s24, 40
  s_add_u32 s26, s26, 8192
  v_add_u32 v116, s26, v120
  s_lshl_b32 s35, s20, 10
  s_cmp_lt_u32 s20, 2
  s_cbranch_scc1 qp3_4
  s_add_u32 m0, s35, 0
  s_movk_i32 s33, 0
  buffer_load_dwordx4 v117, s[4:7], s33 offen lds
  s_add_u32 m0, s35, 8192
  s_mov_b32 s33, 0
  buffer_load_dwordx4 v118, s[8:11], s33 offen lds
  s_or_b32 s26, s2, s20
  s_cmp_lg_u32 s26, 0
  s_cbranch_scc1 np_6
  s_memrealtime s[58:59]
  s_waitcnt lgkmcnt(0)
  s_or_b32 s58, s58, 1
  v_mov_b32 v124, 0
  v_mov_b32 v125, s58
  s_mov_b64 exec, 1
  global_store_dword v124, v125, s[52:53] sc1
  s_mov_b64 exec, -1
np_6:
  v_and_b32 v16, 31, v1
  s_lshl_b32 s26, s23, 5
  v_add_u32 v16, s26, v16
  v_mul_u32_u24 v16, 176, v16
  v_lshrrev_b32 v18, 5, v1
  v_lshlrev_b32 v18, 3, v18
  s_mul_i32 s26, s24, 40
  s_add_u32 s26, s26, 49152
  v_add3_u32 v2, v16, v18, s26
  s_add_u32 s26, s20, 0
  s_lshl_b32 s26, s26, 2
  v_lshrrev_b32 v16, 4, v1
  v_add_u32 v16, s26, v16
  v_mul_u32_u24 v17, 26, v16
  v_lshrrev_b32 v17, 8, v17
  v_mul_u32_u24 v18, 10, v17
  v_sub_u32 v18, v16, v18
  v_and_b32 v19, 15, v1
  v_lshlrev_b32 v16, 4, v17
  v_add_u32 v16, v16, v19
  v_mul_u32_u24 v16, 176, v16
  v_lshlrev_b32 v3, 4, v18
  v_add_u32 v3, v3, v16
  v_add_u32 v3, 49152, v3
  v_mul_u32_u24 v17, 20480, v17
  v_lshlrev_b32 v18, 8, v18
  v_lshlrev_b32 v19, 4, v19
  v_add3_u32 v121, v17, v18, v19
  s_add_u32 s26, s20, 8
  s_lshl_b32 s26, s26, 2
  v_lshrrev_b32 v16, 4, v1
  v_add_u32 v16, s26, v16
  v_mul_u32_u24 v17, 26, v16
  v_lshrrev_b32 v17, 8, v17
  v_mul_u32_u24 v18, 10, v17
  v_sub_u32 v18, v16, v18
  v_and_b32 v19, 15, v1
  v_lshlrev_b32 v16, 4, v17
  v_add_u32 v16, v16, v19
  v_mul_u32_u24 v16, 176, v16
  v_lshlrev_b32 v120, 4, v18
  v_add_u32 v120, v120, v16
  v_add_u32 v120, 49152, v120
  v_mul_u32_u24 v17, 20480, v17
  v_lshlrev_b32 v18, 8, v18
  v_lshlrev_b32 v19, 4, v19
  v_add3_u32 v122, v17, v18, v19
  s_mul_i32 s50, s21, 81920
  s_mul_i32 s27, s22, 2560
  s_add_u32 s50, s50, s27
  s_add_u32 s50, s50, 10485760
  v_lshlrev_b32 v11, 4, v1
  v_lshlrev_b32 v12, 3, v1
  v_add_u32 v12, 50176, v12
  v_add_u32 v11, 49152, v11
  v_and_b32 v15, 31, v1
  v_min_u32 v33, 21, v15
  v_lshlrev_b32 v33, 4, v33
  v_lshrrev_b32 v32, 5, v1
  v_mul_u32_u24 v32, 384, v32
  v_add_u32 v33, v33, v32
  v_add_u32 v13, 50688, v33
  s_mul_i32 s26, s20, 3072
  v_lshlrev_b32 v14, 4, v1
  v_add_u32 v14, s26, v14
  s_cmp_lg_u32 s20, 3
  s_cbranch_scc1 pw_7
  v_mul_u32_u24 v124, 21846, v1
  v_lshrrev_b32 v124, 16, v124
  v_mul_u32_u24 v125, 3, v124
  v_sub_u32 v125, v1, v125
  v_mul_u32_u24 v124, 1280, v124
  v_lshlrev_b32 v125, 7, v125
  s_lshr_b32 s48, s2, 3
  s_mul_i32 s48, s48, 25600
  s_and_b32 s49, s2, 3
  s_mul_i32 s49, s49, 320
  s_and_b32 s49, s49, 0xffffff80
  s_add_u32 s48, s48, s49
  v_add3_u32 v124, v124, v125, s48
  v_cmp_gt_u32 vcc, 60, v1
  s_and_saveexec_b64 s[48:49], vcc
  buffer_load_dword v125, v124, s[8:11], 0 offen
  s_mov_b64 exec, -1
  s_waitcnt vmcnt(1)
  s_branch pw_8
pw_7:
  s_waitcnt vmcnt(0)
pw_8:
  s_barrier
  s_cmp_ge_u32 s20, 3
  s_cbranch_scc1 kvdone_9
  s_and_b32 s26, s22, 1
  s_lshl_b32 s27, s26, 2
  s_add_u32 s27, s27, s20
  s_cmp_eq_u32 s27, 6
  s_cbranch_scc1 kvdone_9
  v_and_b32 v96, 15, v1
  v_lshrrev_b32 v97, 4, v1
  v_xor_b32 v98, v96, v97
  v_lshlrev_b32 v99, 8, v96
  v_add_u32 v99, 18432, v99
  v_xor_b32 v100, 0, v98
  v_lshlrev_b32 v100, 4, v100
  v_add_u32 v100, v100, v99
  v_xor_b32 v101, 4, v98
  v_lshlrev_b32 v101, 4, v101
  v_add_u32 v101, v101, v99
  v_xor_b32 v102, 8, v98
  v_lshlrev_b32 v102, 4, v102
  v_add_u32 v102, v102, v99
  v_xor_b32 v103, 12, v98
  v_lshlrev_b32 v103, 4, v103
  v_add_u32 v103, v103, v99
  v_lshlrev_b32 v98, 3, v97
  v_bfe_u32 v99, v1, 2, 2
  v_add_u32 v98, v98, v99
  v_mul_u32_u24 v98, 40, v98
  v_and_b32 v99, 3, v1
  v_lshlrev_b32 v99, 3, v99
  v_add_u32 v98, v98, v99
  s_lshl_b32 s26, s20, 5
  s_add_u32 s26, s26, 38912
  v_add_u32 v104, s26, v98
  v_lshlrev_b32 v98, 4, v97
  v_add_u32 v105, 64512, v98
  s_cmp_eq_u32 s27, 1
  s_cbranch_scc1 kv_k1_11
  s_cmp_eq_u32 s27, 2
  s_cbranch_scc1 kv_g_12
  s_cmp_eq_u32 s27, 4
  s_cbranch_scc1 kv_v0_13
  s_cmp_eq_u32 s27, 5
  s_cbranch_scc1 kv_v1_14
  ds_read_b128 v[32:35], v100 offset:0
  ds_read_b64_tr_b16 v[48:49], v104 offset:0
  ds_read_b64_tr_b16 v[50:51], v104 offset:160
  ds_read_b128 v[36:39], v101 offset:0
  ds_read_b64_tr_b16 v[52:53], v104 offset:1280
  ds_read_b64_tr_b16 v[54:55], v104 offset:1440
  ds_read_b128 v[40:43], v102 offset:0
  ds_read_b64_tr_b16 v[56:57], v104 offset:2560
  ds_read_b64_tr_b16 v[58:59], v104 offset:2720
  ds_read_b128 v[44:47], v103 offset:0
  ds_read_b64_tr_b16 v[60:61], v104 offset:3840
  ds_read_b64_tr_b16 v[62:63], v104 offset:4000
  ds_read_b128 v[64:67], v100 offset:4096
  ds_read_b64_tr_b16 v[80:81], v104 offset:5120
  ds_read_b64_tr_b16 v[82:83], v104 offset:5280
  ds_read_b128 v[68:71], v101 offset:4096
  ds_read_b64_tr_b16 v[84:85], v104 offset:6400
  ds_read_b64_tr_b16 v[86:87], v104 offset:6560
  ds_read_b128 v[72:75], v102 offset:4096
  ds_read_b64_tr_b16 v[88:89], v104 offset:7680
  ds_read_b64_tr_b16 v[90:91], v104 offset:7840
  ds_read_b128 v[76:79], v103 offset:4096
  ds_read_b64_tr_b16 v[92:93], v104 offset:8960
  ds_read_b64_tr_b16 v[94:95], v104 offset:9120
  s_waitcnt lgkmcnt(15)
  v_mfma_f32_16x16x32_bf16 v[108:111], v[48:51], v[32:35], 0
  s_waitcnt lgkmcnt(15)
  v_mfma_f32_16x16x32_bf16 v[108:111], v[52:55], v[36:39], v[108:111]
  s_waitcnt lgkmcnt(15)
  v_mfma_f32_16x16x32_bf16 v[108:111], v[56:59], v[40:43], v[108:111]
  s_waitcnt lgkmcnt(12)
  v_mfma_f32_16x16x32_bf16 v[108:111], v[60:63], v[44:47], v[108:111]
  ds_read_b128 v[32:35], v100 offset:8192
  ds_read_b64_tr_b16 v[48:49], v104 offset:10240
  ds_read_b64_tr_b16 v[50:51], v104 offset:10400
  ds_read_b128 v[36:39], v101 offset:8192
  ds_read_b64_tr_b16 v[52:53], v104 offset:11520
  ds_read_b64_tr_b16 v[54:55], v104 offset:11680
  ds_read_b128 v[40:43], v102 offset:8192
  ds_read_b64_tr_b16 v[56:57], v104 offset:12800
  ds_read_b64_tr_b16 v[58:59], v104 offset:12960
  ds_read_b128 v[44:47], v103 offset:8192
  ds_read_b64_tr_b16 v[60:61], v104 offset:14080
  ds_read_b64_tr_b16 v[62:63], v104 offset:14240
  s_waitcnt lgkmcnt(15)
  v_mfma_f32_16x16x32_bf16 v[108:111], v[80:83], v[64:67], v[108:111]
  s_waitcnt lgkmcnt(15)
  v_mfma_f32_16x16x32_bf16 v[108:111], v[84:87], v[68:71], v[108:111]
  s_waitcnt lgkmcnt(15)
  v_mfma_f32_16x16x32_bf16 v[108:111], v[88:91], v[72:75], v[108:111]
  s_waitcnt lgkmcnt(12)
  v_mfma_f32_16x16x32_bf16 v[108:111], v[92:95], v[76:79], v[108:111]
  ds_read_b128 v[64:67], v100 offset:12288
  ds_read_b64_tr_b16 v[80:81], v104 offset:15360
  ds_read_b64_tr_b16 v[82:83], v104 offset:15520
  ds_read_b128 v[68:71], v101 offset:12288
  ds_read_b64_tr_b16 v[84:85], v104 offset:16640
  ds_read_b64_tr_b16 v[86:87], v104 offset:16800
  ds_read_b128 v[72:75], v102 offset:12288
  ds_read_b64_tr_b16 v[88:89], v104 offset:17920
  ds_read_b64_tr_b16 v[90:91], v104 offset:18080
  ds_read_b128 v[76:79], v103 offset:12288
  ds_read_b64_tr_b16 v[92:93], v104 offset:19200
  ds_read_b64_tr_b16 v[94:95], v104 offset:19360
  s_waitcnt lgkmcnt(15)
  v_mfma_f32_16x16x32_bf16 v[108:111], v[48:51], v[32:35], v[108:111]
  s_waitcnt lgkmcnt(15)
  v_mfma_f32_16x16x32_bf16 v[108:111], v[52:55], v[36:39], v[108:111]
  s_waitcnt lgkmcnt(15)
  v_mfma_f32_16x16x32_bf16 v[108:111], v[56:59], v[40:43], v[108:111]
  s_waitcnt lgkmcnt(12)
  v_mfma_f32_16x16x32_bf16 v[108:111], v[60:63], v[44:47], v[108:111]
  ds_read_b128 v[32:35], v100 offset:16384
  ds_read_b64_tr_b16 v[48:49], v104 offset:20480
  ds_read_b64_tr_b16 v[50:51], v104 offset:20640
  ds_read_b128 v[36:39], v101 offset:16384
  ds_read_b64_tr_b16 v[52:53], v104 offset:21760
  ds_read_b64_tr_b16 v[54:55], v104 offset:21920
  ds_read_b128 v[40:43], v102 offset:16384
  ds_read_b64_tr_b16 v[56:57], v104 offset:23040
  ds_read_b64_tr_b16 v[58:59], v104 offset:23200
  ds_read_b128 v[44:47], v103 offset:16384
  ds_read_b64_tr_b16 v[60:61], v104 offset:24320
  ds_read_b64_tr_b16 v[62:63], v104 offset:24480
  s_waitcnt lgkmcnt(15)
  v_mfma_f32_16x16x32_bf16 v[108:111], v[80:83], v[64:67], v[108:111]
  s_waitcnt lgkmcnt(15)
  v_mfma_f32_16x16x32_bf16 v[108:111], v[84:87], v[68:71], v[108:111]
  s_waitcnt lgkmcnt(15)
  v_mfma_f32_16x16x32_bf16 v[108:111], v[88:91], v[72:75], v[108:111]
  s_waitcnt lgkmcnt(12)
  v_mfma_f32_16x16x32_bf16 v[108:111], v[92:95], v[76:79], v[108:111]
  s_waitcnt lgkmcnt(9)
  v_mfma_f32_16x16x32_bf16 v[108:111], v[48:51], v[32:35], v[108:111]
  s_waitcnt lgkmcnt(6)
  v_mfma_f32_16x16x32_bf16 v[108:111], v[52:55], v[36:39], v[108:111]
  s_waitcnt lgkmcnt(3)
  v_mfma_f32_16x16x32_bf16 v[108:111], v[56:59], v[40:43], v[108:111]
  s_waitcnt lgkmcnt(0)
  v_mfma_f32_16x16x32_bf16 v[108:111], v[60:63], v[44:47], v[108:111]
  s_nop 7
  s_nop 1
  s_lshr_b32 s26, s29, 5
  s_mul_i32 s26, s26, 3072
  s_bfe_u32 s27, s29, 0x10004
  v_cvt_pk_bf16_f32 v108, v108, v109
  v_cvt_pk_bf16_f32 v109, v110, v111
  v_and_b32 v96, 15, v1
  v_bfe_u32 v97, v1, 4, 1
  v_lshrrev_b32 v98, 5, v1
  v_lshlrev_b32 v97, 5, v97
  v_add_u32 v96, v96, v97
  s_lshl_b32 s27, s27, 4
  v_add_u32 v96, s27, v96
  v_lshlrev_b32 v96, 4, v96
  v_lshlrev_b32 v98, 3, v98
  v_add_u32 v96, v96, v98
  buffer_store_dwordx2 v[108:109], v96, s[12:15], s26 offen sc1
  s_branch kvdone_9
kv_k1_11:
  ds_read_b128 v[32:35], v100 offset:0
  ds_read_b64_tr_b16 v[48:49], v104 offset:0
  ds_read_b64_tr_b16 v[50:51], v104 offset:160
  ds_read_b128 v[36:39], v101 offset:0
  ds_read_b64_tr_b16 v[52:53], v104 offset:1280
  ds_read_b64_tr_b16 v[54:55], v104 offset:1440
  ds_read_b128 v[40:43], v102 offset:0
  ds_read_b64_tr_b16 v[56:57], v104 offset:2560
  ds_read_b64_tr_b16 v[58:59], v104 offset:2720
  ds_read_b128 v[44:47], v103 offset:0
  ds_read_b64_tr_b16 v[60:61], v104 offset:3840
  ds_read_b64_tr_b16 v[62:63], v104 offset:4000
  ds_read_b128 v[64:67], v100 offset:4096
  ds_read_b64_tr_b16 v[80:81], v104 offset:5120
  ds_read_b64_tr_b16 v[82:83], v104 offset:5280
  ds_read_b128 v[68:71], v101 offset:4096
  ds_read_b64_tr_b16 v[84:85], v104 offset:6400
  ds_read_b64_tr_b16 v[86:87], v104 offset:6560
  ds_read_b128 v[72:75], v102 offset:4096
  ds_read_b64_tr_b16 v[88:89], v104 offset:7680
  ds_read_b64_tr_b16 v[90:91], v104 offset:7840
  ds_read_b128 v[76:79], v103 offset:4096
  ds_read_b64_tr_b16 v[92:93], v104 offset:8960
  ds_read_b64_tr_b16 v[94:95], v104 offset:9120
  s_waitcnt lgkmcnt(15)
  v_mfma_f32_16x16x32_bf16 v[108:111], v[48:51], v[32:35], 0
  s_waitcnt lgkmcnt(15)
  v_mfma_f32_16x16x32_bf16 v[108:111], v[52:55], v[36:39], v[108:111]
  s_waitcnt lgkmcnt(15)
  v_mfma_f32_16x16x32_bf16 v[108:111], v[56:59], v[40:43], v[108:111]
  s_waitcnt lgkmcnt(12)
  v_mfma_f32_16x16x32_bf16 v[108:111], v[60:63], v[44:47], v[108:111]
  ds_read_b128 v[32:35], v100 offset:8192
  ds_read_b64_tr_b16 v[48:49], v104 offset:10240
  ds_read_b64_tr_b16 v[50:51], v104 offset:10400
  ds_read_b128 v[36:39], v101 offset:8192
  ds_read_b64_tr_b16 v[52:53], v104 offset:11520
  ds_read_b64_tr_b16 v[54:55], v104 offset:11680
  ds_read_b128 v[40:43], v102 offset:8192
  ds_read_b64_tr_b16 v[56:57], v104 offset:12800
  ds_read_b64_tr_b16 v[58:59], v104 offset:12960
  ds_read_b128 v[44:47], v103 offset:8192
  ds_read_b64_tr_b16 v[60:61], v104 offset:14080
  ds_read_b64_tr_b16 v[62:63], v104 offset:14240
  s_waitcnt lgkmcnt(15)
  v_mfma_f32_16x16x32_bf16 v[108:111], v[80:83], v[64:67], v[108:111]
  s_waitcnt lgkmcnt(15)
  v_mfma_f32_16x16x32_bf16 v[108:111], v[84:87], v[68:71], v[108:111]
  s_waitcnt lgkmcnt(15)
  v_mfma_f32_16x16x32_bf16 v[108:111], v[88:91], v[72:75], v[108:111]
  s_waitcnt lgkmcnt(12)
  v_mfma_f32_16x16x32_bf16 v[108:111], v[92:95], v[76:79], v[108:111]
  ds_read_b128 v[64:67], v100 offset:12288
  ds_read_b64_tr_b16 v[80:81], v104 offset:15360
  ds_read_b64_tr_b16 v[82:83], v104 offset:15520
  ds_read_b128 v[68:71], v101 offset:12288
  ds_read_b64_tr_b16 v[84:85], v104 offset:16640
  ds_read_b64_tr_b16 v[86:87], v104 offset:16800
  ds_read_b128 v[72:75], v102 offset:12288
  ds_read_b64_tr_b16 v[88:89], v104 offset:17920
  ds_read_b64_tr_b16 v[90:91], v104 offset:18080
  ds_read_b128 v[76:79], v103 offset:12288
  ds_read_b64_tr_b16 v[92:93], v104 offset:19200
  ds_read_b64_tr_b16 v[94:95], v104 offset:19360
  s_waitcnt lgkmcnt(15)
  v_mfma_f32_16x16x32_bf16 v[108:111], v[48:51], v[32:35], v[108:111]
  s_waitcnt lgkmcnt(15)
  v_mfma_f32_16x16x32_bf16 v[108:111], v[52:55], v[36:39], v[108:111]
  s_waitcnt lgkmcnt(15)
  v_mfma_f32_16x16x32_bf16 v[108:111], v[56:59], v[40:43], v[108:111]
  s_waitcnt lgkmcnt(12)
  v_mfma_f32_16x16x32_bf16 v[108:111], v[60:63], v[44:47], v[108:111]
  ds_read_b128 v[32:35], v100 offset:16384
  ds_read_b64_tr_b16 v[48:49], v104 offset:20480
  ds_read_b64_tr_b16 v[50:51], v104 offset:20640
  ds_read_b128 v[36:39], v101 offset:16384
  ds_read_b64_tr_b16 v[52:53], v104 offset:21760
  ds_read_b64_tr_b16 v[54:55], v104 offset:21920
  ds_read_b128 v[40:43], v102 offset:16384
  ds_read_b64_tr_b16 v[56:57], v104 offset:23040
  ds_read_b64_tr_b16 v[58:59], v104 offset:23200
  ds_read_b128 v[44:47], v103 offset:16384
  ds_read_b64_tr_b16 v[60:61], v104 offset:24320
  ds_read_b64_tr_b16 v[62:63], v104 offset:24480
  s_waitcnt lgkmcnt(15)
  v_mfma_f32_16x16x32_bf16 v[108:111], v[80:83], v[64:67], v[108:111]
  s_waitcnt lgkmcnt(15)
  v_mfma_f32_16x16x32_bf16 v[108:111], v[84:87], v[68:71], v[108:111]
  s_waitcnt lgkmcnt(15)
  v_mfma_f32_16x16x32_bf16 v[108:111], v[88:91], v[72:75], v[108:111]
  s_waitcnt lgkmcnt(12)
  v_mfma_f32_16x16x32_bf16 v[108:111], v[92:95], v[76:79], v[108:111]
  s_waitcnt lgkmcnt(9)
  v_mfma_f32_16x16x32_bf16 v[108:111], v[48:51], v[32:35], v[108:111]
  s_waitcnt lgkmcnt(6)
  v_mfma_f32_16x16x32_bf16 v[108:111], v[52:55], v[36:39], v[108:111]
  s_waitcnt lgkmcnt(3)
  v_mfma_f32_16x16x32_bf16 v[108:111], v[56:59], v[40:43], v[108:111]
  s_waitcnt lgkmcnt(0)
  v_mfma_f32_16x16x32_bf16 v[108:111], v[60:63], v[44:47], v[108:111]
  s_nop 7
  s_nop 1
  s_lshr_b32 s26, s29, 5
  s_mul_i32 s26, s26, 3072
  s_bfe_u32 s27, s29, 0x10004
  v_cvt_pk_bf16_f32 v108, v108, v109
  v_cvt_pk_bf16_f32 v109, v110, v111
  v_and_b32 v96, 15, v1
  v_bfe_u32 v97, v1, 4, 1
  v_lshrrev_b32 v98, 5, v1
  v_cmp_gt_u32 vcc, 16, v1
  s_nop 1
  v_cndmask_b32 v108, 0, v108, vcc
  v_cndmask_b32 v109, 0, v109, vcc
  v_lshlrev_b32 v97, 5, v97
  v_add_u32 v96, v96, v97
  s_lshl_b32 s27, s27, 4
  v_add_u32 v96, s27, v96
  v_lshlrev_b32 v96, 3, v96
  s_mov_b64 exec, 0xffffffff
  buffer_store_dwordx2 v[108:109], v96, s[12:15], s26 offen offset:1024 sc1
  s_mov_b64 exec, -1
  s_branch kvdone_9
kv_g_12:
  ds_read_b128 v[32:35], v100 offset:0
  ds_read_b128 v[48:51], v105 offset:0
  ds_read_b128 v[36:39], v101 offset:0
  ds_read_b128 v[52:55], v105 offset:64
  ds_read_b128 v[40:43], v102 offset:0
  ds_read_b128 v[56:59], v105 offset:128
  ds_read_b128 v[44:47], v103 offset:0
  ds_read_b128 v[60:63], v105 offset:192
  ds_read_b128 v[64:67], v100 offset:4096
  ds_read_b128 v[80:83], v105 offset:256
  ds_read_b128 v[68:71], v101 offset:4096
  ds_read_b128 v[84:87], v105 offset:320
  ds_read_b128 v[72:75], v102 offset:4096
  ds_read_b128 v[88:91], v105 offset:384
  ds_read_b128 v[76:79], v103 offset:4096
  ds_read_b128 v[92:95], v105 offset:448
  s_waitcnt lgkmcnt(14)
  v_mfma_f32_16x16x32_bf16 v[108:111], v[48:51], v[32:35], 0
  s_waitcnt lgkmcnt(12)
  v_mfma_f32_16x16x32_bf16 v[108:111], v[52:55], v[36:39], v[108:111]
  s_waitcnt lgkmcnt(10)
  v_mfma_f32_16x16x32_bf16 v[108:111], v[56:59], v[40:43], v[108:111]
  s_waitcnt lgkmcnt(8)
  v_mfma_f32_16x16x32_bf16 v[108:111], v[60:63], v[44:47], v[108:111]
  ds_read_b128 v[32:35], v100 offset:8192
  ds_read_b128 v[48:51], v105 offset:512
  ds_read_b128 v[36:39], v101 offset:8192
  ds_read_b128 v[52:55], v105 offset:576
  ds_read_b128 v[40:43], v102 offset:8192
  ds_read_b128 v[56:59], v105 offset:640
  ds_read_b128 v[44:47], v103 offset:8192
  ds_read_b128 v[60:63], v105 offset:704
  s_waitcnt lgkmcnt(14)
  v_mfma_f32_16x16x32_bf16 v[108:111], v[80:83], v[64:67], v[108:111]
  s_waitcnt lgkmcnt(12)
  v_mfma_f32_16x16x32_bf16 v[108:111], v[84:87], v[68:71], v[108:111]
  s_waitcnt lgkmcnt(10)
  v_mfma_f32_16x16x32_bf16 v[108:111], v[88:91], v[72:75], v[108:111]
  s_waitcnt lgkmcnt(8)
  v_mfma_f32_16x16x32_bf16 v[108:111], v[92:95], v[76:79], v[108:111]
  ds_read_b128 v[64:67], v100 offset:12288
  ds_read_b128 v[80:83], v105 offset:768
  ds_read_b128 v[68:71], v101 offset:12288
  ds_read_b128 v[84:87], v105 offset:832
  ds_read_b128 v[72:75], v102 offset:12288
  ds_read_b128 v[88:91], v105 offset:896
  ds_read_b128 v[76:79], v103 offset:12288
  ds_read_b128 v[92:95], v105 offset:960
  s_waitcnt lgkmcnt(14)
  v_mfma_f32_16x16x32_bf16 v[108:111], v[48:51], v[32:35], v[108:111]
  s_waitcnt lgkmcnt(12)
  v_mfma_f32_16x16x32_bf16 v[108:111], v[52:55], v[36:39], v[108:111]
  s_waitcnt lgkmcnt(10)
  v_mfma_f32_16x16x32_bf16 v[108:111], v[56:59], v[40:43], v[108:111]
  s_waitcnt lgkmcnt(8)
  v_mfma_f32_16x16x32_bf16 v[108:111], v[60:63], v[44:47], v[108:111]
  ds_read_b128 v[32:35], v100 offset:16384
  ds_read_b128 v[48:51], v105 offset:1024
  ds_read_b128 v[36:39], v101 offset:16384
  ds_read_b128 v[52:55], v105 offset:1088
  ds_read_b128 v[40:43], v102 offset:16384
  ds_read_b128 v[56:59], v105 offset:1152
  ds_read_b128 v[44:47], v103 offset:16384
  ds_read_b128 v[60:63], v105 offset:1216
  s_waitcnt lgkmcnt(14)
  v_mfma_f32_16x16x32_bf16 v[108:111], v[80:83], v[64:67], v[108:111]
  s_waitcnt lgkmcnt(12)
  v_mfma_f32_16x16x32_bf16 v[108:111], v[84:87], v[68:71], v[108:111]
  s_waitcnt lgkmcnt(10)
  v_mfma_f32_16x16x32_bf16 v[108:111], v[88:91], v[72:75], v[108:111]
  s_waitcnt lgkmcnt(8)
  v_mfma_f32_16x16x32_bf16 v[108:111], v[92:95], v[76:79], v[108:111]
  s_waitcnt lgkmcnt(6)
  v_mfma_f32_16x16x32_bf16 v[108:111], v[48:51], v[32:35], v[108:111]
  s_waitcnt lgkmcnt(4)
  v_mfma_f32_16x16x32_bf16 v[108:111], v[52:55], v[36:39], v[108:111]
  s_waitcnt lgkmcnt(2)
  v_mfma_f32_16x16x32_bf16 v[108:111], v[56:59], v[40:43], v[108:111]
  s_waitcnt lgkmcnt(0)
  v_mfma_f32_16x16x32_bf16 v[108:111], v[60:63], v[44:47], v[108:111]
  s_nop 7
  s_nop 1
  s_mov_b32 s26, 0xbfb8aa3b
  v_mul_f32 v108, s26, v108
  v_exp_f32 v108, v108
  s_nop 0
  v_add_f32 v108, 1.0, v108
  v_rcp_f32 v108, v108
  v_and_b32 v96, 15, v1
  v_add_u32 v96, s29, v96
  v_lshlrev_b32 v96, 2, v96
  s_mov_b32 s26, 196608
  s_mov_b64 exec, 0xffff
  buffer_store_dword v108, v96, s[12:15], s26 offen sc1
  s_mov_b64 exec, -1
  s_branch kvdone_9
kv_v0_13:
  ds_read_b128 v[32:35], v100 offset:0
  ds_read_b64_tr_b16 v[48:49], v104 offset:0
  ds_read_b64_tr_b16 v[50:51], v104 offset:160
  ds_read_b128 v[36:39], v101 offset:0
  ds_read_b64_tr_b16 v[52:53], v104 offset:1280
  ds_read_b64_tr_b16 v[54:55], v104 offset:1440
  ds_read_b128 v[40:43], v102 offset:0
  ds_read_b64_tr_b16 v[56:57], v104 offset:2560
  ds_read_b64_tr_b16 v[58:59], v104 offset:2720
  ds_read_b128 v[44:47], v103 offset:0
  ds_read_b64_tr_b16 v[60:61], v104 offset:3840
  ds_read_b64_tr_b16 v[62:63], v104 offset:4000
  ds_read_b128 v[64:67], v100 offset:4096
  ds_read_b64_tr_b16 v[80:81], v104 offset:5120
  ds_read_b64_tr_b16 v[82:83], v104 offset:5280
  ds_read_b128 v[68:71], v101 offset:4096
  ds_read_b64_tr_b16 v[84:85], v104 offset:6400
  ds_read_b64_tr_b16 v[86:87], v104 offset:6560
  ds_read_b128 v[72:75], v102 offset:4096
  ds_read_b64_tr_b16 v[88:89], v104 offset:7680
  ds_read_b64_tr_b16 v[90:91], v104 offset:7840
  ds_read_b128 v[76:79], v103 offset:4096
  ds_read_b64_tr_b16 v[92:93], v104 offset:8960
  ds_read_b64_tr_b16 v[94:95], v104 offset:9120
  s_waitcnt lgkmcnt(15)
  v_mfma_f32_16x16x32_bf16 v[108:111], v[32:35], v[48:51], 0
  s_waitcnt lgkmcnt(15)
  v_mfma_f32_16x16x32_bf16 v[108:111], v[36:39], v[52:55], v[108:111]
  s_waitcnt lgkmcnt(15)
  v_mfma_f32_16x16x32_bf16 v[108:111], v[40:43], v[56:59], v[108:111]
  s_waitcnt lgkmcnt(12)
  v_mfma_f32_16x16x32_bf16 v[108:111], v[44:47], v[60:63], v[108:111]
  ds_read_b128 v[32:35], v100 offset:8192
  ds_read_b64_tr_b16 v[48:49], v104 offset:10240
  ds_read_b64_tr_b16 v[50:51], v104 offset:10400
  ds_read_b128 v[36:39], v101 offset:8192
  ds_read_b64_tr_b16 v[52:53], v104 offset:11520
  ds_read_b64_tr_b16 v[54:55], v104 offset:11680
  ds_read_b128 v[40:43], v102 offset:8192
  ds_read_b64_tr_b16 v[56:57], v104 offset:12800
  ds_read_b64_tr_b16 v[58:59], v104 offset:12960
  ds_read_b128 v[44:47], v103 offset:8192
  ds_read_b64_tr_b16 v[60:61], v104 offset:14080
  ds_read_b64_tr_b16 v[62:63], v104 offset:14240
  s_waitcnt lgkmcnt(15)
  v_mfma_f32_16x16x32_bf16 v[108:111], v[64:67], v[80:83], v[108:111]
  s_waitcnt lgkmcnt(15)
  v_mfma_f32_16x16x32_bf16 v[108:111], v[68:71], v[84:87], v[108:111]
  s_waitcnt lgkmcnt(15)
  v_mfma_f32_16x16x32_bf16 v[108:111], v[72:75], v[88:91], v[108:111]
  s_waitcnt lgkmcnt(12)
  v_mfma_f32_16x16x32_bf16 v[108:111], v[76:79], v[92:95], v[108:111]
  ds_read_b128 v[64:67], v100 offset:12288
  ds_read_b64_tr_b16 v[80:81], v104 offset:15360
  ds_read_b64_tr_b16 v[82:83], v104 offset:15520
  ds_read_b128 v[68:71], v101 offset:12288
  ds_read_b64_tr_b16 v[84:85], v104 offset:16640
  ds_read_b64_tr_b16 v[86:87], v104 offset:16800
  ds_read_b128 v[72:75], v102 offset:12288
  ds_read_b64_tr_b16 v[88:89], v104 offset:17920
  ds_read_b64_tr_b16 v[90:91], v104 offset:18080
  ds_read_b128 v[76:79], v103 offset:12288
  ds_read_b64_tr_b16 v[92:93], v104 offset:19200
  ds_read_b64_tr_b16 v[94:95], v104 offset:19360
  s_waitcnt lgkmcnt(15)
  v_mfma_f32_16x16x32_bf16 v[108:111], v[32:35], v[48:51], v[108:111]
  s_waitcnt lgkmcnt(15)
  v_mfma_f32_16x16x32_bf16 v[108:111], v[36:39], v[52:55], v[108:111]
  s_waitcnt lgkmcnt(15)
  v_mfma_f32_16x16x32_bf16 v[108:111], v[40:43], v[56:59], v[108:111]
  s_waitcnt lgkmcnt(12)
  v_mfma_f32_16x16x32_bf16 v[108:111], v[44:47], v[60:63], v[108:111]
  ds_read_b128 v[32:35], v100 offset:16384
  ds_read_b64_tr_b16 v[48:49], v104 offset:20480
  ds_read_b64_tr_b16 v[50:51], v104 offset:20640
  ds_read_b128 v[36:39], v101 offset:16384
  ds_read_b64_tr_b16 v[52:53], v104 offset:21760
  ds_read_b64_tr_b16 v[54:55], v104 offset:21920
  ds_read_b128 v[40:43], v102 offset:16384
  ds_read_b64_tr_b16 v[56:57], v104 offset:23040
  ds_read_b64_tr_b16 v[58:59], v104 offset:23200
  ds_read_b128 v[44:47], v103 offset:16384
  ds_read_b64_tr_b16 v[60:61], v104 offset:24320
  ds_read_b64_tr_b16 v[62:63], v104 offset:24480
  s_waitcnt lgkmcnt(15)
  v_mfma_f32_16x16x32_bf16 v[108:111], v[64:67], v[80:83], v[108:111]
  s_waitcnt lgkmcnt(15)
  v_mfma_f32_16x16x32_bf16 v[108:111], v[68:71], v[84:87], v[108:111]
  s_waitcnt lgkmcnt(15)
  v_mfma_f32_16x16x32_bf16 v[108:111], v[72:75], v[88:91], v[108:111]
  s_waitcnt lgkmcnt(12)
  v_mfma_f32_16x16x32_bf16 v[108:111], v[76:79], v[92:95], v[108:111]
  s_waitcnt lgkmcnt(9)
  v_mfma_f32_16x16x32_bf16 v[108:111], v[32:35], v[48:51], v[108:111]
  s_waitcnt lgkmcnt(6)
  v_mfma_f32_16x16x32_bf16 v[108:111], v[36:39], v[52:55], v[108:111]
  s_waitcnt lgkmcnt(3)
  v_mfma_f32_16x16x32_bf16 v[108:111], v[40:43], v[56:59], v[108:111]
  s_waitcnt lgkmcnt(0)
  v_mfma_f32_16x16x32_bf16 v[108:111], v[44:47], v[60:63], v[108:111]
  s_nop 7
  s_nop 1
  s_lshr_b32 s26, s29, 5
  s_mul_i32 s26, s26, 3072
  s_bfe_u32 s27, s29, 0x10004
  v_cvt_pk_bf16_f32 v108, v108, v109
  v_cvt_pk_bf16_f32 v109, v110, v111
  v_and_b32 v96, 15, v1
  v_bfe_u32 v97, v1, 4, 1
  v_lshrrev_b32 v98, 5, v1
  v_mul_u32_u24 v97, 384, v97
  v_lshlrev_b32 v99, 4, v96
  v_add_u32 v97, v97, v99
  v_lshlrev_b32 v98, 3, v98
  v_add_u32 v97, v97, v98
  s_mul_i32 s27, s27, 768
  s_add_u32 s26, s26, s27
  buffer_store_dwordx2 v[108:109], v97, s[12:15], s26 offen offset:1536 sc1
  s_branch kvdone_9
kv_v1_14:
  ds_read_b128 v[32:35], v100 offset:0
  ds_read_b64_tr_b16 v[48:49], v104 offset:0
  ds_read_b64_tr_b16 v[50:51], v104 offset:160
  ds_read_b128 v[36:39], v101 offset:0
  ds_read_b64_tr_b16 v[52:53], v104 offset:1280
  ds_read_b64_tr_b16 v[54:55], v104 offset:1440
  ds_read_b128 v[40:43], v102 offset:0
  ds_read_b64_tr_b16 v[56:57], v104 offset:2560
  ds_read_b64_tr_b16 v[58:59], v104 offset:2720
  ds_read_b128 v[44:47], v103 offset:0
  ds_read_b64_tr_b16 v[60:61], v104 offset:3840
  ds_read_b64_tr_b16 v[62:63], v104 offset:4000
  ds_read_b128 v[64:67], v100 offset:4096
  ds_read_b64_tr_b16 v[80:81], v104 offset:5120
  ds_read_b64_tr_b16 v[82:83], v104 offset:5280
  ds_read_b128 v[68:71], v101 offset:4096
  ds_read_b64_tr_b16 v[84:85], v104 offset:6400
  ds_read_b64_tr_b16 v[86:87], v104 offset:6560
  ds_read_b128 v[72:75], v102 offset:4096
  ds_read_b64_tr_b16 v[88:89], v104 offset:7680
  ds_read_b64_tr_b16 v[90:91], v104 offset:7840
  ds_read_b128 v[76:79], v103 offset:4096
  ds_read_b64_tr_b16 v[92:93], v104 offset:8960
  ds_read_b64_tr_b16 v[94:95], v104 offset:9120
  s_waitcnt lgkmcnt(15)
  v_mfma_f32_16x16x32_bf16 v[108:111], v[32:35], v[48:51], 0
  s_waitcnt lgkmcnt(15)
  v_mfma_f32_16x16x32_bf16 v[108:111], v[36:39], v[52:55], v[108:111]
  s_waitcnt lgkmcnt(15)
  v_mfma_f32_16x16x32_bf16 v[108:111], v[40:43], v[56:59], v[108:111]
  s_waitcnt lgkmcnt(12)
  v_mfma_f32_16x16x32_bf16 v[108:111], v[44:47], v[60:63], v[108:111]
  ds_read_b128 v[32:35], v100 offset:8192
  ds_read_b64_tr_b16 v[48:49], v104 offset:10240
  ds_read_b64_tr_b16 v[50:51], v104 offset:10400
  ds_read_b128 v[36:39], v101 offset:8192
  ds_read_b64_tr_b16 v[52:53], v104 offset:11520
  ds_read_b64_tr_b16 v[54:55], v104 offset:11680
  ds_read_b128 v[40:43], v102 offset:8192
  ds_read_b64_tr_b16 v[56:57], v104 offset:12800
  ds_read_b64_tr_b16 v[58:59], v104 offset:12960
  ds_read_b128 v[44:47], v103 offset:8192
  ds_read_b64_tr_b16 v[60:61], v104 offset:14080
  ds_read_b64_tr_b16 v[62:63], v104 offset:14240
  s_waitcnt lgkmcnt(15)
  v_mfma_f32_16x16x32_bf16 v[108:111], v[64:67], v[80:83], v[108:111]
  s_waitcnt lgkmcnt(15)
  v_mfma_f32_16x16x32_bf16 v[108:111], v[68:71], v[84:87], v[108:111]
  s_waitcnt lgkmcnt(15)
  v_mfma_f32_16x16x32_bf16 v[108:111], v[72:75], v[88:91], v[108:111]
  s_waitcnt lgkmcnt(12)
  v_mfma_f32_16x16x32_bf16 v[108:111], v[76:79], v[92:95], v[108:111]
  ds_read_b128 v[64:67], v100 offset:12288
  ds_read_b64_tr_b16 v[80:81], v104 offset:15360
  ds_read_b64_tr_b16 v[82:83], v104 offset:15520
  ds_read_b128 v[68:71], v101 offset:12288
  ds_read_b64_tr_b16 v[84:85], v104 offset:16640
  ds_read_b64_tr_b16 v[86:87], v104 offset:16800
  ds_read_b128 v[72:75], v102 offset:12288
  ds_read_b64_tr_b16 v[88:89], v104 offset:17920
  ds_read_b64_tr_b16 v[90:91], v104 offset:18080
  ds_read_b128 v[76:79], v103 offset:12288
  ds_read_b64_tr_b16 v[92:93], v104 offset:19200
  ds_read_b64_tr_b16 v[94:95], v104 offset:19360
  s_waitcnt lgkmcnt(15)
  v_mfma_f32_16x16x32_bf16 v[108:111], v[32:35], v[48:51], v[108:111]
  s_waitcnt lgkmcnt(15)
  v_mfma_f32_16x16x32_bf16 v[108:111], v[36:39], v[52:55], v[108:111]
  s_waitcnt lgkmcnt(15)
  v_mfma_f32_16x16x32_bf16 v[108:111], v[40:43], v[56:59], v[108:111]
  s_waitcnt lgkmcnt(12)
  v_mfma_f32_16x16x32_bf16 v[108:111], v[44:47], v[60:63], v[108:111]
  ds_read_b128 v[32:35], v100 offset:16384
  ds_read_b64_tr_b16 v[48:49], v104 offset:20480
  ds_read_b64_tr_b16 v[50:51], v104 offset:20640
  ds_read_b128 v[36:39], v101 offset:16384
  ds_read_b64_tr_b16 v[52:53], v104 offset:21760
  ds_read_b64_tr_b16 v[54:55], v104 offset:21920
  ds_read_b128 v[40:43], v102 offset:16384
  ds_read_b64_tr_b16 v[56:57], v104 offset:23040
  ds_read_b64_tr_b16 v[58:59], v104 offset:23200
  ds_read_b128 v[44:47], v103 offset:16384
  ds_read_b64_tr_b16 v[60:61], v104 offset:24320
  ds_read_b64_tr_b16 v[62:63], v104 offset:24480
  s_waitcnt lgkmcnt(15)
  v_mfma_f32_16x16x32_bf16 v[108:111], v[64:67], v[80:83], v[108:111]
  s_waitcnt lgkmcnt(15)
  v_mfma_f32_16x16x32_bf16 v[108:111], v[68:71], v[84:87], v[108:111]
  s_waitcnt lgkmcnt(15)
  v_mfma_f32_16x16x32_bf16 v[108:111], v[72:75], v[88:91], v[108:111]
  s_waitcnt lgkmcnt(12)
  v_mfma_f32_16x16x32_bf16 v[108:111], v[76:79], v[92:95], v[108:111]
  s_waitcnt lgkmcnt(9)
  v_mfma_f32_16x16x32_bf16 v[108:111], v[32:35], v[48:51], v[108:111]
  s_waitcnt lgkmcnt(6)
  v_mfma_f32_16x16x32_bf16 v[108:111], v[36:39], v[52:55], v[108:111]
  s_waitcnt lgkmcnt(3)
  v_mfma_f32_16x16x32_bf16 v[108:111], v[40:43], v[56:59], v[108:111]
  s_waitcnt lgkmcnt(0)
  v_mfma_f32_16x16x32_bf16 v[108:111], v[44:47], v[60:63], v[108:111]
  s_nop 7
  s_nop 1
  s_lshr_b32 s26, s29, 5
  s_mul_i32 s26, s26, 3072
  s_bfe_u32 s27, s29, 0x10004
  v_cvt_pk_bf16_f32 v108, v108, v109
  v_cvt_pk_bf16_f32 v109, v110, v111
  v_and_b32 v96, 15, v1
  v_bfe_u32 v97, v1, 4, 1
  v_lshrrev_b32 v98, 5, v1
  v_cmp_gt_u32 vcc, 4, v96
  s_nop 1
  v_cndmask_b32 v108, 0, v108, vcc
  v_cndmask_b32 v109, 0, v109, vcc
  v_mov_b32 v99, 0x3f803f80
  v_cmp_eq_u32 vcc, 4, v96
  s_nop 1
  v_cndmask_b32 v108, v108, v99, vcc
  v_cndmask_b32 v109, v109, v99, vcc
  v_mul_u32_u24 v97, 384, v97
  v_lshlrev_b32 v99, 4, v96
  v_add_u32 v97, v97, v99
  v_lshlrev_b32 v98, 3, v98
  v_add_u32 v97, v97, v98
  s_mul_i32 s27, s27, 768
  s_add_u32 s26, s26, s27
  v_cmp_gt_u32 vcc, 8, v96
  s_and_saveexec_b64 s[46:47], vcc
  buffer_store_dwordx2 v[108:109], v97, s[12:15], s26 offen offset:1792 sc1
  s_mov_b64 exec, -1
kvdone_9:
  s_cmp_lg_u32 s20, 7
  s_cbranch_scc1 nn_15
  v_mov_b32 v124, 0
  s_mov_b32 s29, 0
ng_16:
  global_load_dword v125, v124, s[52:53] sc1
  s_waitcnt vmcnt(0)
  v_readfirstlane_b32 s57, v125
  s_add_u32 s29, s29, 1
  s_cmp_ge_u32 s29, 200000
  s_cbranch_scc1 ngd_17
  s_cmp_eq_u32 s57, 0
  s_cbranch_scc1 ng_16
ngd_17:
nn_15:
  s_barrier
  s_add_u32 m0, s35, 18432
  s_movk_i32 s33, 128
  buffer_load_dwordx4 v117, s[4:7], s33 offen lds
  s_add_u32 m0, s35, 26624
  s_mov_b32 s33, 81920
  buffer_load_dwordx4 v118, s[8:11], s33 offen lds
  s_add_u32 m0, s35, 36864
  s_movk_i32 s33, 256
  buffer_load_dwordx4 v117, s[4:7], s33 offen lds
  s_add_u32 m0, s35, 45056
  s_mov_b32 s33, 163840
  buffer_load_dwordx4 v118, s[8:11], s33 offen lds
  s_add_u32 m0, s35, 55296
  s_movk_i32 s33, 384
  buffer_load_dwordx4 v117, s[4:7], s33 offen lds
  s_add_u32 m0, s35, 63488
  s_mov_b32 s33, 245760
  buffer_load_dwordx4 v118, s[8:11], s33 offen lds
  s_waitcnt vmcnt(6)
  s_waitcnt vmcnt(6)
  s_barrier
  s_cmp_lg_u32 s20, 7
  s_cbranch_scc1 kvf_18
  s_lshl_b32 s26, s2, 3
  s_add_u32 s26, s26, 4128768
  v_mov_b32 v124, 0
  v_mov_b32 v125, s57
  s_mov_b64 exec, 1
  buffer_store_dword v125, v124, s[12:15], s26 offen sc1
  s_mov_b64 exec, -1
kvf_18:
  ds_read_b128 v[32:35], v112 offset:0
  ds_read_b64_tr_b16 v[48:49], v116 offset:0
  ds_read_b64_tr_b16 v[50:51], v116 offset:640
  ds_read_b128 v[36:39], v113 offset:0
  ds_read_b64_tr_b16 v[52:53], v116 offset:2560
  ds_read_b64_tr_b16 v[54:55], v116 offset:3200
  ds_read_b128 v[40:43], v114 offset:0
  ds_read_b64_tr_b16 v[56:57], v116 offset:5120
  ds_read_b64_tr_b16 v[58:59], v116 offset:5760
  ds_read_b128 v[44:47], v115 offset:0
  ds_read_b64_tr_b16 v[60:61], v116 offset:7680
  ds_read_b64_tr_b16 v[62:63], v116 offset:8320
  s_cmp_eq_u32 s20, 7
  s_cbranch_scc1 w7_19
  s_waitcnt vmcnt(4) lgkmcnt(0)
  s_branch w7e_20
w7_19:
  s_waitcnt vmcnt(5) lgkmcnt(0)
w7e_20:
  s_barrier
  s_add_u32 m0, s35, 0
  s_movk_i32 s33, 512
  buffer_load_dwordx4 v117, s[4:7], s33 offen lds
  s_add_u32 m0, s35, 8192
  s_mov_b32 s33, 327680
  buffer_load_dwordx4 v118, s[8:11], s33 offen lds
  ds_read_b128 v[80:83], v112 offset:18432
  ds_read_b64_tr_b16 v[96:97], v116 offset:18432
  ds_read_b64_tr_b16 v[98:99], v116 offset:19072
  ds_read_b128 v[84:87], v113 offset:18432
  ds_read_b64_tr_b16 v[100:101], v116 offset:20992
  ds_read_b64_tr_b16 v[102:103], v116 offset:21632
  ds_read_b128 v[88:91], v114 offset:18432
  ds_read_b64_tr_b16 v[104:105], v116 offset:23552
  ds_read_b64_tr_b16 v[106:107], v116 offset:24192
  ds_read_b128 v[92:95], v115 offset:18432
  ds_read_b64_tr_b16 v[108:109], v116 offset:26112
  ds_read_b64_tr_b16 v[110:111], v116 offset:26752
  s_waitcnt lgkmcnt(15)
  v_mfma_f32_32x32x16_bf16 v[64:79], v[48:51], v[32:35], 0
  s_waitcnt lgkmcnt(15)
  v_mfma_f32_32x32x16_bf16 v[64:79], v[52:55], v[36:39], v[64:79]
  s_waitcnt lgkmcnt(15)
  v_mfma_f32_32x32x16_bf16 v[64:79], v[56:59], v[40:43], v[64:79]
  s_waitcnt lgkmcnt(12)
  v_mfma_f32_32x32x16_bf16 v[64:79], v[60:63], v[44:47], v[64:79]
  s_cmp_eq_u32 s20, 7
  s_cbranch_scc1 w7_21
  s_waitcnt vmcnt(4) lgkmcnt(0)
  s_branch w7e_22
w7_21:
  s_waitcnt vmcnt(5) lgkmcnt(0)
w7e_22:
  s_barrier
  s_add_u32 m0, s35, 18432
  s_movk_i32 s33, 640
  buffer_load_dwordx4 v117, s[4:7], s33 offen lds
  s_add_u32 m0, s35, 26624
  s_mov_b32 s33, 409600
  buffer_load_dwordx4 v118, s[8:11], s33 offen lds
  ds_read_b128 v[32:35], v112 offset:36864
  ds_read_b64_tr_b16 v[48:49], v116 offset:36864
  ds_read_b64_tr_b16 v[50:51], v116 offset:37504
  ds_read_b128 v[36:39], v113 offset:36864
  ds_read_b64_tr_b16 v[52:53], v116 offset:39424
  ds_read_b64_tr_b16 v[54:55], v116 offset:40064
  ds_read_b128 v[40:43], v114 offset:36864
  ds_read_b64_tr_b16 v[56:57], v116 offset:41984
  ds_read_b64_tr_b16 v[58:59], v116 offset:42624
  ds_read_b128 v[44:47], v115 offset:36864
  ds_read_b64_tr_b16 v[60:61], v116 offset:44544
  ds_read_b64_tr_b16 v[62:63], v116 offset:45184
  s_waitcnt lgkmcnt(15)
  v_mfma_f32_32x32x16_bf16 v[64:79], v[96:99], v[80:83], v[64:79]
  s_waitcnt lgkmcnt(15)
  v_mfma_f32_32x32x16_bf16 v[64:79], v[100:103], v[84:87], v[64:79]
  s_waitcnt lgkmcnt(15)
  v_mfma_f32_32x32x16_bf16 v[64:79], v[104:107], v[88:91], v[64:79]
  s_waitcnt lgkmcnt(12)
  v_mfma_f32_32x32x16_bf16 v[64:79], v[108:111], v[92:95], v[64:79]
  s_cmp_eq_u32 s20, 7
  s_cbranch_scc1 w7_23
  s_waitcnt vmcnt(4) lgkmcnt(0)
  s_branch w7e_24
w7_23:
  s_waitcnt vmcnt(5) lgkmcnt(0)
w7e_24:
  s_barrier
  s_add_u32 m0, s35, 36864
  s_movk_i32 s33, 768
  buffer_load_dwordx4 v117, s[4:7], s33 offen lds
  s_add_u32 m0, s35, 45056
  s_mov_b32 s33, 491520
  buffer_load_dwordx4 v118, s[8:11], s33 offen lds
  ds_read_b128 v[80:83], v112 offset:55296
  ds_read_b64_tr_b16 v[96:97], v116 offset:55296
  ds_read_b64_tr_b16 v[98:99], v116 offset:55936
  ds_read_b128 v[84:87], v113 offset:55296
  ds_read_b64_tr_b16 v[100:101], v116 offset:57856
  ds_read_b64_tr_b16 v[102:103], v116 offset:58496
  ds_read_b128 v[88:91], v114 offset:55296
  ds_read_b64_tr_b16 v[104:105], v116 offset:60416
  ds_read_b64_tr_b16 v[106:107], v116 offset:61056
  ds_read_b128 v[92:95], v115 offset:55296
  ds_read_b64_tr_b16 v[108:109], v116 offset:62976
  ds_read_b64_tr_b16 v[110:111], v116 offset:63616
  s_waitcnt lgkmcnt(15)
  v_mfma_f32_32x32x16_bf16 v[64:79], v[48:51], v[32:35], v[64:79]
  s_waitcnt lgkmcnt(15)
  v_mfma_f32_32x32x16_bf16 v[64:79], v[52:55], v[36:39], v[64:79]
  s_waitcnt lgkmcnt(15)
  v_mfma_f32_32x32x16_bf16 v[64:79], v[56:59], v[40:43], v[64:79]
  s_waitcnt lgkmcnt(12)
  v_mfma_f32_32x32x16_bf16 v[64:79], v[60:63], v[44:47], v[64:79]
  s_waitcnt vmcnt(4) lgkmcnt(0)
  s_barrier
  s_add_u32 m0, s35, 55296
  s_movk_i32 s33, 896
  buffer_load_dwordx4 v117, s[4:7], s33 offen lds
  s_add_u32 m0, s35, 63488
  s_mov_b32 s33, 573440
  buffer_load_dwordx4 v118, s[8:11], s33 offen lds
  ds_read_b128 v[32:35], v112 offset:0
  ds_read_b64_tr_b16 v[48:49], v116 offset:0
  ds_read_b64_tr_b16 v[50:51], v116 offset:640
  ds_read_b128 v[36:39], v113 offset:0
  ds_read_b64_tr_b16 v[52:53], v116 offset:2560
  ds_read_b64_tr_b16 v[54:55], v116 offset:3200
  ds_read_b128 v[40:43], v114 offset:0
  ds_read_b64_tr_b16 v[56:57], v116 offset:5120
  ds_read_b64_tr_b16 v[58:59], v116 offset:5760
  ds_read_b128 v[44:47], v115 offset:0
  ds_read_b64_tr_b16 v[60:61], v116 offset:7680
  ds_read_b64_tr_b16 v[62:63], v116 offset:8320
  s_waitcnt lgkmcnt(15)
  v_mfma_f32_32x32x16_bf16 v[64:79], v[96:99], v[80:83], v[64:79]
  s_waitcnt lgkmcnt(15)
  v_mfma_f32_32x32x16_bf16 v[64:79], v[100:103], v[84:87], v[64:79]
  s_waitcnt lgkmcnt(15)
  v_mfma_f32_32x32x16_bf16 v[64:79], v[104:107], v[88:91], v[64:79]
  s_waitcnt lgkmcnt(12)
  v_mfma_f32_32x32x16_bf16 v[64:79], v[108:111], v[92:95], v[64:79]
  s_waitcnt vmcnt(4) lgkmcnt(0)
  s_barrier
  s_add_u32 m0, s35, 0
  s_movk_i32 s33, 1024
  buffer_load_dwordx4 v117, s[4:7], s33 offen lds
  s_add_u32 m0, s35, 8192
  s_mov_b32 s33, 655360
  buffer_load_dwordx4 v118, s[8:11], s33 offen lds
  ds_read_b128 v[80:83], v112 offset:18432
  ds_read_b64_tr_b16 v[96:97], v116 offset:18432
  ds_read_b64_tr_b16 v[98:99], v116 offset:19072
  ds_read_b128 v[84:87], v113 offset:18432
  ds_read_b64_tr_b16 v[100:101], v116 offset:20992
  ds_read_b64_tr_b16 v[102:103], v116 offset:21632
  ds_read_b128 v[88:91], v114 offset:18432
  ds_read_b64_tr_b16 v[104:105], v116 offset:23552
  ds_read_b64_tr_b16 v[106:107], v116 offset:24192
  ds_read_b128 v[92:95], v115 offset:18432
  ds_read_b64_tr_b16 v[108:109], v116 offset:26112
  ds_read_b64_tr_b16 v[110:111], v116 offset:26752
  s_waitcnt lgkmcnt(15)
  v_mfma_f32_32x32x16_bf16 v[64:79], v[48:51], v[32:35], v[64:79]
  s_waitcnt lgkmcnt(15)
  v_mfma_f32_32x32x16_bf16 v[64:79], v[52:55], v[36:39], v[64:79]
  s_waitcnt lgkmcnt(15)
  v_mfma_f32_32x32x16_bf16 v[64:79], v[56:59], v[40:43], v[64:79]
  s_waitcnt lgkmcnt(12)
  v_mfma_f32_32x32x16_bf16 v[64:79], v[60:63], v[44:47], v[64:79]
  s_waitcnt vmcnt(4) lgkmcnt(0)
  s_barrier
  s_add_u32 m0, s35, 18432
  s_movk_i32 s33, 1152
  buffer_load_dwordx4 v117, s[4:7], s33 offen lds
  s_add_u32 m0, s35, 26624
  s_mov_b32 s33, 737280
  buffer_load_dwordx4 v118, s[8:11], s33 offen lds
  v_lshlrev_b32 v24, 4, v1
  s_cmp_lg_u32 s20, 7
  s_cbranch_scc1 ek0_25
  s_mov_b32 s28, 4128768
  buffer_load_dwordx4 v[16:19], v24, s[12:15], s28 offen sc1
  buffer_load_dwordx4 v[20:23], v24, s[12:15], s28 offen offset:1024 sc1
ek0_25:
  ds_read_b128 v[32:35], v112 offset:36864
  ds_read_b64_tr_b16 v[48:49], v116 offset:36864
  ds_read_b64_tr_b16 v[50:51], v116 offset:37504
  ds_read_b128 v[36:39], v113 offset:36864
  ds_read_b64_tr_b16 v[52:53], v116 offset:39424
  ds_read_b64_tr_b16 v[54:55], v116 offset:40064
  ds_read_b128 v[40:43], v114 offset:36864
  ds_read_b64_tr_b16 v[56:57], v116 offset:41984
  ds_read_b64_tr_b16 v[58:59], v116 offset:42624
  ds_read_b128 v[44:47], v115 offset:36864
  ds_read_b64_tr_b16 v[60:61], v116 offset:44544
  ds_read_b64_tr_b16 v[62:63], v116 offset:45184
  s_waitcnt lgkmcnt(15)
  v_mfma_f32_32x32x16_bf16 v[64:79], v[96:99], v[80:83], v[64:79]
  s_waitcnt lgkmcnt(15)
  v_mfma_f32_32x32x16_bf16 v[64:79], v[100:103], v[84:87], v[64:79]
  s_waitcnt lgkmcnt(15)
  v_mfma_f32_32x32x16_bf16 v[64:79], v[104:107], v[88:91], v[64:79]
  s_waitcnt lgkmcnt(12)
  v_mfma_f32_32x32x16_bf16 v[64:79], v[108:111], v[92:95], v[64:79]
  s_cmp_eq_u32 s20, 7
  s_cbranch_scc1 w7_26
  s_waitcnt vmcnt(4) lgkmcnt(0)
  s_branch w7e_27
w7_26:
  s_waitcnt vmcnt(6) lgkmcnt(0)
w7e_27:
  s_barrier
  ds_read_b128 v[80:83], v112 offset:55296
  ds_read_b64_tr_b16 v[96:97], v116 offset:55296
  ds_read_b64_tr_b16 v[98:99], v116 offset:55936
  ds_read_b128 v[84:87], v113 offset:55296
  ds_read_b64_tr_b16 v[100:101], v116 offset:57856
  ds_read_b64_tr_b16 v[102:103], v116 offset:58496
  ds_read_b128 v[88:91], v114 offset:55296
  ds_read_b64_tr_b16 v[104:105], v116 offset:60416
  ds_read_b64_tr_b16 v[106:107], v116 offset:61056
  ds_read_b128 v[92:95], v115 offset:55296
  ds_read_b64_tr_b16 v[108:109], v116 offset:62976
  ds_read_b64_tr_b16 v[110:111], v116 offset:63616
  s_waitcnt lgkmcnt(15)
  v_mfma_f32_32x32x16_bf16 v[64:79], v[48:51], v[32:35], v[64:79]
  s_waitcnt lgkmcnt(15)
  v_mfma_f32_32x32x16_bf16 v[64:79], v[52:55], v[36:39], v[64:79]
  s_waitcnt lgkmcnt(15)
  v_mfma_f32_32x32x16_bf16 v[64:79], v[56:59], v[40:43], v[64:79]
  s_waitcnt lgkmcnt(12)
  v_mfma_f32_32x32x16_bf16 v[64:79], v[60:63], v[44:47], v[64:79]
  s_cmp_eq_u32 s20, 7
  s_cbranch_scc1 w7_28
  s_waitcnt vmcnt(2) lgkmcnt(0)
  s_branch w7e_29
w7_28:
  s_waitcnt vmcnt(4) lgkmcnt(0)
w7e_29:
  s_barrier
  ds_read_b128 v[32:35], v112 offset:0
  ds_read_b64_tr_b16 v[48:49], v116 offset:0
  ds_read_b64_tr_b16 v[50:51], v116 offset:640
  ds_read_b128 v[36:39], v113 offset:0
  ds_read_b64_tr_b16 v[52:53], v116 offset:2560
  ds_read_b64_tr_b16 v[54:55], v116 offset:3200
  ds_read_b128 v[40:43], v114 offset:0
  ds_read_b64_tr_b16 v[56:57], v116 offset:5120
  ds_read_b64_tr_b16 v[58:59], v116 offset:5760
  ds_read_b128 v[44:47], v115 offset:0
  ds_read_b64_tr_b16 v[60:61], v116 offset:7680
  ds_read_b64_tr_b16 v[62:63], v116 offset:8320
  s_waitcnt lgkmcnt(15)
  v_mfma_f32_32x32x16_bf16 v[64:79], v[96:99], v[80:83], v[64:79]
  s_waitcnt lgkmcnt(15)
  v_mfma_f32_32x32x16_bf16 v[64:79], v[100:103], v[84:87], v[64:79]
  s_waitcnt lgkmcnt(15)
  v_mfma_f32_32x32x16_bf16 v[64:79], v[104:107], v[88:91], v[64:79]
  s_waitcnt lgkmcnt(12)
  v_mfma_f32_32x32x16_bf16 v[64:79], v[108:111], v[92:95], v[64:79]
  s_waitcnt vmcnt(0) lgkmcnt(0)
  s_cmp_lg_u32 s20, 7
  s_cbranch_scc1 ek1_30
  s_mov_b32 s29, 0
ek1l_31:
  v_cmp_ne_u32 vcc, s57, v16
  s_cbranch_vccnz ek1a_32
  v_cmp_ne_u32 vcc, s57, v18
  s_cbranch_vccnz ek1a_32
  v_cmp_ne_u32 vcc, s57, v20
  s_cbranch_vccnz ek1a_32
  v_cmp_ne_u32 vcc, s57, v22
  s_cbranch_vccnz ek1a_32
  s_branch ek1_30
ek1a_32:
  s_mov_b32 s28, 4128768
  buffer_load_dwordx4 v[16:19], v24, s[12:15], s28 offen sc1
  buffer_load_dwordx4 v[20:23], v24, s[12:15], s28 offen offset:1024 sc1
  s_waitcnt vmcnt(0)
  s_add_u32 s29, s29, 1
  s_cmp_lt_u32 s29, 200000
  s_cbranch_scc1 ek1l_31
ek1_30:
  s_barrier
  s_mul_i32 s32, s20, 3072
  s_add_u32 s32, s32, 49152
  s_mov_b32 s31, 0
  s_mov_b32 m0, s32
  s_nop 0
  buffer_load_dwordx4 v14, s[12:15], s31 offen offset:0 sc1 lds
  buffer_load_dwordx4 v14, s[12:15], s31 offen offset:1024 sc1 lds
  buffer_load_dwordx4 v14, s[12:15], s31 offen offset:2048 sc1 lds
  v_and_b32 v15, 31, v1
  s_lshl_b32 s26, s21, 6
  s_lshl_b32 s27, s23, 5
  s_add_u32 s26, s26, s27
  v_add_u32 v15, s26, v15
  v_lshlrev_b32 v15, 2, v15
  s_mov_b32 s28, 196608
  buffer_load_dword v10, v15, s[12:15], s28 offen sc1
  ds_read_b128 v[80:83], v112 offset:18432
  ds_read_b64_tr_b16 v[96:97], v116 offset:18432
  ds_read_b64_tr_b16 v[98:99], v116 offset:19072
  ds_read_b128 v[84:87], v113 offset:18432
  ds_read_b64_tr_b16 v[100:101], v116 offset:20992
  ds_read_b64_tr_b16 v[102:103], v116 offset:21632
  ds_read_b128 v[88:91], v114 offset:18432
  ds_read_b64_tr_b16 v[104:105], v116 offset:23552
  ds_read_b64_tr_b16 v[106:107], v116 offset:24192
  ds_read_b128 v[92:95], v115 offset:18432
  ds_read_b64_tr_b16 v[108:109], v116 offset:26112
  ds_read_b64_tr_b16 v[110:111], v116 offset:26752
  s_waitcnt lgkmcnt(15)
  v_mfma_f32_32x32x16_bf16 v[64:79], v[48:51], v[32:35], v[64:79]
  s_waitcnt lgkmcnt(15)
  v_mfma_f32_32x32x16_bf16 v[64:79], v[52:55], v[36:39], v[64:79]
  s_waitcnt lgkmcnt(15)
  v_mfma_f32_32x32x16_bf16 v[64:79], v[56:59], v[40:43], v[64:79]
  s_waitcnt lgkmcnt(12)
  v_mfma_f32_32x32x16_bf16 v[64:79], v[60:63], v[44:47], v[64:79]
  s_waitcnt lgkmcnt(9)
  v_mfma_f32_32x32x16_bf16 v[64:79], v[96:99], v[80:83], v[64:79]
  s_waitcnt lgkmcnt(6)
  v_mfma_f32_32x32x16_bf16 v[64:79], v[100:103], v[84:87], v[64:79]
  s_waitcnt lgkmcnt(3)
  v_mfma_f32_32x32x16_bf16 v[64:79], v[104:107], v[88:91], v[64:79]
  s_waitcnt lgkmcnt(0)
  v_mfma_f32_32x32x16_bf16 v[64:79], v[108:111], v[92:95], v[64:79]
  s_branch qpend_5
qp3_4:
  s_add_u32 m0, s35, 0
  s_movk_i32 s33, 0
  buffer_load_dwordx4 v117, s[4:7], s33 offen lds
  s_add_u32 m0, s35, 8192
  s_mov_b32 s33, 0
  buffer_load_dwordx4 v118, s[8:11], s33 offen lds
  s_add_u32 m0, s35, 16384
  s_nop 0
  buffer_load_dwordx4 v119, s[8:11], s33 offen lds
  s_or_b32 s26, s2, s20
  s_cmp_lg_u32 s26, 0
  s_cbranch_scc1 np_33
  s_memrealtime s[58:59]
  s_waitcnt lgkmcnt(0)
  s_or_b32 s58, s58, 1
  v_mov_b32 v124, 0
  v_mov_b32 v125, s58
  s_mov_b64 exec, 1
  global_store_dword v124, v125, s[52:53] sc1
  s_mov_b64 exec, -1
np_33:
  v_and_b32 v16, 31, v1
  s_lshl_b32 s26, s23, 5
  v_add_u32 v16, s26, v16
  v_mul_u32_u24 v16, 176, v16
  v_lshrrev_b32 v18, 5, v1
  v_lshlrev_b32 v18, 3, v18
  s_mul_i32 s26, s24, 40
  s_add_u32 s26, s26, 49152
  v_add3_u32 v2, v16, v18, s26
  s_add_u32 s26, s20, 0
  s_lshl_b32 s26, s26, 2
  v_lshrrev_b32 v16, 4, v1
  v_add_u32 v16, s26, v16
  v_mul_u32_u24 v17, 26, v16
  v_lshrrev_b32 v17, 8, v17
  v_mul_u32_u24 v18, 10, v17
  v_sub_u32 v18, v16, v18
  v_and_b32 v19, 15, v1
  v_lshlrev_b32 v16, 4, v17
  v_add_u32 v16, v16, v19
  v_mul_u32_u24 v16, 176, v16
  v_lshlrev_b32 v3, 4, v18
  v_add_u32 v3, v3, v16
  v_add_u32 v3, 49152, v3
  v_mul_u32_u24 v17, 20480, v17
  v_lshlrev_b32 v18, 8, v18
  v_lshlrev_b32 v19, 4, v19
  v_add3_u32 v121, v17, v18, v19
  s_add_u32 s26, s20, 8
  s_lshl_b32 s26, s26, 2
  v_lshrrev_b32 v16, 4, v1
  v_add_u32 v16, s26, v16
  v_mul_u32_u24 v17, 26, v16
  v_lshrrev_b32 v17, 8, v17
  v_mul_u32_u24 v18, 10, v17
  v_sub_u32 v18, v16, v18
  v_and_b32 v19, 15, v1
  v_lshlrev_b32 v16, 4, v17
  v_add_u32 v16, v16, v19
  v_mul_u32_u24 v16, 176, v16
  v_lshlrev_b32 v120, 4, v18
  v_add_u32 v120, v120, v16
  v_add_u32 v120, 49152, v120
  v_mul_u32_u24 v17, 20480, v17
  v_lshlrev_b32 v18, 8, v18
  v_lshlrev_b32 v19, 4, v19
  v_add3_u32 v122, v17, v18, v19
  s_mul_i32 s50, s21, 81920
  s_mul_i32 s27, s22, 2560
  s_add_u32 s50, s50, s27
  s_add_u32 s50, s50, 10485760
  v_lshlrev_b32 v11, 4, v1
  v_lshlrev_b32 v12, 3, v1
  v_add_u32 v12, 50176, v12
  v_add_u32 v11, 49152, v11
  v_and_b32 v15, 31, v1
  v_min_u32 v33, 21, v15
  v_lshlrev_b32 v33, 4, v33
  v_lshrrev_b32 v32, 5, v1
  v_mul_u32_u24 v32, 384, v32
  v_add_u32 v33, v33, v32
  v_add_u32 v13, 50688, v33
  s_mul_i32 s26, s20, 3072
  v_lshlrev_b32 v14, 4, v1
  v_add_u32 v14, s26, v14
  s_cmp_lg_u32 s20, 3
  s_cbranch_scc1 pw_34
  v_mul_u32_u24 v124, 21846, v1
  v_lshrrev_b32 v124, 16, v124
  v_mul_u32_u24 v125, 3, v124
  v_sub_u32 v125, v1, v125
  v_mul_u32_u24 v124, 1280, v124
  v_lshlrev_b32 v125, 7, v125
  s_lshr_b32 s48, s2, 3
  s_mul_i32 s48, s48, 25600
  s_and_b32 s49, s2, 3
  s_mul_i32 s49, s49, 320
  s_and_b32 s49, s49, 0xffffff80
  s_add_u32 s48, s48, s49
  v_add3_u32 v124, v124, v125, s48
  v_cmp_gt_u32 vcc, 60, v1
  s_and_saveexec_b64 s[48:49], vcc
  buffer_load_dword v125, v124, s[8:11], 0 offen
  s_mov_b64 exec, -1
  s_waitcnt vmcnt(1)
  s_branch pw_35
pw_34:
  s_waitcnt vmcnt(0)
pw_35:
  s_barrier
  s_cmp_ge_u32 s20, 3
  s_cbranch_scc1 kvdone_36
  s_and_b32 s26, s22, 1
  s_lshl_b32 s27, s26, 2
  s_add_u32 s27, s27, s20
  s_cmp_eq_u32 s27, 6
  s_cbranch_scc1 kvdone_36
  v_and_b32 v96, 15, v1
  v_lshrrev_b32 v97, 4, v1
  v_xor_b32 v98, v96, v97
  v_lshlrev_b32 v99, 8, v96
  v_add_u32 v99, 18432, v99
  v_xor_b32 v100, 0, v98
  v_lshlrev_b32 v100, 4, v100
  v_add_u32 v100, v100, v99
  v_xor_b32 v101, 4, v98
  v_lshlrev_b32 v101, 4, v101
  v_add_u32 v101, v101, v99
  v_xor_b32 v102, 8, v98
  v_lshlrev_b32 v102, 4, v102
  v_add_u32 v102, v102, v99
  v_xor_b32 v103, 12, v98
  v_lshlrev_b32 v103, 4, v103
  v_add_u32 v103, v103, v99
  v_lshlrev_b32 v98, 3, v97
  v_bfe_u32 v99, v1, 2, 2
  v_add_u32 v98, v98, v99
  v_mul_u32_u24 v98, 40, v98
  v_and_b32 v99, 3, v1
  v_lshlrev_b32 v99, 3, v99
  v_add_u32 v98, v98, v99
  s_lshl_b32 s26, s20, 5
  s_add_u32 s26, s26, 38912
  v_add_u32 v104, s26, v98
  v_lshlrev_b32 v98, 4, v97
  v_add_u32 v105, 64512, v98
  s_cmp_eq_u32 s27, 1
  s_cbranch_scc1 kv_k1_38
  s_cmp_eq_u32 s27, 2
  s_cbranch_scc1 kv_g_39
  s_cmp_eq_u32 s27, 4
  s_cbranch_scc1 kv_v0_40
  s_cmp_eq_u32 s27, 5
  s_cbranch_scc1 kv_v1_41
  ds_read_b128 v[32:35], v100 offset:0
  ds_read_b64_tr_b16 v[48:49], v104 offset:0
  ds_read_b64_tr_b16 v[50:51], v104 offset:160
  ds_read_b128 v[36:39], v101 offset:0
  ds_read_b64_tr_b16 v[52:53], v104 offset:1280
  ds_read_b64_tr_b16 v[54:55], v104 offset:1440
  ds_read_b128 v[40:43], v102 offset:0
  ds_read_b64_tr_b16 v[56:57], v104 offset:2560
  ds_read_b64_tr_b16 v[58:59], v104 offset:2720
  ds_read_b128 v[44:47], v103 offset:0
  ds_read_b64_tr_b16 v[60:61], v104 offset:3840
  ds_read_b64_tr_b16 v[62:63], v104 offset:4000
  ds_read_b128 v[64:67], v100 offset:4096
  ds_read_b64_tr_b16 v[80:81], v104 offset:5120
  ds_read_b64_tr_b16 v[82:83], v104 offset:5280
  ds_read_b128 v[68:71], v101 offset:4096
  ds_read_b64_tr_b16 v[84:85], v104 offset:6400
  ds_read_b64_tr_b16 v[86:87], v104 offset:6560
  ds_read_b128 v[72:75], v102 offset:4096
  ds_read_b64_tr_b16 v[88:89], v104 offset:7680
  ds_read_b64_tr_b16 v[90:91], v104 offset:7840
  ds_read_b128 v[76:79], v103 offset:4096
  ds_read_b64_tr_b16 v[92:93], v104 offset:8960
  ds_read_b64_tr_b16 v[94:95], v104 offset:9120
  s_waitcnt lgkmcnt(15)
  v_mfma_f32_16x16x32_bf16 v[108:111], v[48:51], v[32:35], 0
  s_waitcnt lgkmcnt(15)
  v_mfma_f32_16x16x32_bf16 v[108:111], v[52:55], v[36:39], v[108:111]
  s_waitcnt lgkmcnt(15)
  v_mfma_f32_16x16x32_bf16 v[108:111], v[56:59], v[40:43], v[108:111]
  s_waitcnt lgkmcnt(12)
  v_mfma_f32_16x16x32_bf16 v[108:111], v[60:63], v[44:47], v[108:111]
  ds_read_b128 v[32:35], v100 offset:8192
  ds_read_b64_tr_b16 v[48:49], v104 offset:10240
  ds_read_b64_tr_b16 v[50:51], v104 offset:10400
  ds_read_b128 v[36:39], v101 offset:8192
  ds_read_b64_tr_b16 v[52:53], v104 offset:11520
  ds_read_b64_tr_b16 v[54:55], v104 offset:11680
  ds_read_b128 v[40:43], v102 offset:8192
  ds_read_b64_tr_b16 v[56:57], v104 offset:12800
  ds_read_b64_tr_b16 v[58:59], v104 offset:12960
  ds_read_b128 v[44:47], v103 offset:8192
  ds_read_b64_tr_b16 v[60:61], v104 offset:14080
  ds_read_b64_tr_b16 v[62:63], v104 offset:14240
  s_waitcnt lgkmcnt(15)
  v_mfma_f32_16x16x32_bf16 v[108:111], v[80:83], v[64:67], v[108:111]
  s_waitcnt lgkmcnt(15)
  v_mfma_f32_16x16x32_bf16 v[108:111], v[84:87], v[68:71], v[108:111]
  s_waitcnt lgkmcnt(15)
  v_mfma_f32_16x16x32_bf16 v[108:111], v[88:91], v[72:75], v[108:111]
  s_waitcnt lgkmcnt(12)
  v_mfma_f32_16x16x32_bf16 v[108:111], v[92:95], v[76:79], v[108:111]
  ds_read_b128 v[64:67], v100 offset:12288
  ds_read_b64_tr_b16 v[80:81], v104 offset:15360
  ds_read_b64_tr_b16 v[82:83], v104 offset:15520
  ds_read_b128 v[68:71], v101 offset:12288
  ds_read_b64_tr_b16 v[84:85], v104 offset:16640
  ds_read_b64_tr_b16 v[86:87], v104 offset:16800
  ds_read_b128 v[72:75], v102 offset:12288
  ds_read_b64_tr_b16 v[88:89], v104 offset:17920
  ds_read_b64_tr_b16 v[90:91], v104 offset:18080
  ds_read_b128 v[76:79], v103 offset:12288
  ds_read_b64_tr_b16 v[92:93], v104 offset:19200
  ds_read_b64_tr_b16 v[94:95], v104 offset:19360
  s_waitcnt lgkmcnt(15)
  v_mfma_f32_16x16x32_bf16 v[108:111], v[48:51], v[32:35], v[108:111]
  s_waitcnt lgkmcnt(15)
  v_mfma_f32_16x16x32_bf16 v[108:111], v[52:55], v[36:39], v[108:111]
  s_waitcnt lgkmcnt(15)
  v_mfma_f32_16x16x32_bf16 v[108:111], v[56:59], v[40:43], v[108:111]
  s_waitcnt lgkmcnt(12)
  v_mfma_f32_16x16x32_bf16 v[108:111], v[60:63], v[44:47], v[108:111]
  ds_read_b128 v[32:35], v100 offset:16384
  ds_read_b64_tr_b16 v[48:49], v104 offset:20480
  ds_read_b64_tr_b16 v[50:51], v104 offset:20640
  ds_read_b128 v[36:39], v101 offset:16384
  ds_read_b64_tr_b16 v[52:53], v104 offset:21760
  ds_read_b64_tr_b16 v[54:55], v104 offset:21920
  ds_read_b128 v[40:43], v102 offset:16384
  ds_read_b64_tr_b16 v[56:57], v104 offset:23040
  ds_read_b64_tr_b16 v[58:59], v104 offset:23200
  ds_read_b128 v[44:47], v103 offset:16384
  ds_read_b64_tr_b16 v[60:61], v104 offset:24320
  ds_read_b64_tr_b16 v[62:63], v104 offset:24480
  s_waitcnt lgkmcnt(15)
  v_mfma_f32_16x16x32_bf16 v[108:111], v[80:83], v[64:67], v[108:111]
  s_waitcnt lgkmcnt(15)
  v_mfma_f32_16x16x32_bf16 v[108:111], v[84:87], v[68:71], v[108:111]
  s_waitcnt lgkmcnt(15)
  v_mfma_f32_16x16x32_bf16 v[108:111], v[88:91], v[72:75], v[108:111]
  s_waitcnt lgkmcnt(12)
  v_mfma_f32_16x16x32_bf16 v[108:111], v[92:95], v[76:79], v[108:111]
  s_waitcnt lgkmcnt(9)
  v_mfma_f32_16x16x32_bf16 v[108:111], v[48:51], v[32:35], v[108:111]
  s_waitcnt lgkmcnt(6)
  v_mfma_f32_16x16x32_bf16 v[108:111], v[52:55], v[36:39], v[108:111]
  s_waitcnt lgkmcnt(3)
  v_mfma_f32_16x16x32_bf16 v[108:111], v[56:59], v[40:43], v[108:111]
  s_waitcnt lgkmcnt(0)
  v_mfma_f32_16x16x32_bf16 v[108:111], v[60:63], v[44:47], v[108:111]
  s_nop 7
  s_nop 1
  s_lshr_b32 s26, s29, 5
  s_mul_i32 s26, s26, 3072
  s_bfe_u32 s27, s29, 0x10004
  v_cvt_pk_bf16_f32 v108, v108, v109
  v_cvt_pk_bf16_f32 v109, v110, v111
  v_and_b32 v96, 15, v1
  v_bfe_u32 v97, v1, 4, 1
  v_lshrrev_b32 v98, 5, v1
  v_lshlrev_b32 v97, 5, v97
  v_add_u32 v96, v96, v97
  s_lshl_b32 s27, s27, 4
  v_add_u32 v96, s27, v96
  v_lshlrev_b32 v96, 4, v96
  v_lshlrev_b32 v98, 3, v98
  v_add_u32 v96, v96, v98
  buffer_store_dwordx2 v[108:109], v96, s[12:15], s26 offen sc1
  s_branch kvdone_36
kv_k1_38:
  ds_read_b128 v[32:35], v100 offset:0
  ds_read_b64_tr_b16 v[48:49], v104 offset:0
  ds_read_b64_tr_b16 v[50:51], v104 offset:160
  ds_read_b128 v[36:39], v101 offset:0
  ds_read_b64_tr_b16 v[52:53], v104 offset:1280
  ds_read_b64_tr_b16 v[54:55], v104 offset:1440
  ds_read_b128 v[40:43], v102 offset:0
  ds_read_b64_tr_b16 v[56:57], v104 offset:2560
  ds_read_b64_tr_b16 v[58:59], v104 offset:2720
  ds_read_b128 v[44:47], v103 offset:0
  ds_read_b64_tr_b16 v[60:61], v104 offset:3840
  ds_read_b64_tr_b16 v[62:63], v104 offset:4000
  ds_read_b128 v[64:67], v100 offset:4096
  ds_read_b64_tr_b16 v[80:81], v104 offset:5120
  ds_read_b64_tr_b16 v[82:83], v104 offset:5280
  ds_read_b128 v[68:71], v101 offset:4096
  ds_read_b64_tr_b16 v[84:85], v104 offset:6400
  ds_read_b64_tr_b16 v[86:87], v104 offset:6560
  ds_read_b128 v[72:75], v102 offset:4096
  ds_read_b64_tr_b16 v[88:89], v104 offset:7680
  ds_read_b64_tr_b16 v[90:91], v104 offset:7840
  ds_read_b128 v[76:79], v103 offset:4096
  ds_read_b64_tr_b16 v[92:93], v104 offset:8960
  ds_read_b64_tr_b16 v[94:95], v104 offset:9120
  s_waitcnt lgkmcnt(15)
  v_mfma_f32_16x16x32_bf16 v[108:111], v[48:51], v[32:35], 0
  s_waitcnt lgkmcnt(15)
  v_mfma_f32_16x16x32_bf16 v[108:111], v[52:55], v[36:39], v[108:111]
  s_waitcnt lgkmcnt(15)
  v_mfma_f32_16x16x32_bf16 v[108:111], v[56:59], v[40:43], v[108:111]
  s_waitcnt lgkmcnt(12)
  v_mfma_f32_16x16x32_bf16 v[108:111], v[60:63], v[44:47], v[108:111]
  ds_read_b128 v[32:35], v100 offset:8192
  ds_read_b64_tr_b16 v[48:49], v104 offset:10240
  ds_read_b64_tr_b16 v[50:51], v104 offset:10400
  ds_read_b128 v[36:39], v101 offset:8192
  ds_read_b64_tr_b16 v[52:53], v104 offset:11520
  ds_read_b64_tr_b16 v[54:55], v104 offset:11680
  ds_read_b128 v[40:43], v102 offset:8192
  ds_read_b64_tr_b16 v[56:57], v104 offset:12800
  ds_read_b64_tr_b16 v[58:59], v104 offset:12960
  ds_read_b128 v[44:47], v103 offset:8192
  ds_read_b64_tr_b16 v[60:61], v104 offset:14080
  ds_read_b64_tr_b16 v[62:63], v104 offset:14240
  s_waitcnt lgkmcnt(15)
  v_mfma_f32_16x16x32_bf16 v[108:111], v[80:83], v[64:67], v[108:111]
  s_waitcnt lgkmcnt(15)
  v_mfma_f32_16x16x32_bf16 v[108:111], v[84:87], v[68:71], v[108:111]
  s_waitcnt lgkmcnt(15)
  v_mfma_f32_16x16x32_bf16 v[108:111], v[88:91], v[72:75], v[108:111]
  s_waitcnt lgkmcnt(12)
  v_mfma_f32_16x16x32_bf16 v[108:111], v[92:95], v[76:79], v[108:111]
  ds_read_b128 v[64:67], v100 offset:12288
  ds_read_b64_tr_b16 v[80:81], v104 offset:15360
  ds_read_b64_tr_b16 v[82:83], v104 offset:15520
  ds_read_b128 v[68:71], v101 offset:12288
  ds_read_b64_tr_b16 v[84:85], v104 offset:16640
  ds_read_b64_tr_b16 v[86:87], v104 offset:16800
  ds_read_b128 v[72:75], v102 offset:12288
  ds_read_b64_tr_b16 v[88:89], v104 offset:17920
  ds_read_b64_tr_b16 v[90:91], v104 offset:18080
  ds_read_b128 v[76:79], v103 offset:12288
  ds_read_b64_tr_b16 v[92:93], v104 offset:19200
  ds_read_b64_tr_b16 v[94:95], v104 offset:19360
  s_waitcnt lgkmcnt(15)
  v_mfma_f32_16x16x32_bf16 v[108:111], v[48:51], v[32:35], v[108:111]
  s_waitcnt lgkmcnt(15)
  v_mfma_f32_16x16x32_bf16 v[108:111], v[52:55], v[36:39], v[108:111]
  s_waitcnt lgkmcnt(15)
  v_mfma_f32_16x16x32_bf16 v[108:111], v[56:59], v[40:43], v[108:111]
  s_waitcnt lgkmcnt(12)
  v_mfma_f32_16x16x32_bf16 v[108:111], v[60:63], v[44:47], v[108:111]
  ds_read_b128 v[32:35], v100 offset:16384
  ds_read_b64_tr_b16 v[48:49], v104 offset:20480
  ds_read_b64_tr_b16 v[50:51], v104 offset:20640
  ds_read_b128 v[36:39], v101 offset:16384
  ds_read_b64_tr_b16 v[52:53], v104 offset:21760
  ds_read_b64_tr_b16 v[54:55], v104 offset:21920
  ds_read_b128 v[40:43], v102 offset:16384
  ds_read_b64_tr_b16 v[56:57], v104 offset:23040
  ds_read_b64_tr_b16 v[58:59], v104 offset:23200
  ds_read_b128 v[44:47], v103 offset:16384
  ds_read_b64_tr_b16 v[60:61], v104 offset:24320
  ds_read_b64_tr_b16 v[62:63], v104 offset:24480
  s_waitcnt lgkmcnt(15)
  v_mfma_f32_16x16x32_bf16 v[108:111], v[80:83], v[64:67], v[108:111]
  s_waitcnt lgkmcnt(15)
  v_mfma_f32_16x16x32_bf16 v[108:111], v[84:87], v[68:71], v[108:111]
  s_waitcnt lgkmcnt(15)
  v_mfma_f32_16x16x32_bf16 v[108:111], v[88:91], v[72:75], v[108:111]
  s_waitcnt lgkmcnt(12)
  v_mfma_f32_16x16x32_bf16 v[108:111], v[92:95], v[76:79], v[108:111]
  s_waitcnt lgkmcnt(9)
  v_mfma_f32_16x16x32_bf16 v[108:111], v[48:51], v[32:35], v[108:111]
  s_waitcnt lgkmcnt(6)
  v_mfma_f32_16x16x32_bf16 v[108:111], v[52:55], v[36:39], v[108:111]
  s_waitcnt lgkmcnt(3)
  v_mfma_f32_16x16x32_bf16 v[108:111], v[56:59], v[40:43], v[108:111]
  s_waitcnt lgkmcnt(0)
  v_mfma_f32_16x16x32_bf16 v[108:111], v[60:63], v[44:47], v[108:111]
  s_nop 7
  s_nop 1
  s_lshr_b32 s26, s29, 5
  s_mul_i32 s26, s26, 3072
  s_bfe_u32 s27, s29, 0x10004
  v_cvt_pk_bf16_f32 v108, v108, v109
  v_cvt_pk_bf16_f32 v109, v110, v111
  v_and_b32 v96, 15, v1
  v_bfe_u32 v97, v1, 4, 1
  v_lshrrev_b32 v98, 5, v1
  v_cmp_gt_u32 vcc, 16, v1
  s_nop 1
  v_cndmask_b32 v108, 0, v108, vcc
  v_cndmask_b32 v109, 0, v109, vcc
  v_lshlrev_b32 v97, 5, v97
  v_add_u32 v96, v96, v97
  s_lshl_b32 s27, s27, 4
  v_add_u32 v96, s27, v96
  v_lshlrev_b32 v96, 3, v96
  s_mov_b64 exec, 0xffffffff
  buffer_store_dwordx2 v[108:109], v96, s[12:15], s26 offen offset:1024 sc1
  s_mov_b64 exec, -1
  s_branch kvdone_36
kv_g_39:
  ds_read_b128 v[32:35], v100 offset:0
  ds_read_b128 v[48:51], v105 offset:0
  ds_read_b128 v[36:39], v101 offset:0
  ds_read_b128 v[52:55], v105 offset:64
  ds_read_b128 v[40:43], v102 offset:0
  ds_read_b128 v[56:59], v105 offset:128
  ds_read_b128 v[44:47], v103 offset:0
  ds_read_b128 v[60:63], v105 offset:192
  ds_read_b128 v[64:67], v100 offset:4096
  ds_read_b128 v[80:83], v105 offset:256
  ds_read_b128 v[68:71], v101 offset:4096
  ds_read_b128 v[84:87], v105 offset:320
  ds_read_b128 v[72:75], v102 offset:4096
  ds_read_b128 v[88:91], v105 offset:384
  ds_read_b128 v[76:79], v103 offset:4096
  ds_read_b128 v[92:95], v105 offset:448
  s_waitcnt lgkmcnt(14)
  v_mfma_f32_16x16x32_bf16 v[108:111], v[48:51], v[32:35], 0
  s_waitcnt lgkmcnt(12)
  v_mfma_f32_16x16x32_bf16 v[108:111], v[52:55], v[36:39], v[108:111]
  s_waitcnt lgkmcnt(10)
  v_mfma_f32_16x16x32_bf16 v[108:111], v[56:59], v[40:43], v[108:111]
  s_waitcnt lgkmcnt(8)
  v_mfma_f32_16x16x32_bf16 v[108:111], v[60:63], v[44:47], v[108:111]
  ds_read_b128 v[32:35], v100 offset:8192
  ds_read_b128 v[48:51], v105 offset:512
  ds_read_b128 v[36:39], v101 offset:8192
  ds_read_b128 v[52:55], v105 offset:576
  ds_read_b128 v[40:43], v102 offset:8192
  ds_read_b128 v[56:59], v105 offset:640
  ds_read_b128 v[44:47], v103 offset:8192
  ds_read_b128 v[60:63], v105 offset:704
  s_waitcnt lgkmcnt(14)
  v_mfma_f32_16x16x32_bf16 v[108:111], v[80:83], v[64:67], v[108:111]
  s_waitcnt lgkmcnt(12)
  v_mfma_f32_16x16x32_bf16 v[108:111], v[84:87], v[68:71], v[108:111]
  s_waitcnt lgkmcnt(10)
  v_mfma_f32_16x16x32_bf16 v[108:111], v[88:91], v[72:75], v[108:111]
  s_waitcnt lgkmcnt(8)
  v_mfma_f32_16x16x32_bf16 v[108:111], v[92:95], v[76:79], v[108:111]
  ds_read_b128 v[64:67], v100 offset:12288
  ds_read_b128 v[80:83], v105 offset:768
  ds_read_b128 v[68:71], v101 offset:12288
  ds_read_b128 v[84:87], v105 offset:832
  ds_read_b128 v[72:75], v102 offset:12288
  ds_read_b128 v[88:91], v105 offset:896
  ds_read_b128 v[76:79], v103 offset:12288
  ds_read_b128 v[92:95], v105 offset:960
  s_waitcnt lgkmcnt(14)
  v_mfma_f32_16x16x32_bf16 v[108:111], v[48:51], v[32:35], v[108:111]
  s_waitcnt lgkmcnt(12)
  v_mfma_f32_16x16x32_bf16 v[108:111], v[52:55], v[36:39], v[108:111]
  s_waitcnt lgkmcnt(10)
  v_mfma_f32_16x16x32_bf16 v[108:111], v[56:59], v[40:43], v[108:111]
  s_waitcnt lgkmcnt(8)
  v_mfma_f32_16x16x32_bf16 v[108:111], v[60:63], v[44:47], v[108:111]
  ds_read_b128 v[32:35], v100 offset:16384
  ds_read_b128 v[48:51], v105 offset:1024
  ds_read_b128 v[36:39], v101 offset:16384
  ds_read_b128 v[52:55], v105 offset:1088
  ds_read_b128 v[40:43], v102 offset:16384
  ds_read_b128 v[56:59], v105 offset:1152
  ds_read_b128 v[44:47], v103 offset:16384
  ds_read_b128 v[60:63], v105 offset:1216
  s_waitcnt lgkmcnt(14)
  v_mfma_f32_16x16x32_bf16 v[108:111], v[80:83], v[64:67], v[108:111]
  s_waitcnt lgkmcnt(12)
  v_mfma_f32_16x16x32_bf16 v[108:111], v[84:87], v[68:71], v[108:111]
  s_waitcnt lgkmcnt(10)
  v_mfma_f32_16x16x32_bf16 v[108:111], v[88:91], v[72:75], v[108:111]
  s_waitcnt lgkmcnt(8)
  v_mfma_f32_16x16x32_bf16 v[108:111], v[92:95], v[76:79], v[108:111]
  s_waitcnt lgkmcnt(6)
  v_mfma_f32_16x16x32_bf16 v[108:111], v[48:51], v[32:35], v[108:111]
  s_waitcnt lgkmcnt(4)
  v_mfma_f32_16x16x32_bf16 v[108:111], v[52:55], v[36:39], v[108:111]
  s_waitcnt lgkmcnt(2)
  v_mfma_f32_16x16x32_bf16 v[108:111], v[56:59], v[40:43], v[108:111]
  s_waitcnt lgkmcnt(0)
  v_mfma_f32_16x16x32_bf16 v[108:111], v[60:63], v[44:47], v[108:111]
  s_nop 7
  s_nop 1
  s_mov_b32 s26, 0xbfb8aa3b
  v_mul_f32 v108, s26, v108
  v_exp_f32 v108, v108
  s_nop 0
  v_add_f32 v108, 1.0, v108
  v_rcp_f32 v108, v108
  v_and_b32 v96, 15, v1
  v_add_u32 v96, s29, v96
  v_lshlrev_b32 v96, 2, v96
  s_mov_b32 s26, 196608
  s_mov_b64 exec, 0xffff
  buffer_store_dword v108, v96, s[12:15], s26 offen sc1
  s_mov_b64 exec, -1
  s_branch kvdone_36
kv_v0_40:
  ds_read_b128 v[32:35], v100 offset:0
  ds_read_b64_tr_b16 v[48:49], v104 offset:0
  ds_read_b64_tr_b16 v[50:51], v104 offset:160
  ds_read_b128 v[36:39], v101 offset:0
  ds_read_b64_tr_b16 v[52:53], v104 offset:1280
  ds_read_b64_tr_b16 v[54:55], v104 offset:1440
  ds_read_b128 v[40:43], v102 offset:0
  ds_read_b64_tr_b16 v[56:57], v104 offset:2560
  ds_read_b64_tr_b16 v[58:59], v104 offset:2720
  ds_read_b128 v[44:47], v103 offset:0
  ds_read_b64_tr_b16 v[60:61], v104 offset:3840
  ds_read_b64_tr_b16 v[62:63], v104 offset:4000
  ds_read_b128 v[64:67], v100 offset:4096
  ds_read_b64_tr_b16 v[80:81], v104 offset:5120
  ds_read_b64_tr_b16 v[82:83], v104 offset:5280
  ds_read_b128 v[68:71], v101 offset:4096
  ds_read_b64_tr_b16 v[84:85], v104 offset:6400
  ds_read_b64_tr_b16 v[86:87], v104 offset:6560
  ds_read_b128 v[72:75], v102 offset:4096
  ds_read_b64_tr_b16 v[88:89], v104 offset:7680
  ds_read_b64_tr_b16 v[90:91], v104 offset:7840
  ds_read_b128 v[76:79], v103 offset:4096
  ds_read_b64_tr_b16 v[92:93], v104 offset:8960
  ds_read_b64_tr_b16 v[94:95], v104 offset:9120
  s_waitcnt lgkmcnt(15)
  v_mfma_f32_16x16x32_bf16 v[108:111], v[32:35], v[48:51], 0
  s_waitcnt lgkmcnt(15)
  v_mfma_f32_16x16x32_bf16 v[108:111], v[36:39], v[52:55], v[108:111]
  s_waitcnt lgkmcnt(15)
  v_mfma_f32_16x16x32_bf16 v[108:111], v[40:43], v[56:59], v[108:111]
  s_waitcnt lgkmcnt(12)
  v_mfma_f32_16x16x32_bf16 v[108:111], v[44:47], v[60:63], v[108:111]
  ds_read_b128 v[32:35], v100 offset:8192
  ds_read_b64_tr_b16 v[48:49], v104 offset:10240
  ds_read_b64_tr_b16 v[50:51], v104 offset:10400
  ds_read_b128 v[36:39], v101 offset:8192
  ds_read_b64_tr_b16 v[52:53], v104 offset:11520
  ds_read_b64_tr_b16 v[54:55], v104 offset:11680
  ds_read_b128 v[40:43], v102 offset:8192
  ds_read_b64_tr_b16 v[56:57], v104 offset:12800
  ds_read_b64_tr_b16 v[58:59], v104 offset:12960
  ds_read_b128 v[44:47], v103 offset:8192
  ds_read_b64_tr_b16 v[60:61], v104 offset:14080
  ds_read_b64_tr_b16 v[62:63], v104 offset:14240
  s_waitcnt lgkmcnt(15)
  v_mfma_f32_16x16x32_bf16 v[108:111], v[64:67], v[80:83], v[108:111]
  s_waitcnt lgkmcnt(15)
  v_mfma_f32_16x16x32_bf16 v[108:111], v[68:71], v[84:87], v[108:111]
  s_waitcnt lgkmcnt(15)
  v_mfma_f32_16x16x32_bf16 v[108:111], v[72:75], v[88:91], v[108:111]
  s_waitcnt lgkmcnt(12)
  v_mfma_f32_16x16x32_bf16 v[108:111], v[76:79], v[92:95], v[108:111]
  ds_read_b128 v[64:67], v100 offset:12288
  ds_read_b64_tr_b16 v[80:81], v104 offset:15360
  ds_read_b64_tr_b16 v[82:83], v104 offset:15520
  ds_read_b128 v[68:71], v101 offset:12288
  ds_read_b64_tr_b16 v[84:85], v104 offset:16640
  ds_read_b64_tr_b16 v[86:87], v104 offset:16800
  ds_read_b128 v[72:75], v102 offset:12288
  ds_read_b64_tr_b16 v[88:89], v104 offset:17920
  ds_read_b64_tr_b16 v[90:91], v104 offset:18080
  ds_read_b128 v[76:79], v103 offset:12288
  ds_read_b64_tr_b16 v[92:93], v104 offset:19200
  ds_read_b64_tr_b16 v[94:95], v104 offset:19360
  s_waitcnt lgkmcnt(15)
  v_mfma_f32_16x16x32_bf16 v[108:111], v[32:35], v[48:51], v[108:111]
  s_waitcnt lgkmcnt(15)
  v_mfma_f32_16x16x32_bf16 v[108:111], v[36:39], v[52:55], v[108:111]
  s_waitcnt lgkmcnt(15)
  v_mfma_f32_16x16x32_bf16 v[108:111], v[40:43], v[56:59], v[108:111]
  s_waitcnt lgkmcnt(12)
  v_mfma_f32_16x16x32_bf16 v[108:111], v[44:47], v[60:63], v[108:111]
  ds_read_b128 v[32:35], v100 offset:16384
  ds_read_b64_tr_b16 v[48:49], v104 offset:20480
  ds_read_b64_tr_b16 v[50:51], v104 offset:20640
  ds_read_b128 v[36:39], v101 offset:16384
  ds_read_b64_tr_b16 v[52:53], v104 offset:21760
  ds_read_b64_tr_b16 v[54:55], v104 offset:21920
  ds_read_b128 v[40:43], v102 offset:16384
  ds_read_b64_tr_b16 v[56:57], v104 offset:23040
  ds_read_b64_tr_b16 v[58:59], v104 offset:23200
  ds_read_b128 v[44:47], v103 offset:16384
  ds_read_b64_tr_b16 v[60:61], v104 offset:24320
  ds_read_b64_tr_b16 v[62:63], v104 offset:24480
  s_waitcnt lgkmcnt(15)
  v_mfma_f32_16x16x32_bf16 v[108:111], v[64:67], v[80:83], v[108:111]
  s_waitcnt lgkmcnt(15)
  v_mfma_f32_16x16x32_bf16 v[108:111], v[68:71], v[84:87], v[108:111]
  s_waitcnt lgkmcnt(15)
  v_mfma_f32_16x16x32_bf16 v[108:111], v[72:75], v[88:91], v[108:111]
  s_waitcnt lgkmcnt(12)
  v_mfma_f32_16x16x32_bf16 v[108:111], v[76:79], v[92:95], v[108:111]
  s_waitcnt lgkmcnt(9)
  v_mfma_f32_16x16x32_bf16 v[108:111], v[32:35], v[48:51], v[108:111]
  s_waitcnt lgkmcnt(6)
  v_mfma_f32_16x16x32_bf16 v[108:111], v[36:39], v[52:55], v[108:111]
  s_waitcnt lgkmcnt(3)
  v_mfma_f32_16x16x32_bf16 v[108:111], v[40:43], v[56:59], v[108:111]
  s_waitcnt lgkmcnt(0)
  v_mfma_f32_16x16x32_bf16 v[108:111], v[44:47], v[60:63], v[108:111]
  s_nop 7
  s_nop 1
  s_lshr_b32 s26, s29, 5
  s_mul_i32 s26, s26, 3072
  s_bfe_u32 s27, s29, 0x10004
  v_cvt_pk_bf16_f32 v108, v108, v109
  v_cvt_pk_bf16_f32 v109, v110, v111
  v_and_b32 v96, 15, v1
  v_bfe_u32 v97, v1, 4, 1
  v_lshrrev_b32 v98, 5, v1
  v_mul_u32_u24 v97, 384, v97
  v_lshlrev_b32 v99, 4, v96
  v_add_u32 v97, v97, v99
  v_lshlrev_b32 v98, 3, v98
  v_add_u32 v97, v97, v98
  s_mul_i32 s27, s27, 768
  s_add_u32 s26, s26, s27
  buffer_store_dwordx2 v[108:109], v97, s[12:15], s26 offen offset:1536 sc1
  s_branch kvdone_36
kv_v1_41:
  ds_read_b128 v[32:35], v100 offset:0
  ds_read_b64_tr_b16 v[48:49], v104 offset:0
  ds_read_b64_tr_b16 v[50:51], v104 offset:160
  ds_read_b128 v[36:39], v101 offset:0
  ds_read_b64_tr_b16 v[52:53], v104 offset:1280
  ds_read_b64_tr_b16 v[54:55], v104 offset:1440
  ds_read_b128 v[40:43], v102 offset:0
  ds_read_b64_tr_b16 v[56:57], v104 offset:2560
  ds_read_b64_tr_b16 v[58:59], v104 offset:2720
  ds_read_b128 v[44:47], v103 offset:0
  ds_read_b64_tr_b16 v[60:61], v104 offset:3840
  ds_read_b64_tr_b16 v[62:63], v104 offset:4000
  ds_read_b128 v[64:67], v100 offset:4096
  ds_read_b64_tr_b16 v[80:81], v104 offset:5120
  ds_read_b64_tr_b16 v[82:83], v104 offset:5280
  ds_read_b128 v[68:71], v101 offset:4096
  ds_read_b64_tr_b16 v[84:85], v104 offset:6400
  ds_read_b64_tr_b16 v[86:87], v104 offset:6560
  ds_read_b128 v[72:75], v102 offset:4096
  ds_read_b64_tr_b16 v[88:89], v104 offset:7680
  ds_read_b64_tr_b16 v[90:91], v104 offset:7840
  ds_read_b128 v[76:79], v103 offset:4096
  ds_read_b64_tr_b16 v[92:93], v104 offset:8960
  ds_read_b64_tr_b16 v[94:95], v104 offset:9120
  s_waitcnt lgkmcnt(15)
  v_mfma_f32_16x16x32_bf16 v[108:111], v[32:35], v[48:51], 0
  s_waitcnt lgkmcnt(15)
  v_mfma_f32_16x16x32_bf16 v[108:111], v[36:39], v[52:55], v[108:111]
  s_waitcnt lgkmcnt(15)
  v_mfma_f32_16x16x32_bf16 v[108:111], v[40:43], v[56:59], v[108:111]
  s_waitcnt lgkmcnt(12)
  v_mfma_f32_16x16x32_bf16 v[108:111], v[44:47], v[60:63], v[108:111]
  ds_read_b128 v[32:35], v100 offset:8192
  ds_read_b64_tr_b16 v[48:49], v104 offset:10240
  ds_read_b64_tr_b16 v[50:51], v104 offset:10400
  ds_read_b128 v[36:39], v101 offset:8192
  ds_read_b64_tr_b16 v[52:53], v104 offset:11520
  ds_read_b64_tr_b16 v[54:55], v104 offset:11680
  ds_read_b128 v[40:43], v102 offset:8192
  ds_read_b64_tr_b16 v[56:57], v104 offset:12800
  ds_read_b64_tr_b16 v[58:59], v104 offset:12960
  ds_read_b128 v[44:47], v103 offset:8192
  ds_read_b64_tr_b16 v[60:61], v104 offset:14080
  ds_read_b64_tr_b16 v[62:63], v104 offset:14240
  s_waitcnt lgkmcnt(15)
  v_mfma_f32_16x16x32_bf16 v[108:111], v[64:67], v[80:83], v[108:111]
  s_waitcnt lgkmcnt(15)
  v_mfma_f32_16x16x32_bf16 v[108:111], v[68:71], v[84:87], v[108:111]
  s_waitcnt lgkmcnt(15)
  v_mfma_f32_16x16x32_bf16 v[108:111], v[72:75], v[88:91], v[108:111]
  s_waitcnt lgkmcnt(12)
  v_mfma_f32_16x16x32_bf16 v[108:111], v[76:79], v[92:95], v[108:111]
  ds_read_b128 v[64:67], v100 offset:12288
  ds_read_b64_tr_b16 v[80:81], v104 offset:15360
  ds_read_b64_tr_b16 v[82:83], v104 offset:15520
  ds_read_b128 v[68:71], v101 offset:12288
  ds_read_b64_tr_b16 v[84:85], v104 offset:16640
  ds_read_b64_tr_b16 v[86:87], v104 offset:16800
  ds_read_b128 v[72:75], v102 offset:12288
  ds_read_b64_tr_b16 v[88:89], v104 offset:17920
  ds_read_b64_tr_b16 v[90:91], v104 offset:18080
  ds_read_b128 v[76:79], v103 offset:12288
  ds_read_b64_tr_b16 v[92:93], v104 offset:19200
  ds_read_b64_tr_b16 v[94:95], v104 offset:19360
  s_waitcnt lgkmcnt(15)
  v_mfma_f32_16x16x32_bf16 v[108:111], v[32:35], v[48:51], v[108:111]
  s_waitcnt lgkmcnt(15)
  v_mfma_f32_16x16x32_bf16 v[108:111], v[36:39], v[52:55], v[108:111]
  s_waitcnt lgkmcnt(15)
  v_mfma_f32_16x16x32_bf16 v[108:111], v[40:43], v[56:59], v[108:111]
  s_waitcnt lgkmcnt(12)
  v_mfma_f32_16x16x32_bf16 v[108:111], v[44:47], v[60:63], v[108:111]
  ds_read_b128 v[32:35], v100 offset:16384
  ds_read_b64_tr_b16 v[48:49], v104 offset:20480
  ds_read_b64_tr_b16 v[50:51], v104 offset:20640
  ds_read_b128 v[36:39], v101 offset:16384
  ds_read_b64_tr_b16 v[52:53], v104 offset:21760
  ds_read_b64_tr_b16 v[54:55], v104 offset:21920
  ds_read_b128 v[40:43], v102 offset:16384
  ds_read_b64_tr_b16 v[56:57], v104 offset:23040
  ds_read_b64_tr_b16 v[58:59], v104 offset:23200
  ds_read_b128 v[44:47], v103 offset:16384
  ds_read_b64_tr_b16 v[60:61], v104 offset:24320
  ds_read_b64_tr_b16 v[62:63], v104 offset:24480
  s_waitcnt lgkmcnt(15)
  v_mfma_f32_16x16x32_bf16 v[108:111], v[64:67], v[80:83], v[108:111]
  s_waitcnt lgkmcnt(15)
  v_mfma_f32_16x16x32_bf16 v[108:111], v[68:71], v[84:87], v[108:111]
  s_waitcnt lgkmcnt(15)
  v_mfma_f32_16x16x32_bf16 v[108:111], v[72:75], v[88:91], v[108:111]
  s_waitcnt lgkmcnt(12)
  v_mfma_f32_16x16x32_bf16 v[108:111], v[76:79], v[92:95], v[108:111]
  s_waitcnt lgkmcnt(9)
  v_mfma_f32_16x16x32_bf16 v[108:111], v[32:35], v[48:51], v[108:111]
  s_waitcnt lgkmcnt(6)
  v_mfma_f32_16x16x32_bf16 v[108:111], v[36:39], v[52:55], v[108:111]
  s_waitcnt lgkmcnt(3)
  v_mfma_f32_16x16x32_bf16 v[108:111], v[40:43], v[56:59], v[108:111]
  s_waitcnt lgkmcnt(0)
  v_mfma_f32_16x16x32_bf16 v[108:111], v[44:47], v[60:63], v[108:111]
  s_nop 7
  s_nop 1
  s_lshr_b32 s26, s29, 5
  s_mul_i32 s26, s26, 3072
  s_bfe_u32 s27, s29, 0x10004
  v_cvt_pk_bf16_f32 v108, v108, v109
  v_cvt_pk_bf16_f32 v109, v110, v111
  v_and_b32 v96, 15, v1
  v_bfe_u32 v97, v1, 4, 1
  v_lshrrev_b32 v98, 5, v1
  v_cmp_gt_u32 vcc, 4, v96
  s_nop 1
  v_cndmask_b32 v108, 0, v108, vcc
  v_cndmask_b32 v109, 0, v109, vcc
  v_mov_b32 v99, 0x3f803f80
  v_cmp_eq_u32 vcc, 4, v96
  s_nop 1
  v_cndmask_b32 v108, v108, v99, vcc
  v_cndmask_b32 v109, v109, v99, vcc
  v_mul_u32_u24 v97, 384, v97
  v_lshlrev_b32 v99, 4, v96
  v_add_u32 v97, v97, v99
  v_lshlrev_b32 v98, 3, v98
  v_add_u32 v97, v97, v98
  s_mul_i32 s27, s27, 768
  s_add_u32 s26, s26, s27
  v_cmp_gt_u32 vcc, 8, v96
  s_and_saveexec_b64 s[46:47], vcc
  buffer_store_dwordx2 v[108:109], v97, s[12:15], s26 offen offset:1792 sc1
  s_mov_b64 exec, -1
kvdone_36:
  s_cmp_lg_u32 s20, 7
  s_cbranch_scc1 nn_42
  v_mov_b32 v124, 0
  s_mov_b32 s29, 0
ng_43:
  global_load_dword v125, v124, s[52:53] sc1
  s_waitcnt vmcnt(0)
  v_readfirstlane_b32 s57, v125
  s_add_u32 s29, s29, 1
  s_cmp_ge_u32 s29, 200000
  s_cbranch_scc1 ngd_44
  s_cmp_eq_u32 s57, 0
  s_cbranch_scc1 ng_43
ngd_44:
nn_42:
  s_barrier
  s_add_u32 m0, s35, 18432
  s_movk_i32 s33, 128
  buffer_load_dwordx4 v117, s[4:7], s33 offen lds
  s_add_u32 m0, s35, 26624
  s_mov_b32 s33, 81920
  buffer_load_dwordx4 v118, s[8:11], s33 offen lds
  s_add_u32 m0, s35, 34816
  s_nop 0
  buffer_load_dwordx4 v119, s[8:11], s33 offen lds
  s_add_u32 m0, s35, 36864
  s_movk_i32 s33, 256
  buffer_load_dwordx4 v117, s[4:7], s33 offen lds
  s_add_u32 m0, s35, 45056
  s_mov_b32 s33, 163840
  buffer_load_dwordx4 v118, s[8:11], s33 offen lds
  s_add_u32 m0, s35, 53248
  s_nop 0
  buffer_load_dwordx4 v119, s[8:11], s33 offen lds
  s_add_u32 m0, s35, 55296
  s_movk_i32 s33, 384
  buffer_load_dwordx4 v117, s[4:7], s33 offen lds
  s_add_u32 m0, s35, 63488
  s_mov_b32 s33, 245760
  buffer_load_dwordx4 v118, s[8:11], s33 offen lds
  s_add_u32 m0, s35, 71680
  s_nop 0
  buffer_load_dwordx4 v119, s[8:11], s33 offen lds
  s_waitcnt vmcnt(9)
  s_waitcnt vmcnt(9)
  s_barrier
  s_cmp_lg_u32 s20, 7
  s_cbranch_scc1 kvf_45
  s_lshl_b32 s26, s2, 3
  s_add_u32 s26, s26, 4128768
  v_mov_b32 v124, 0
  v_mov_b32 v125, s57
  s_mov_b64 exec, 1
  buffer_store_dword v125, v124, s[12:15], s26 offen sc1
  s_mov_b64 exec, -1
kvf_45:
  ds_read_b128 v[32:35], v112 offset:0
  ds_read_b64_tr_b16 v[48:49], v116 offset:0
  ds_read_b64_tr_b16 v[50:51], v116 offset:640
  ds_read_b128 v[36:39], v113 offset:0
  ds_read_b64_tr_b16 v[52:53], v116 offset:2560
  ds_read_b64_tr_b16 v[54:55], v116 offset:3200
  ds_read_b128 v[40:43], v114 offset:0
  ds_read_b64_tr_b16 v[56:57], v116 offset:5120
  ds_read_b64_tr_b16 v[58:59], v116 offset:5760
  ds_read_b128 v[44:47], v115 offset:0
  ds_read_b64_tr_b16 v[60:61], v116 offset:7680
  ds_read_b64_tr_b16 v[62:63], v116 offset:8320
  s_waitcnt vmcnt(6) lgkmcnt(0)
  s_barrier
  s_add_u32 m0, s35, 0
  s_movk_i32 s33, 512
  buffer_load_dwordx4 v117, s[4:7], s33 offen lds
  s_add_u32 m0, s35, 8192
  s_mov_b32 s33, 327680
  buffer_load_dwordx4 v118, s[8:11], s33 offen lds
  s_add_u32 m0, s35, 16384
  s_nop 0
  buffer_load_dwordx4 v119, s[8:11], s33 offen lds
  ds_read_b128 v[80:83], v112 offset:18432
  ds_read_b64_tr_b16 v[96:97], v116 offset:18432
  ds_read_b64_tr_b16 v[98:99], v116 offset:19072
  ds_read_b128 v[84:87], v113 offset:18432
  ds_read_b64_tr_b16 v[100:101], v116 offset:20992
  ds_read_b64_tr_b16 v[102:103], v116 offset:21632
  ds_read_b128 v[88:91], v114 offset:18432
  ds_read_b64_tr_b16 v[104:105], v116 offset:23552
  ds_read_b64_tr_b16 v[106:107], v116 offset:24192
  ds_read_b128 v[92:95], v115 offset:18432
  ds_read_b64_tr_b16 v[108:109], v116 offset:26112
  ds_read_b64_tr_b16 v[110:111], v116 offset:26752
  s_waitcnt lgkmcnt(15)
  v_mfma_f32_32x32x16_bf16 v[64:79], v[48:51], v[32:35], 0
  s_waitcnt lgkmcnt(15)
  v_mfma_f32_32x32x16_bf16 v[64:79], v[52:55], v[36:39], v[64:79]
  s_waitcnt lgkmcnt(15)
  v_mfma_f32_32x32x16_bf16 v[64:79], v[56:59], v[40:43], v[64:79]
  s_waitcnt lgkmcnt(12)
  v_mfma_f32_32x32x16_bf16 v[64:79], v[60:63], v[44:47], v[64:79]
  s_waitcnt vmcnt(6) lgkmcnt(0)
  s_barrier
  s_add_u32 m0, s35, 18432
  s_movk_i32 s33, 640
  buffer_load_dwordx4 v117, s[4:7], s33 offen lds
  s_add_u32 m0, s35, 26624
  s_mov_b32 s33, 409600
  buffer_load_dwordx4 v118, s[8:11], s33 offen lds
  s_add_u32 m0, s35, 34816
  s_nop 0
  buffer_load_dwordx4 v119, s[8:11], s33 offen lds
  ds_read_b128 v[32:35], v112 offset:36864
  ds_read_b64_tr_b16 v[48:49], v116 offset:36864
  ds_read_b64_tr_b16 v[50:51], v116 offset:37504
  ds_read_b128 v[36:39], v113 offset:36864
  ds_read_b64_tr_b16 v[52:53], v116 offset:39424
  ds_read_b64_tr_b16 v[54:55], v116 offset:40064
  ds_read_b128 v[40:43], v114 offset:36864
  ds_read_b64_tr_b16 v[56:57], v116 offset:41984
  ds_read_b64_tr_b16 v[58:59], v116 offset:42624
  ds_read_b128 v[44:47], v115 offset:36864
  ds_read_b64_tr_b16 v[60:61], v116 offset:44544
  ds_read_b64_tr_b16 v[62:63], v116 offset:45184
  s_waitcnt lgkmcnt(15)
  v_mfma_f32_32x32x16_bf16 v[64:79], v[96:99], v[80:83], v[64:79]
  s_waitcnt lgkmcnt(15)
  v_mfma_f32_32x32x16_bf16 v[64:79], v[100:103], v[84:87], v[64:79]
  s_waitcnt lgkmcnt(15)
  v_mfma_f32_32x32x16_bf16 v[64:79], v[104:107], v[88:91], v[64:79]
  s_waitcnt lgkmcnt(12)
  v_mfma_f32_32x32x16_bf16 v[64:79], v[108:111], v[92:95], v[64:79]
  s_waitcnt vmcnt(6) lgkmcnt(0)
  s_barrier
  s_add_u32 m0, s35, 36864
  s_movk_i32 s33, 768
  buffer_load_dwordx4 v117, s[4:7], s33 offen lds
  s_add_u32 m0, s35, 45056
  s_mov_b32 s33, 491520
  buffer_load_dwordx4 v118, s[8:11], s33 offen lds
  s_add_u32 m0, s35, 53248
  s_nop 0
  buffer_load_dwordx4 v119, s[8:11], s33 offen lds
  ds_read_b128 v[80:83], v112 offset:55296
  ds_read_b64_tr_b16 v[96:97], v116 offset:55296
  ds_read_b64_tr_b16 v[98:99], v116 offset:55936
  ds_read_b128 v[84:87], v113 offset:55296
  ds_read_b64_tr_b16 v[100:101], v116 offset:57856
  ds_read_b64_tr_b16 v[102:103], v116 offset:58496
  ds_read_b128 v[88:91], v114 offset:55296
  ds_read_b64_tr_b16 v[104:105], v116 offset:60416
  ds_read_b64_tr_b16 v[106:107], v116 offset:61056
  ds_read_b128 v[92:95], v115 offset:55296
  ds_read_b64_tr_b16 v[108:109], v116 offset:62976
  ds_read_b64_tr_b16 v[110:111], v116 offset:63616
  s_waitcnt lgkmcnt(15)
  v_mfma_f32_32x32x16_bf16 v[64:79], v[48:51], v[32:35], v[64:79]
  s_waitcnt lgkmcnt(15)
  v_mfma_f32_32x32x16_bf16 v[64:79], v[52:55], v[36:39], v[64:79]
  s_waitcnt lgkmcnt(15)
  v_mfma_f32_32x32x16_bf16 v[64:79], v[56:59], v[40:43], v[64:79]
  s_waitcnt lgkmcnt(12)
  v_mfma_f32_32x32x16_bf16 v[64:79], v[60:63], v[44:47], v[64:79]
  s_waitcnt vmcnt(6) lgkmcnt(0)
  s_barrier
  s_add_u32 m0, s35, 55296
  s_movk_i32 s33, 896
  buffer_load_dwordx4 v117, s[4:7], s33 offen lds
  s_add_u32 m0, s35, 63488
  s_mov_b32 s33, 573440
  buffer_load_dwordx4 v118, s[8:11], s33 offen lds
  s_add_u32 m0, s35, 71680
  s_nop 0
  buffer_load_dwordx4 v119, s[8:11], s33 offen lds
  ds_read_b128 v[32:35], v112 offset:0
  ds_read_b64_tr_b16 v[48:49], v116 offset:0
  ds_read_b64_tr_b16 v[50:51], v116 offset:640
  ds_read_b128 v[36:39], v113 offset:0
  ds_read_b64_tr_b16 v[52:53], v116 offset:2560
  ds_read_b64_tr_b16 v[54:55], v116 offset:3200
  ds_read_b128 v[40:43], v114 offset:0
  ds_read_b64_tr_b16 v[56:57], v116 offset:5120
  ds_read_b64_tr_b16 v[58:59], v116 offset:5760
  ds_read_b128 v[44:47], v115 offset:0
  ds_read_b64_tr_b16 v[60:61], v116 offset:7680
  ds_read_b64_tr_b16 v[62:63], v116 offset:8320
  s_waitcnt lgkmcnt(15)
  v_mfma_f32_32x32x16_bf16 v[64:79], v[96:99], v[80:83], v[64:79]
  s_waitcnt lgkmcnt(15)
  v_mfma_f32_32x32x16_bf16 v[64:79], v[100:103], v[84:87], v[64:79]
  s_waitcnt lgkmcnt(15)
  v_mfma_f32_32x32x16_bf16 v[64:79], v[104:107], v[88:91], v[64:79]
  s_waitcnt lgkmcnt(12)
  v_mfma_f32_32x32x16_bf16 v[64:79], v[108:111], v[92:95], v[64:79]
  s_waitcnt vmcnt(6) lgkmcnt(0)
  s_barrier
  s_add_u32 m0, s35, 0
  s_movk_i32 s33, 1024
  buffer_load_dwordx4 v117, s[4:7], s33 offen lds
  s_add_u32 m0, s35, 8192
  s_mov_b32 s33, 655360
  buffer_load_dwordx4 v118, s[8:11], s33 offen lds
  s_add_u32 m0, s35, 16384
  s_nop 0
  buffer_load_dwordx4 v119, s[8:11], s33 offen lds
  ds_read_b128 v[80:83], v112 offset:18432
  ds_read_b64_tr_b16 v[96:97], v116 offset:18432
  ds_read_b64_tr_b16 v[98:99], v116 offset:19072
  ds_read_b128 v[84:87], v113 offset:18432
  ds_read_b64_tr_b16 v[100:101], v116 offset:20992
  ds_read_b64_tr_b16 v[102:103], v116 offset:21632
  ds_read_b128 v[88:91], v114 offset:18432
  ds_read_b64_tr_b16 v[104:105], v116 offset:23552
  ds_read_b64_tr_b16 v[106:107], v116 offset:24192
  ds_read_b128 v[92:95], v115 offset:18432
  ds_read_b64_tr_b16 v[108:109], v116 offset:26112
  ds_read_b64_tr_b16 v[110:111], v116 offset:26752
  s_waitcnt lgkmcnt(15)
  v_mfma_f32_32x32x16_bf16 v[64:79], v[48:51], v[32:35], v[64:79]
  s_waitcnt lgkmcnt(15)
  v_mfma_f32_32x32x16_bf16 v[64:79], v[52:55], v[36:39], v[64:79]
  s_waitcnt lgkmcnt(15)
  v_mfma_f32_32x32x16_bf16 v[64:79], v[56:59], v[40:43], v[64:79]
  s_waitcnt lgkmcnt(12)
  v_mfma_f32_32x32x16_bf16 v[64:79], v[60:63], v[44:47], v[64:79]
  s_waitcnt vmcnt(6) lgkmcnt(0)
  s_barrier
  s_add_u32 m0, s35, 18432
  s_movk_i32 s33, 1152
  buffer_load_dwordx4 v117, s[4:7], s33 offen lds
  s_add_u32 m0, s35, 26624
  s_mov_b32 s33, 737280
  buffer_load_dwordx4 v118, s[8:11], s33 offen lds
  s_add_u32 m0, s35, 34816
  s_nop 0
  buffer_load_dwordx4 v119, s[8:11], s33 offen lds
  ds_read_b128 v[32:35], v112 offset:36864
  ds_read_b64_tr_b16 v[48:49], v116 offset:36864
  ds_read_b64_tr_b16 v[50:51], v116 offset:37504
  ds_read_b128 v[36:39], v113 offset:36864
  ds_read_b64_tr_b16 v[52:53], v116 offset:39424
  ds_read_b64_tr_b16 v[54:55], v116 offset:40064
  ds_read_b128 v[40:43], v114 offset:36864
  ds_read_b64_tr_b16 v[56:57], v116 offset:41984
  ds_read_b64_tr_b16 v[58:59], v116 offset:42624
  ds_read_b128 v[44:47], v115 offset:36864
  ds_read_b64_tr_b16 v[60:61], v116 offset:44544
  ds_read_b64_tr_b16 v[62:63], v116 offset:45184
  s_waitcnt lgkmcnt(15)
  v_mfma_f32_32x32x16_bf16 v[64:79], v[96:99], v[80:83], v[64:79]
  s_waitcnt lgkmcnt(15)
  v_mfma_f32_32x32x16_bf16 v[64:79], v[100:103], v[84:87], v[64:79]
  s_waitcnt lgkmcnt(15)
  v_mfma_f32_32x32x16_bf16 v[64:79], v[104:107], v[88:91], v[64:79]
  s_waitcnt lgkmcnt(12)
  v_mfma_f32_32x32x16_bf16 v[64:79], v[108:111], v[92:95], v[64:79]
  s_waitcnt vmcnt(6) lgkmcnt(0)
  s_barrier
  ds_read_b128 v[80:83], v112 offset:55296
  ds_read_b64_tr_b16 v[96:97], v116 offset:55296
  ds_read_b64_tr_b16 v[98:99], v116 offset:55936
  ds_read_b128 v[84:87], v113 offset:55296
  ds_read_b64_tr_b16 v[100:101], v116 offset:57856
  ds_read_b64_tr_b16 v[102:103], v116 offset:58496
  ds_read_b128 v[88:91], v114 offset:55296
  ds_read_b64_tr_b16 v[104:105], v116 offset:60416
  ds_read_b64_tr_b16 v[106:107], v116 offset:61056
  ds_read_b128 v[92:95], v115 offset:55296
  ds_read_b64_tr_b16 v[108:109], v116 offset:62976
  ds_read_b64_tr_b16 v[110:111], v116 offset:63616
  s_waitcnt lgkmcnt(15)
  v_mfma_f32_32x32x16_bf16 v[64:79], v[48:51], v[32:35], v[64:79]
  s_waitcnt lgkmcnt(15)
  v_mfma_f32_32x32x16_bf16 v[64:79], v[52:55], v[36:39], v[64:79]
  s_waitcnt lgkmcnt(15)
  v_mfma_f32_32x32x16_bf16 v[64:79], v[56:59], v[40:43], v[64:79]
  s_waitcnt lgkmcnt(12)
  v_mfma_f32_32x32x16_bf16 v[64:79], v[60:63], v[44:47], v[64:79]
  s_waitcnt vmcnt(3) lgkmcnt(0)
  s_barrier
  ds_read_b128 v[32:35], v112 offset:0
  ds_read_b64_tr_b16 v[48:49], v116 offset:0
  ds_read_b64_tr_b16 v[50:51], v116 offset:640
  ds_read_b128 v[36:39], v113 offset:0
  ds_read_b64_tr_b16 v[52:53], v116 offset:2560
  ds_read_b64_tr_b16 v[54:55], v116 offset:3200
  ds_read_b128 v[40:43], v114 offset:0
  ds_read_b64_tr_b16 v[56:57], v116 offset:5120
  ds_read_b64_tr_b16 v[58:59], v116 offset:5760
  ds_read_b128 v[44:47], v115 offset:0
  ds_read_b64_tr_b16 v[60:61], v116 offset:7680
  ds_read_b64_tr_b16 v[62:63], v116 offset:8320
  s_waitcnt lgkmcnt(15)
  v_mfma_f32_32x32x16_bf16 v[64:79], v[96:99], v[80:83], v[64:79]
  s_waitcnt lgkmcnt(15)
  v_mfma_f32_32x32x16_bf16 v[64:79], v[100:103], v[84:87], v[64:79]
  s_waitcnt lgkmcnt(15)
  v_mfma_f32_32x32x16_bf16 v[64:79], v[104:107], v[88:91], v[64:79]
  s_waitcnt lgkmcnt(12)
  v_mfma_f32_32x32x16_bf16 v[64:79], v[108:111], v[92:95], v[64:79]
  s_waitcnt vmcnt(0) lgkmcnt(0)
  s_barrier
  s_mul_i32 s32, s20, 3072
  s_add_u32 s32, s32, 49152
  s_mov_b32 s31, 0
  s_mov_b32 m0, s32
  s_nop 0
  buffer_load_dwordx4 v14, s[12:15], s31 offen offset:0 sc1 lds
  buffer_load_dwordx4 v14, s[12:15], s31 offen offset:1024 sc1 lds
  buffer_load_dwordx4 v14, s[12:15], s31 offen offset:2048 sc1 lds
  v_and_b32 v15, 31, v1
  s_lshl_b32 s26, s21, 6
  s_lshl_b32 s27, s23, 5
  s_add_u32 s26, s26, s27
  v_add_u32 v15, s26, v15
  v_lshlrev_b32 v15, 2, v15
  s_mov_b32 s28, 196608
  buffer_load_dword v10, v15, s[12:15], s28 offen sc1
  ds_read_b128 v[80:83], v112 offset:18432
  ds_read_b64_tr_b16 v[96:97], v116 offset:18432
  ds_read_b64_tr_b16 v[98:99], v116 offset:19072
  ds_read_b128 v[84:87], v113 offset:18432
  ds_read_b64_tr_b16 v[100:101], v116 offset:20992
  ds_read_b64_tr_b16 v[102:103], v116 offset:21632
  ds_read_b128 v[88:91], v114 offset:18432
  ds_read_b64_tr_b16 v[104:105], v116 offset:23552
  ds_read_b64_tr_b16 v[106:107], v116 offset:24192
  ds_read_b128 v[92:95], v115 offset:18432
  ds_read_b64_tr_b16 v[108:109], v116 offset:26112
  ds_read_b64_tr_b16 v[110:111], v116 offset:26752
  s_waitcnt lgkmcnt(15)
  v_mfma_f32_32x32x16_bf16 v[64:79], v[48:51], v[32:35], v[64:79]
  s_waitcnt lgkmcnt(15)
  v_mfma_f32_32x32x16_bf16 v[64:79], v[52:55], v[36:39], v[64:79]
  s_waitcnt lgkmcnt(15)
  v_mfma_f32_32x32x16_bf16 v[64:79], v[56:59], v[40:43], v[64:79]
  s_waitcnt lgkmcnt(12)
  v_mfma_f32_32x32x16_bf16 v[64:79], v[60:63], v[44:47], v[64:79]
  s_waitcnt lgkmcnt(9)
  v_mfma_f32_32x32x16_bf16 v[64:79], v[96:99], v[80:83], v[64:79]
  s_waitcnt lgkmcnt(6)
  v_mfma_f32_32x32x16_bf16 v[64:79], v[100:103], v[84:87], v[64:79]
  s_waitcnt lgkmcnt(3)
  v_mfma_f32_32x32x16_bf16 v[64:79], v[104:107], v[88:91], v[64:79]
  s_waitcnt lgkmcnt(0)
  v_mfma_f32_32x32x16_bf16 v[64:79], v[108:111], v[92:95], v[64:79]
qpend_5:
  s_nop 7
  s_nop 7
  s_mov_b32 s26, 0x3ea52b5c
  v_mul_f32 v64, s26, v64
  v_mul_f32 v65, s26, v65
  v_mul_f32 v66, s26, v66
  v_mul_f32 v67, s26, v67
  v_mul_f32 v68, s26, v68
  v_mul_f32 v69, s26, v69
  v_mul_f32 v70, s26, v70
  v_mul_f32 v71, s26, v71
  v_mul_f32 v72, s26, v72
  v_mul_f32 v73, s26, v73
  v_mul_f32 v74, s26, v74
  v_mul_f32 v75, s26, v75
  v_cvt_pk_bf16_f32 v4, v64, v65
  v_cvt_pk_bf16_f32 v5, v66, v67
  v_cvt_pk_bf16_f32 v6, v68, v69
  v_cvt_pk_bf16_f32 v7, v70, v71
  v_cvt_pk_bf16_f32 v8, v72, v73
  v_cvt_pk_bf16_f32 v9, v74, v75
  v_cmp_gt_u32 vcc, 32, v1
  s_nop 1
  v_cndmask_b32 v8, 0, v8, vcc
  v_cndmask_b32 v9, 0, v9, vcc
  s_setprio 0
  s_mul_i32 s32, s20, 3072
  v_mov_b32 v16, 0
  v_mov_b32 v17, 0
  v_mov_b32 v18, 0
  v_mov_b32 v19, 0
  v_mov_b32 v20, 0
  v_mov_b32 v21, 0
  v_mov_b32 v22, 0
  v_mov_b32 v23, 0
  v_mov_b32 v24, 0
  v_mov_b32 v25, 0
  v_mov_b32 v26, 0
  v_mov_b32 v27, 0
  v_mov_b32 v28, 0
  v_mov_b32 v29, 0
  v_mov_b32 v30, 0
  v_mov_b32 v31, 0
  v_mov_b32 v68, 0
  v_mov_b32 v69, 0
  v_mov_b32 v70, 0
  v_mov_b32 v71, 0
  v_mov_b32 v100, 0
  v_mov_b32 v101, 0
  v_mov_b32 v102, 0
  v_mov_b32 v103, 0
  s_mov_b32 s33, 24576
  s_waitcnt vmcnt(0)
  s_barrier
  s_mov_b32 m0, s32
  s_nop 0
  buffer_load_dwordx4 v14, s[12:15], s33 offen offset:0 sc1 lds
  buffer_load_dwordx4 v14, s[12:15], s33 offen offset:1024 sc1 lds
  buffer_load_dwordx4 v14, s[12:15], s33 offen offset:2048 sc1 lds
  s_add_u32 s32, s32, 24576
  s_add_u32 s33, s33, 24576
  ds_read_b128 v[72:75], v11
  ds_read_b64 v[76:77], v12
  ds_read_b128 v[80:83], v11 offset:3072
  ds_read_b64 v[84:85], v12 offset:3072
  ds_read_b128 v[88:91], v13
  ds_read_b128 v[92:95], v13 offset:768
  s_waitcnt lgkmcnt(4)
  v_mfma_f32_32x32x16_bf16 v[32:47], v[72:75], v[4:7], 0
  v_mfma_f32_32x32x8bf16_1k v[32:47], v[76:77], v[8:9], v[32:47]
  s_nop 7
  s_nop 7
  s_nop 3
  s_mov_b32 s30, 0
  s_mov_b32 s34, 0
attn_loop_46:
  s_waitcnt lgkmcnt(0)
  s_setprio 3
  v_mfma_f32_32x32x16_bf16 v[16:31], v[100:103], v[68:71], v[16:31]
  v_exp_f32 v32, v32
  v_exp_f32 v33, v33
  v_exp_f32 v34, v34
  v_exp_f32 v35, v35
  v_mfma_f32_32x32x16_bf16 v[48:63], v[80:83], v[4:7], 0
  ds_read_b128 v[72:75], v11 offset:6144
  ds_read_b64 v[76:77], v12 offset:6144
  v_exp_f32 v36, v36
  v_exp_f32 v37, v37
  v_cvt_pk_bf16_f32 v64, v32, v33
  v_cvt_pk_bf16_f32 v65, v34, v35
  ds_read_b128 v[96:99], v13 offset:3072
  ds_read_b128 v[100:103], v13 offset:3840
  v_exp_f32 v38, v38
  v_exp_f32 v39, v39
  v_mfma_f32_32x32x8bf16_1k v[48:63], v[84:85], v[8:9], v[48:63]
  v_exp_f32 v40, v40
  v_exp_f32 v41, v41
  v_cvt_pk_bf16_f32 v66, v36, v37
  v_cvt_pk_bf16_f32 v67, v38, v39
  v_exp_f32 v42, v42
  v_exp_f32 v43, v43
  v_mfma_f32_32x32x16_bf16 v[16:31], v[88:91], v[64:67], v[16:31]
  v_exp_f32 v44, v44
  v_exp_f32 v45, v45
  v_cvt_pk_bf16_f32 v68, v40, v41
  v_cvt_pk_bf16_f32 v69, v42, v43
  v_exp_f32 v46, v46
  v_exp_f32 v47, v47
  v_cvt_pk_bf16_f32 v70, v44, v45
  v_cvt_pk_bf16_f32 v71, v46, v47
  s_waitcnt lgkmcnt(0)
  s_setprio 2
  v_mfma_f32_32x32x16_bf16 v[16:31], v[92:95], v[68:71], v[16:31]
  v_exp_f32 v48, v48
  v_exp_f32 v49, v49
  v_exp_f32 v50, v50
  v_exp_f32 v51, v51
  v_mfma_f32_32x32x16_bf16 v[32:47], v[72:75], v[4:7], 0
  ds_read_b128 v[80:83], v11 offset:9216
  ds_read_b64 v[84:85], v12 offset:9216
  v_exp_f32 v52, v52
  v_exp_f32 v53, v53
  v_cvt_pk_bf16_f32 v64, v48, v49
  v_cvt_pk_bf16_f32 v65, v50, v51
  ds_read_b128 v[88:91], v13 offset:6144
  ds_read_b128 v[92:95], v13 offset:6912
  v_exp_f32 v54, v54
  v_exp_f32 v55, v55
  v_mfma_f32_32x32x8bf16_1k v[32:47], v[76:77], v[8:9], v[32:47]
  v_exp_f32 v56, v56
  v_exp_f32 v57, v57
  v_cvt_pk_bf16_f32 v66, v52, v53
  v_cvt_pk_bf16_f32 v67, v54, v55
  v_exp_f32 v58, v58
  v_exp_f32 v59, v59
  v_mfma_f32_32x32x16_bf16 v[16:31], v[96:99], v[64:67], v[16:31]
  v_exp_f32 v60, v60
  v_exp_f32 v61, v61
  v_cvt_pk_bf16_f32 v68, v56, v57
  v_cvt_pk_bf16_f32 v69, v58, v59
  v_exp_f32 v62, v62
  v_exp_f32 v63, v63
  v_cvt_pk_bf16_f32 v70, v60, v61
  v_cvt_pk_bf16_f32 v71, v62, v63
  s_waitcnt lgkmcnt(0)
  s_setprio 2
  v_mfma_f32_32x32x16_bf16 v[16:31], v[100:103], v[68:71], v[16:31]
  v_exp_f32 v32, v32
  v_exp_f32 v33, v33
  v_exp_f32 v34, v34
  v_exp_f32 v35, v35
  v_mfma_f32_32x32x16_bf16 v[48:63], v[80:83], v[4:7], 0
  ds_read_b128 v[72:75], v11 offset:12288
  ds_read_b64 v[76:77], v12 offset:12288
  v_exp_f32 v36, v36
  v_exp_f32 v37, v37
  v_cvt_pk_bf16_f32 v64, v32, v33
  v_cvt_pk_bf16_f32 v65, v34, v35
  ds_read_b128 v[96:99], v13 offset:9216
  ds_read_b128 v[100:103], v13 offset:9984
  v_exp_f32 v38, v38
  v_exp_f32 v39, v39
  v_mfma_f32_32x32x8bf16_1k v[48:63], v[84:85], v[8:9], v[48:63]
  v_exp_f32 v40, v40
  v_exp_f32 v41, v41
  v_cvt_pk_bf16_f32 v66, v36, v37
  v_cvt_pk_bf16_f32 v67, v38, v39
  v_exp_f32 v42, v42
  v_exp_f32 v43, v43
  v_mfma_f32_32x32x16_bf16 v[16:31], v[88:91], v[64:67], v[16:31]
  v_exp_f32 v44, v44
  v_exp_f32 v45, v45
  v_cvt_pk_bf16_f32 v68, v40, v41
  v_cvt_pk_bf16_f32 v69, v42, v43
  v_exp_f32 v46, v46
  v_exp_f32 v47, v47
  v_cvt_pk_bf16_f32 v70, v44, v45
  v_cvt_pk_bf16_f32 v71, v46, v47
  s_waitcnt lgkmcnt(0)
  s_setprio 1
  v_mfma_f32_32x32x16_bf16 v[16:31], v[92:95], v[68:71], v[16:31]
  v_exp_f32 v48, v48
  v_exp_f32 v49, v49
  v_exp_f32 v50, v50
  v_exp_f32 v51, v51
  v_mfma_f32_32x32x16_bf16 v[32:47], v[72:75], v[4:7], 0
  ds_read_b128 v[80:83], v11 offset:15360
  ds_read_b64 v[84:85], v12 offset:15360
  v_exp_f32 v52, v52
  v_exp_f32 v53, v53
  v_cvt_pk_bf16_f32 v64, v48, v49
  v_cvt_pk_bf16_f32 v65, v50, v51
  ds_read_b128 v[88:91], v13 offset:12288
  ds_read_b128 v[92:95], v13 offset:13056
  v_exp_f32 v54, v54
  v_exp_f32 v55, v55
  v_mfma_f32_32x32x8bf16_1k v[32:47], v[76:77], v[8:9], v[32:47]
  v_exp_f32 v56, v56
  v_exp_f32 v57, v57
  v_cvt_pk_bf16_f32 v66, v52, v53
  v_cvt_pk_bf16_f32 v67, v54, v55
  v_exp_f32 v58, v58
  v_exp_f32 v59, v59
  v_mfma_f32_32x32x16_bf16 v[16:31], v[96:99], v[64:67], v[16:31]
  v_exp_f32 v60, v60
  v_exp_f32 v61, v61
  v_cvt_pk_bf16_f32 v68, v56, v57
  v_cvt_pk_bf16_f32 v69, v58, v59
  v_exp_f32 v62, v62
  v_exp_f32 v63, v63
  v_cvt_pk_bf16_f32 v70, v60, v61
  v_cvt_pk_bf16_f32 v71, v62, v63
  s_waitcnt lgkmcnt(0)
  s_setprio 1
  v_mfma_f32_32x32x16_bf16 v[16:31], v[100:103], v[68:71], v[16:31]
  v_exp_f32 v32, v32
  v_exp_f32 v33, v33
  v_exp_f32 v34, v34
  v_exp_f32 v35, v35
  v_mfma_f32_32x32x16_bf16 v[48:63], v[80:83], v[4:7], 0
  ds_read_b128 v[72:75], v11 offset:18432
  ds_read_b64 v[76:77], v12 offset:18432
  v_exp_f32 v36, v36
  v_exp_f32 v37, v37
  v_cvt_pk_bf16_f32 v64, v32, v33
  v_cvt_pk_bf16_f32 v65, v34, v35
  ds_read_b128 v[96:99], v13 offset:15360
  ds_read_b128 v[100:103], v13 offset:16128
  v_exp_f32 v38, v38
  v_exp_f32 v39, v39
  v_mfma_f32_32x32x8bf16_1k v[48:63], v[84:85], v[8:9], v[48:63]
  v_exp_f32 v40, v40
  v_exp_f32 v41, v41
  v_cvt_pk_bf16_f32 v66, v36, v37
  v_cvt_pk_bf16_f32 v67, v38, v39
  v_exp_f32 v42, v42
  v_exp_f32 v43, v43
  v_mfma_f32_32x32x16_bf16 v[16:31], v[88:91], v[64:67], v[16:31]
  v_exp_f32 v44, v44
  v_exp_f32 v45, v45
  v_cvt_pk_bf16_f32 v68, v40, v41
  v_cvt_pk_bf16_f32 v69, v42, v43
  v_exp_f32 v46, v46
  v_exp_f32 v47, v47
  v_cvt_pk_bf16_f32 v70, v44, v45
  v_cvt_pk_bf16_f32 v71, v46, v47
  s_waitcnt lgkmcnt(0)
  s_setprio 0
  v_mfma_f32_32x32x16_bf16 v[16:31], v[92:95], v[68:71], v[16:31]
  v_exp_f32 v48, v48
  v_exp_f32 v49, v49
  v_exp_f32 v50, v50
  v_exp_f32 v51, v51
  v_mfma_f32_32x32x16_bf16 v[32:47], v[72:75], v[4:7], 0
  ds_read_b128 v[80:83], v11 offset:21504
  ds_read_b64 v[84:85], v12 offset:21504
  v_exp_f32 v52, v52
  v_exp_f32 v53, v53
  v_cvt_pk_bf16_f32 v64, v48, v49
  v_cvt_pk_bf16_f32 v65, v50, v51
  ds_read_b128 v[88:91], v13 offset:18432
  ds_read_b128 v[92:95], v13 offset:19200
  v_exp_f32 v54, v54
  v_exp_f32 v55, v55
  v_mfma_f32_32x32x8bf16_1k v[32:47], v[76:77], v[8:9], v[32:47]
  v_exp_f32 v56, v56
  v_exp_f32 v57, v57
  v_cvt_pk_bf16_f32 v66, v52, v53
  v_cvt_pk_bf16_f32 v67, v54, v55
  v_exp_f32 v58, v58
  v_exp_f32 v59, v59
  v_mfma_f32_32x32x16_bf16 v[16:31], v[96:99], v[64:67], v[16:31]
  v_exp_f32 v60, v60
  v_exp_f32 v61, v61
  v_cvt_pk_bf16_f32 v68, v56, v57
  v_cvt_pk_bf16_f32 v69, v58, v59
  v_exp_f32 v62, v62
  v_exp_f32 v63, v63
  v_cvt_pk_bf16_f32 v70, v60, v61
  v_cvt_pk_bf16_f32 v71, v62, v63
  s_waitcnt vmcnt(0) lgkmcnt(0)
  s_barrier
  s_cmp_ge_u32 s30, 6
  s_cbranch_scc1 nodma_47
  s_mov_b32 m0, s32
  s_nop 0
  buffer_load_dwordx4 v14, s[12:15], s33 offen offset:0 sc1 lds
  buffer_load_dwordx4 v14, s[12:15], s33 offen offset:1024 sc1 lds
  buffer_load_dwordx4 v14, s[12:15], s33 offen offset:2048 sc1 lds
  s_add_u32 s33, s33, 24576
  s_add_u32 s32, s32, 24576
  s_sub_u32 s26, s32, 73728
  s_cmp_ge_u32 s32, 73728
  s_cselect_b32 s32, s26, s32
nodma_47:
  s_cmp_eq_u32 s34, 0
  s_movk_i32 s31, 24576
  s_cselect_b32 s31, 0xffff4000, s31
  s_add_u32 s34, s34, 1
  s_cmp_eq_u32 s34, 3
  s_cselect_b32 s34, 0, s34
  v_add_u32 v11, s31, v11
  v_add_u32 v12, s31, v12
  s_setprio 3
  v_mfma_f32_32x32x16_bf16 v[16:31], v[100:103], v[68:71], v[16:31]
  v_exp_f32 v32, v32
  v_exp_f32 v33, v33
  v_exp_f32 v34, v34
  v_exp_f32 v35, v35
  v_mfma_f32_32x32x16_bf16 v[48:63], v[80:83], v[4:7], 0
  ds_read_b128 v[72:75], v11 offset:0
  ds_read_b64 v[76:77], v12 offset:0
  v_exp_f32 v36, v36
  v_exp_f32 v37, v37
  v_cvt_pk_bf16_f32 v64, v32, v33
  v_cvt_pk_bf16_f32 v65, v34, v35
  ds_read_b128 v[96:99], v13 offset:21504
  ds_read_b128 v[100:103], v13 offset:22272
  v_exp_f32 v38, v38
  v_exp_f32 v39, v39
  v_mfma_f32_32x32x8bf16_1k v[48:63], v[84:85], v[8:9], v[48:63]
  v_exp_f32 v40, v40
  v_exp_f32 v41, v41
  v_cvt_pk_bf16_f32 v66, v36, v37
  v_cvt_pk_bf16_f32 v67, v38, v39
  v_exp_f32 v42, v42
  v_exp_f32 v43, v43
  v_mfma_f32_32x32x16_bf16 v[16:31], v[88:91], v[64:67], v[16:31]
  v_exp_f32 v44, v44
  v_exp_f32 v45, v45
  v_cvt_pk_bf16_f32 v68, v40, v41
  v_cvt_pk_bf16_f32 v69, v42, v43
  v_exp_f32 v46, v46
  v_exp_f32 v47, v47
  v_cvt_pk_bf16_f32 v70, v44, v45
  v_cvt_pk_bf16_f32 v71, v46, v47
  s_waitcnt lgkmcnt(0)
  v_add_u32 v13, s31, v13
  s_setprio 3
  v_mfma_f32_32x32x16_bf16 v[16:31], v[92:95], v[68:71], v[16:31]
  v_exp_f32 v48, v48
  v_exp_f32 v49, v49
  v_exp_f32 v50, v50
  v_exp_f32 v51, v51
  v_mfma_f32_32x32x16_bf16 v[32:47], v[72:75], v[4:7], 0
  ds_read_b128 v[80:83], v11 offset:3072
  ds_read_b64 v[84:85], v12 offset:3072
  v_exp_f32 v52, v52
  v_exp_f32 v53, v53
  v_cvt_pk_bf16_f32 v64, v48, v49
  v_cvt_pk_bf16_f32 v65, v50, v51
  ds_read_b128 v[88:91], v13 offset:0
  ds_read_b128 v[92:95], v13 offset:768
  v_exp_f32 v54, v54
  v_exp_f32 v55, v55
  v_mfma_f32_32x32x8bf16_1k v[32:47], v[76:77], v[8:9], v[32:47]
  v_exp_f32 v56, v56
  v_exp_f32 v57, v57
  v_cvt_pk_bf16_f32 v66, v52, v53
  v_cvt_pk_bf16_f32 v67, v54, v55
  v_exp_f32 v58, v58
  v_exp_f32 v59, v59
  v_mfma_f32_32x32x16_bf16 v[16:31], v[96:99], v[64:67], v[16:31]
  v_exp_f32 v60, v60
  v_exp_f32 v61, v61
  v_cvt_pk_bf16_f32 v68, v56, v57
  v_cvt_pk_bf16_f32 v69, v58, v59
  v_exp_f32 v62, v62
  v_exp_f32 v63, v63
  v_cvt_pk_bf16_f32 v70, v60, v61
  v_cvt_pk_bf16_f32 v71, v62, v63
  s_add_u32 s30, s30, 1
  s_cmp_lt_u32 s30, 8
  s_cbranch_scc1 attn_loop_46
  s_nop 1
  v_mfma_f32_32x32x16_bf16 v[16:31], v[100:103], v[68:71], v[16:31]
  s_waitcnt lgkmcnt(0)
  s_nop 7
  s_nop 7
  v_mov_b32 v49, v24
  v_mov_b32 v50, v24
  s_nop 1
  v_permlane32_swap_b32 v49, v50
  s_nop 1
  v_fma_f32 v50, v16, 0, v50
  v_fma_f32 v50, v17, 0, v50
  v_fma_f32 v50, v18, 0, v50
  v_fma_f32 v50, v19, 0, v50
  v_fma_f32 v50, v20, 0, v50
  v_fma_f32 v50, v21, 0, v50
  v_fma_f32 v50, v22, 0, v50
  v_fma_f32 v50, v23, 0, v50
  v_fma_f32 v50, v24, 0, v50
  v_fma_f32 v50, v25, 0, v50
  v_fma_f32 v50, v26, 0, v50
  v_fma_f32 v50, v27, 0, v50
  s_mov_b32 s26, 0x2b800000
  s_mov_b32 s27, 0x53800000
  v_cmp_nle_f32 vcc, s26, v50
  v_cmp_nge_f32 s[58:59], s27, v50
  s_nop 1
  s_or_b64 vcc, vcc, s[58:59]
  s_cbranch_vccz fb_done_48
  v_lshlrev_b32 v52, 4, v1
  v_lshlrev_b32 v53, 3, v1
  v_and_b32 v49, 31, v1
  v_min_u32 v49, 21, v49
  v_lshlrev_b32 v49, 4, v49
  v_lshrrev_b32 v50, 5, v1
  v_mul_u32_u24 v50, 384, v50
  v_add_u32 v54, v49, v50
  v_mov_b32 v48, 0xff800000
  s_mov_b32 s33, 0
  s_mov_b32 s30, 0
fb_p1_49:
  buffer_load_dwordx4 v[72:75], v52, s[12:15], s33 offen sc1
  buffer_load_dwordx2 v[76:77], v53, s[12:15], s33 offen offset:1024 sc1
  s_waitcnt vmcnt(0)
  v_mfma_f32_32x32x16_bf16 v[32:47], v[72:75], v[4:7], 0
  v_mfma_f32_32x32x8bf16_1k v[32:47], v[76:77], v[8:9], v[32:47]
  s_nop 7
  s_nop 7
  s_nop 3
  v_max_f32 v48, v48, v32
  v_max_f32 v48, v48, v33
  v_max_f32 v48, v48, v34
  v_max_f32 v48, v48, v35
  v_max_f32 v48, v48, v36
  v_max_f32 v48, v48, v37
  v_max_f32 v48, v48, v38
  v_max_f32 v48, v48, v39
  v_max_f32 v48, v48, v40
  v_max_f32 v48, v48, v41
  v_max_f32 v48, v48, v42
  v_max_f32 v48, v48, v43
  v_max_f32 v48, v48, v44
  v_max_f32 v48, v48, v45
  v_max_f32 v48, v48, v46
  v_max_f32 v48, v48, v47
  s_add_u32 s33, s33, 3072
  s_add_u32 s30, s30, 1
  s_cmp_lt_u32 s30, 64
  s_cbranch_scc1 fb_p1_49
  v_mov_b32 v49, v48
  v_mov_b32 v50, v48
  s_nop 1
  v_permlane32_swap_b32 v49, v50
  s_nop 1
  v_max_f32 v48, v49, v50
  v_max_f32 v48, v48, v49
  v_mov_b32 v16, 0
  v_mov_b32 v17, 0
  v_mov_b32 v18, 0
  v_mov_b32 v19, 0
  v_mov_b32 v20, 0
  v_mov_b32 v21, 0
  v_mov_b32 v22, 0
  v_mov_b32 v23, 0
  v_mov_b32 v24, 0
  v_mov_b32 v25, 0
  v_mov_b32 v26, 0
  v_mov_b32 v27, 0
  v_mov_b32 v28, 0
  v_mov_b32 v29, 0
  v_mov_b32 v30, 0
  v_mov_b32 v31, 0
  s_mov_b32 s33, 0
  s_mov_b32 s30, 0
fb_p2_50:
  buffer_load_dwordx4 v[88:91], v54, s[12:15], s33 offen offset:1536 sc1
  buffer_load_dwordx4 v[92:95], v54, s[12:15], s33 offen offset:2304 sc1
  buffer_load_dwordx4 v[72:75], v52, s[12:15], s33 offen sc1
  buffer_load_dwordx2 v[76:77], v53, s[12:15], s33 offen offset:1024 sc1
  s_waitcnt vmcnt(0)
  v_mfma_f32_32x32x16_bf16 v[32:47], v[72:75], v[4:7], 0
  v_mfma_f32_32x32x8bf16_1k v[32:47], v[76:77], v[8:9], v[32:47]
  s_nop 7
  s_nop 7
  s_nop 3
  v_sub_f32 v32, v32, v48
  v_sub_f32 v33, v33, v48
  v_sub_f32 v34, v34, v48
  v_sub_f32 v35, v35, v48
  v_sub_f32 v36, v36, v48
  v_sub_f32 v37, v37, v48
  v_sub_f32 v38, v38, v48
  v_sub_f32 v39, v39, v48
  v_sub_f32 v40, v40, v48
  v_sub_f32 v41, v41, v48
  v_sub_f32 v42, v42, v48
  v_sub_f32 v43, v43, v48
  v_sub_f32 v44, v44, v48
  v_sub_f32 v45, v45, v48
  v_sub_f32 v46, v46, v48
  v_sub_f32 v47, v47, v48
  v_exp_f32 v32, v32
  v_exp_f32 v33, v33
  v_exp_f32 v34, v34
  v_exp_f32 v35, v35
  v_exp_f32 v36, v36
  v_exp_f32 v37, v37
  v_exp_f32 v38, v38
  v_exp_f32 v39, v39
  v_exp_f32 v40, v40
  v_exp_f32 v41, v41
  v_exp_f32 v42, v42
  v_exp_f32 v43, v43
  v_exp_f32 v44, v44
  v_exp_f32 v45, v45
  v_exp_f32 v46, v46
  v_exp_f32 v47, v47
  s_nop 1
  v_cvt_pk_bf16_f32 v64, v32, v33
  v_cvt_pk_bf16_f32 v65, v34, v35
  v_cvt_pk_bf16_f32 v66, v36, v37
  v_cvt_pk_bf16_f32 v67, v38, v39
  v_cvt_pk_bf16_f32 v68, v40, v41
  v_cvt_pk_bf16_f32 v69, v42, v43
  v_cvt_pk_bf16_f32 v70, v44, v45
  v_cvt_pk_bf16_f32 v71, v46, v47
  s_nop 1
  v_mfma_f32_32x32x16_bf16 v[16:31], v[88:91], v[64:67], v[16:31]
  v_mfma_f32_32x32x16_bf16 v[16:31], v[92:95], v[68:71], v[16:31]
  s_nop 7
  s_nop 7
  s_nop 3
  s_add_u32 s33, s33, 3072
  s_add_u32 s30, s30, 1
  s_cmp_lt_u32 s30, 64
  s_cbranch_scc1 fb_p2_50
  v_mov_b32 v49, v24
  v_mov_b32 v50, v24
  s_nop 1
  v_permlane32_swap_b32 v49, v50
  s_nop 1
fb_done_48:
  s_setprio 3
  v_rcp_f32 v33, v50
  s_nop 0
  v_mul_f32 v33, v10, v33
  v_mul_f32 v16, v33, v16
  v_mul_f32 v17, v33, v17
  v_mul_f32 v18, v33, v18
  v_mul_f32 v19, v33, v19
  v_mul_f32 v20, v33, v20
  v_mul_f32 v21, v33, v21
  v_mul_f32 v22, v33, v22
  v_mul_f32 v23, v33, v23
  v_mul_f32 v24, v33, v24
  v_mul_f32 v25, v33, v25
  v_mul_f32 v26, v33, v26
  v_mul_f32 v27, v33, v27
  v_cvt_pk_bf16_f32 v40, v16, v17
  v_cvt_pk_bf16_f32 v41, v18, v19
  v_cvt_pk_bf16_f32 v42, v20, v21
  v_cvt_pk_bf16_f32 v43, v22, v23
  v_cvt_pk_bf16_f32 v44, v24, v25
  v_cvt_pk_bf16_f32 v45, v26, v27
  ds_write_b64 v2, v[40:41]
  ds_write_b64 v2, v[42:43] offset:16
  s_mov_b64 exec, 0xffffffff
  ds_write_b64 v2, v[44:45] offset:32
  s_mov_b64 exec, -1
  s_waitcnt lgkmcnt(0)
  s_barrier
  ds_read_b128 v[48:51], v3
  s_cmp_ge_u32 s20, 2
  s_cbranch_scc1 ost_51
  ds_read_b128 v[52:55], v120
  s_waitcnt lgkmcnt(0)
  buffer_store_dwordx4 v[52:55], v122, s[12:15], s50 offen sc1
ost_51:
  s_waitcnt lgkmcnt(0)
  buffer_store_dwordx4 v[48:51], v121, s[12:15], s50 offen sc1
  s_waitcnt vmcnt(0)
  s_barrier
  s_cmp_lg_u32 s20, 7
  s_cbranch_scc1 of_52
  s_lshl_b32 s26, s21, 7
  s_lshl_b32 s27, s22, 4
  s_add_u32 s26, s26, s27
  s_add_u32 s26, s26, 4136960
  v_mov_b32 v32, 0
  v_mov_b32 v33, s57
  s_mov_b64 exec, 1
  buffer_store_dword v33, v32, s[12:15], s26 offen sc1
  s_mov_b64 exec, -1
of_52:
  s_endpgm
grole:
  s_sub_u32 s2, s2, 256
  v_and_b32 v1, 63, v0
  v_lshrrev_b32 v2, 6, v0
  s_nop 0
  v_readfirstlane_b32 s20, v2
  s_and_b32 s26, s2, 3
  s_lshl_b32 s26, s26, 2
  s_bfe_u32 s27, s2, 0x20003
  s_add_u32 s21, s26, s27
  s_bfe_u32 s26, s2, 0x10002
  s_lshl_b32 s26, s26, 3
  s_lshr_b32 s27, s2, 5
  s_add_u32 s22, s26, s27
  s_waitcnt lgkmcnt(0)
  s_mov_b32 s4, s82
  s_mov_b32 s5, s83
  s_mov_b32 s6, 0x280000
  s_mov_b32 s7, 0x00020000
  s_mov_b32 s8, s92
  s_mov_b32 s9, s93
  s_mov_b32 s10, 0x1e0000
  s_mov_b32 s11, 0x00020000
  s_mov_b32 s16, s94
  s_mov_b32 s17, s95
  s_mov_b32 s18, 0x1e0000
  s_mov_b32 s19, 0x00020000
  s_mov_b32 s12, s54
  s_mov_b32 s13, s55
  s_mov_b32 s14, 0x10000000
  s_mov_b32 s15, 0x00020000
  s_cmp_ge_u32 s20, 4
  s_cbranch_scc1 sa_load_53
  v_lshrrev_b32 v4, 5, v1
  v_lshlrev_b32 v4, 3, v4
  v_bfe_u32 v5, v1, 2, 2
  v_add_u32 v4, v4, v5
  v_mul_u32_u24 v4, 192, v4
  v_bfe_u32 v5, v1, 4, 1
  v_lshlrev_b32 v5, 5, v5
  v_add_u32 v4, v4, v5
  v_and_b32 v5, 3, v1
  v_lshlrev_b32 v5, 3, v5
  v_add_u32 v4, v4, v5
  v_add_u32 v30, 16384, v4
  v_add_u32 v31, 57344, v4
  v_and_b32 v4, 31, v1
  v_lshrrev_b32 v5, 5, v1
  v_bfe_u32 v6, v4, 1, 3
  v_xor_b32 v6, v6, v5
  s_lshl_b32 s26, s20, 5
  v_add_u32 v4, s26, v4
  v_lshlrev_b32 v4, 7, v4
  v_xor_b32 v5, 0, v6
  v_lshlrev_b32 v5, 4, v5
  v_add_u32 v28, v4, v5
  v_xor_b32 v5, 2, v6
  v_lshlrev_b32 v5, 4, v5
  v_add_u32 v29, v4, v5
  v_xor_b32 v5, 4, v6
  v_lshlrev_b32 v5, 4, v5
  v_add_u32 v2, v4, v5
  v_xor_b32 v5, 6, v6
  v_lshlrev_b32 v5, 4, v5
  v_add_u32 v3, v4, v5
  s_barrier
  ds_read_b128 v[4:7], v28 offset:0
  ds_read_b64_tr_b16 v[12:13], v30 offset:0
  ds_read_b64_tr_b16 v[14:15], v30 offset:768
  ds_read_b64_tr_b16 v[16:17], v30 offset:12288
  ds_read_b64_tr_b16 v[18:19], v30 offset:13056
  ds_read_b64_tr_b16 v[20:21], v30 offset:64
  ds_read_b64_tr_b16 v[22:23], v30 offset:832
  ds_read_b64_tr_b16 v[24:25], v30 offset:12352
  ds_read_b64_tr_b16 v[26:27], v30 offset:13120
  s_waitcnt lgkmcnt(6)
  v_mfma_f32_32x32x16_bf16 v[32:47], v[12:15], v[4:7], 0
  ds_read_b64_tr_b16 v[12:13], v30 offset:128
  ds_read_b64_tr_b16 v[14:15], v30 offset:896
  s_waitcnt lgkmcnt(6)
  v_mfma_f32_32x32x16_bf16 v[48:63], v[16:19], v[4:7], 0
  ds_read_b128 v[8:11], v29 offset:0
  ds_read_b64_tr_b16 v[16:17], v30 offset:12416
  ds_read_b64_tr_b16 v[18:19], v30 offset:13184
  s_waitcnt lgkmcnt(7)
  v_mfma_f32_32x32x16_bf16 v[64:79], v[20:23], v[4:7], 0
  ds_read_b64_tr_b16 v[20:21], v30 offset:3072
  ds_read_b64_tr_b16 v[22:23], v30 offset:3840
  s_waitcnt lgkmcnt(7)
  v_mfma_f32_32x32x16_bf16 v[80:95], v[24:27], v[4:7], 0
  ds_read_b64_tr_b16 v[24:25], v30 offset:15360
  ds_read_b64_tr_b16 v[26:27], v30 offset:16128
  s_waitcnt lgkmcnt(7)
  v_mfma_f32_32x32x16_bf16 v[96:111], v[12:15], v[4:7], 0
  ds_read_b64_tr_b16 v[12:13], v30 offset:3136
  ds_read_b64_tr_b16 v[14:15], v30 offset:3904
  s_waitcnt lgkmcnt(6)
  v_mfma_f32_32x32x16_bf16 v[112:127], v[16:19], v[4:7], 0
  ds_read_b64_tr_b16 v[16:17], v30 offset:15424
  ds_read_b64_tr_b16 v[18:19], v30 offset:16192
  s_waitcnt lgkmcnt(6)
  v_mfma_f32_32x32x16_bf16 v[32:47], v[20:23], v[8:11], v[32:47]
  ds_read_b64_tr_b16 v[20:21], v30 offset:3200
  ds_read_b64_tr_b16 v[22:23], v30 offset:3968
  s_waitcnt lgkmcnt(6)
  v_mfma_f32_32x32x16_bf16 v[48:63], v[24:27], v[8:11], v[48:63]
  ds_read_b128 v[4:7], v2 offset:0
  ds_read_b64_tr_b16 v[24:25], v30 offset:15488
  ds_read_b64_tr_b16 v[26:27], v30 offset:16256
  s_waitcnt lgkmcnt(7)
  v_mfma_f32_32x32x16_bf16 v[64:79], v[12:15], v[8:11], v[64:79]
  ds_read_b64_tr_b16 v[12:13], v30 offset:6144
  ds_read_b64_tr_b16 v[14:15], v30 offset:6912
  s_waitcnt lgkmcnt(7)
  v_mfma_f32_32x32x16_bf16 v[80:95], v[16:19], v[8:11], v[80:95]
  ds_read_b64_tr_b16 v[16:17], v30 offset:18432
  ds_read_b64_tr_b16 v[18:19], v30 offset:19200
  s_waitcnt lgkmcnt(7)
  v_mfma_f32_32x32x16_bf16 v[96:111], v[20:23], v[8:11], v[96:111]
  ds_read_b64_tr_b16 v[20:21], v30 offset:6208
  ds_read_b64_tr_b16 v[22:23], v30 offset:6976
  s_waitcnt lgkmcnt(6)
  v_mfma_f32_32x32x16_bf16 v[112:127], v[24:27], v[8:11], v[112:127]
  ds_read_b64_tr_b16 v[24:25], v30 offset:18496
  ds_read_b64_tr_b16 v[26:27], v30 offset:19264
  s_waitcnt lgkmcnt(6)
  v_mfma_f32_32x32x16_bf16 v[32:47], v[12:15], v[4:7], v[32:47]
  ds_read_b64_tr_b16 v[12:13], v30 offset:6272
  ds_read_b64_tr_b16 v[14:15], v30 offset:7040
  s_waitcnt lgkmcnt(6)
  v_mfma_f32_32x32x16_bf16 v[48:63], v[16:19], v[4:7], v[48:63]
  ds_read_b128 v[8:11], v3 offset:0
  ds_read_b64_tr_b16 v[16:17], v30 offset:18560
  ds_read_b64_tr_b16 v[18:19], v30 offset:19328
  s_waitcnt lgkmcnt(7)
  v_mfma_f32_32x32x16_bf16 v[64:79], v[20:23], v[4:7], v[64:79]
  ds_read_b64_tr_b16 v[20:21], v30 offset:9216
  ds_read_b64_tr_b16 v[22:23], v30 offset:9984
  s_waitcnt lgkmcnt(7)
  v_mfma_f32_32x32x16_bf16 v[80:95], v[24:27], v[4:7], v[80:95]
  ds_read_b64_tr_b16 v[24:25], v30 offset:21504
  ds_read_b64_tr_b16 v[26:27], v30 offset:22272
  s_waitcnt lgkmcnt(7)
  v_mfma_f32_32x32x16_bf16 v[96:111], v[12:15], v[4:7], v[96:111]
  ds_read_b64_tr_b16 v[12:13], v30 offset:9280
  ds_read_b64_tr_b16 v[14:15], v30 offset:10048
  s_waitcnt lgkmcnt(6)
  v_mfma_f32_32x32x16_bf16 v[112:127], v[16:19], v[4:7], v[112:127]
  ds_read_b64_tr_b16 v[16:17], v30 offset:21568
  ds_read_b64_tr_b16 v[18:19], v30 offset:22336
  s_waitcnt lgkmcnt(6)
  v_mfma_f32_32x32x16_bf16 v[32:47], v[20:23], v[8:11], v[32:47]
  ds_read_b64_tr_b16 v[20:21], v30 offset:9344
  ds_read_b64_tr_b16 v[22:23], v30 offset:10112
  s_waitcnt lgkmcnt(6)
  v_mfma_f32_32x32x16_bf16 v[48:63], v[24:27], v[8:11], v[48:63]
  ds_read_b64_tr_b16 v[24:25], v30 offset:21632
  ds_read_b64_tr_b16 v[26:27], v30 offset:22400
  s_waitcnt lgkmcnt(6)
  v_mfma_f32_32x32x16_bf16 v[64:79], v[12:15], v[8:11], v[64:79]
  s_waitcnt lgkmcnt(0)
  s_barrier
  ds_read_b128 v[4:7], v28 offset:40960
  ds_read_b64_tr_b16 v[12:13], v31 offset:0
  ds_read_b64_tr_b16 v[14:15], v31 offset:768
  v_mfma_f32_32x32x16_bf16 v[80:95], v[16:19], v[8:11], v[80:95]
  ds_read_b64_tr_b16 v[16:17], v31 offset:12288
  ds_read_b64_tr_b16 v[18:19], v31 offset:13056
  v_mfma_f32_32x32x16_bf16 v[96:111], v[20:23], v[8:11], v[96:111]
  ds_read_b64_tr_b16 v[20:21], v31 offset:64
  ds_read_b64_tr_b16 v[22:23], v31 offset:832
  v_mfma_f32_32x32x16_bf16 v[112:127], v[24:27], v[8:11], v[112:127]
  ds_read_b64_tr_b16 v[24:25], v31 offset:12352
  ds_read_b64_tr_b16 v[26:27], v31 offset:13120
  s_waitcnt lgkmcnt(6)
  v_mfma_f32_32x32x16_bf16 v[32:47], v[12:15], v[4:7], v[32:47]
  ds_read_b64_tr_b16 v[12:13], v31 offset:128
  ds_read_b64_tr_b16 v[14:15], v31 offset:896
  s_waitcnt lgkmcnt(6)
  v_mfma_f32_32x32x16_bf16 v[48:63], v[16:19], v[4:7], v[48:63]
  ds_read_b128 v[8:11], v29 offset:40960
  ds_read_b64_tr_b16 v[16:17], v31 offset:12416
  ds_read_b64_tr_b16 v[18:19], v31 offset:13184
  s_waitcnt lgkmcnt(7)
  v_mfma_f32_32x32x16_bf16 v[64:79], v[20:23], v[4:7], v[64:79]
  ds_read_b64_tr_b16 v[20:21], v31 offset:3072
  ds_read_b64_tr_b16 v[22:23], v31 offset:3840
  s_waitcnt lgkmcnt(7)
  v_mfma_f32_32x32x16_bf16 v[80:95], v[24:27], v[4:7], v[80:95]
  ds_read_b64_tr_b16 v[24:25], v31 offset:15360
  ds_read_b64_tr_b16 v[26:27], v31 offset:16128
  s_waitcnt lgkmcnt(7)
  v_mfma_f32_32x32x16_bf16 v[96:111], v[12:15], v[4:7], v[96:111]
  ds_read_b64_tr_b16 v[12:13], v31 offset:3136
  ds_read_b64_tr_b16 v[14:15], v31 offset:3904
  s_waitcnt lgkmcnt(6)
  v_mfma_f32_32x32x16_bf16 v[112:127], v[16:19], v[4:7], v[112:127]
  ds_read_b64_tr_b16 v[16:17], v31 offset:15424
  ds_read_b64_tr_b16 v[18:19], v31 offset:16192
  s_waitcnt lgkmcnt(6)
  v_mfma_f32_32x32x16_bf16 v[32:47], v[20:23], v[8:11], v[32:47]
  ds_read_b64_tr_b16 v[20:21], v31 offset:3200
  ds_read_b64_tr_b16 v[22:23], v31 offset:3968
  s_waitcnt lgkmcnt(6)
  v_mfma_f32_32x32x16_bf16 v[48:63], v[24:27], v[8:11], v[48:63]
  ds_read_b128 v[4:7], v2 offset:40960
  ds_read_b64_tr_b16 v[24:25], v31 offset:15488
  ds_read_b64_tr_b16 v[26:27], v31 offset:16256
  s_waitcnt lgkmcnt(7)
  v_mfma_f32_32x32x16_bf16 v[64:79], v[12:15], v[8:11], v[64:79]
  ds_read_b64_tr_b16 v[12:13], v31 offset:6144
  ds_read_b64_tr_b16 v[14:15], v31 offset:6912
  s_waitcnt lgkmcnt(7)
  v_mfma_f32_32x32x16_bf16 v[80:95], v[16:19], v[8:11], v[80:95]
  ds_read_b64_tr_b16 v[16:17], v31 offset:18432
  ds_read_b64_tr_b16 v[18:19], v31 offset:19200
  s_waitcnt lgkmcnt(7)
  v_mfma_f32_32x32x16_bf16 v[96:111], v[20:23], v[8:11], v[96:111]
  ds_read_b64_tr_b16 v[20:21], v31 offset:6208
  ds_read_b64_tr_b16 v[22:23], v31 offset:6976
  s_waitcnt lgkmcnt(6)
  v_mfma_f32_32x32x16_bf16 v[112:127], v[24:27], v[8:11], v[112:127]
  ds_read_b64_tr_b16 v[24:25], v31 offset:18496
  ds_read_b64_tr_b16 v[26:27], v31 offset:19264
  s_waitcnt lgkmcnt(6)
  v_mfma_f32_32x32x16_bf16 v[32:47], v[12:15], v[4:7], v[32:47]
  ds_read_b64_tr_b16 v[12:13], v31 offset:6272
  ds_read_b64_tr_b16 v[14:15], v31 offset:7040
  s_waitcnt lgkmcnt(6)
  v_mfma_f32_32x32x16_bf16 v[48:63], v[16:19], v[4:7], v[48:63]
  ds_read_b128 v[8:11], v3 offset:40960
  ds_read_b64_tr_b16 v[16:17], v31 offset:18560
  ds_read_b64_tr_b16 v[18:19], v31 offset:19328
  s_waitcnt lgkmcnt(7)
  v_mfma_f32_32x32x16_bf16 v[64:79], v[20:23], v[4:7], v[64:79]
  ds_read_b64_tr_b16 v[20:21], v31 offset:9216
  ds_read_b64_tr_b16 v[22:23], v31 offset:9984
  s_waitcnt lgkmcnt(7)
  v_mfma_f32_32x32x16_bf16 v[80:95], v[24:27], v[4:7], v[80:95]
  ds_read_b64_tr_b16 v[24:25], v31 offset:21504
  ds_read_b64_tr_b16 v[26:27], v31 offset:22272
  s_waitcnt lgkmcnt(7)
  v_mfma_f32_32x32x16_bf16 v[96:111], v[12:15], v[4:7], v[96:111]
  ds_read_b64_tr_b16 v[12:13], v31 offset:9280
  ds_read_b64_tr_b16 v[14:15], v31 offset:10048
  s_waitcnt lgkmcnt(6)
  v_mfma_f32_32x32x16_bf16 v[112:127], v[16:19], v[4:7], v[112:127]
  ds_read_b64_tr_b16 v[16:17], v31 offset:21568
  ds_read_b64_tr_b16 v[18:19], v31 offset:22336
  s_waitcnt lgkmcnt(6)
  v_mfma_f32_32x32x16_bf16 v[32:47], v[20:23], v[8:11], v[32:47]
  ds_read_b64_tr_b16 v[20:21], v31 offset:9344
  ds_read_b64_tr_b16 v[22:23], v31 offset:10112
  s_waitcnt lgkmcnt(6)
  v_mfma_f32_32x32x16_bf16 v[48:63], v[24:27], v[8:11], v[48:63]
  ds_read_b64_tr_b16 v[24:25], v31 offset:21632
  ds_read_b64_tr_b16 v[26:27], v31 offset:22400
  s_waitcnt lgkmcnt(6)
  v_mfma_f32_32x32x16_bf16 v[64:79], v[12:15], v[8:11], v[64:79]
  s_waitcnt lgkmcnt(0)
  s_barrier
  ds_read_b128 v[4:7], v28 offset:0
  ds_read_b64_tr_b16 v[12:13], v30 offset:0
  ds_read_b64_tr_b16 v[14:15], v30 offset:768
  v_mfma_f32_32x32x16_bf16 v[80:95], v[16:19], v[8:11], v[80:95]
  ds_read_b64_tr_b16 v[16:17], v30 offset:12288
  ds_read_b64_tr_b16 v[18:19], v30 offset:13056
  v_mfma_f32_32x32x16_bf16 v[96:111], v[20:23], v[8:11], v[96:111]
  ds_read_b64_tr_b16 v[20:21], v30 offset:64
  ds_read_b64_tr_b16 v[22:23], v30 offset:832
  v_mfma_f32_32x32x16_bf16 v[112:127], v[24:27], v[8:11], v[112:127]
  ds_read_b64_tr_b16 v[24:25], v30 offset:12352
  ds_read_b64_tr_b16 v[26:27], v30 offset:13120
  s_waitcnt lgkmcnt(6)
  v_mfma_f32_32x32x16_bf16 v[32:47], v[12:15], v[4:7], v[32:47]
  ds_read_b64_tr_b16 v[12:13], v30 offset:128
  ds_read_b64_tr_b16 v[14:15], v30 offset:896
  s_waitcnt lgkmcnt(6)
  v_mfma_f32_32x32x16_bf16 v[48:63], v[16:19], v[4:7], v[48:63]
  ds_read_b128 v[8:11], v29 offset:0
  ds_read_b64_tr_b16 v[16:17], v30 offset:12416
  ds_read_b64_tr_b16 v[18:19], v30 offset:13184
  s_waitcnt lgkmcnt(7)
  v_mfma_f32_32x32x16_bf16 v[64:79], v[20:23], v[4:7], v[64:79]
  ds_read_b64_tr_b16 v[20:21], v30 offset:3072
  ds_read_b64_tr_b16 v[22:23], v30 offset:3840
  s_waitcnt lgkmcnt(7)
  v_mfma_f32_32x32x16_bf16 v[80:95], v[24:27], v[4:7], v[80:95]
  ds_read_b64_tr_b16 v[24:25], v30 offset:15360
  ds_read_b64_tr_b16 v[26:27], v30 offset:16128
  s_waitcnt lgkmcnt(7)
  v_mfma_f32_32x32x16_bf16 v[96:111], v[12:15], v[4:7], v[96:111]
  ds_read_b64_tr_b16 v[12:13], v30 offset:3136
  ds_read_b64_tr_b16 v[14:15], v30 offset:3904
  s_waitcnt lgkmcnt(6)
  v_mfma_f32_32x32x16_bf16 v[112:127], v[16:19], v[4:7], v[112:127]
  ds_read_b64_tr_b16 v[16:17], v30 offset:15424
  ds_read_b64_tr_b16 v[18:19], v30 offset:16192
  s_waitcnt lgkmcnt(6)
  v_mfma_f32_32x32x16_bf16 v[32:47], v[20:23], v[8:11], v[32:47]
  ds_read_b64_tr_b16 v[20:21], v30 offset:3200
  ds_read_b64_tr_b16 v[22:23], v30 offset:3968
  s_waitcnt lgkmcnt(6)
  v_mfma_f32_32x32x16_bf16 v[48:63], v[24:27], v[8:11], v[48:63]
  ds_read_b128 v[4:7], v2 offset:0
  ds_read_b64_tr_b16 v[24:25], v30 offset:15488
  ds_read_b64_tr_b16 v[26:27], v30 offset:16256
  s_waitcnt lgkmcnt(7)
  v_mfma_f32_32x32x16_bf16 v[64:79], v[12:15], v[8:11], v[64:79]
  ds_read_b64_tr_b16 v[12:13], v30 offset:6144
  ds_read_b64_tr_b16 v[14:15], v30 offset:6912
  s_waitcnt lgkmcnt(7)
  v_mfma_f32_32x32x16_bf16 v[80:95], v[16:19], v[8:11], v[80:95]
  ds_read_b64_tr_b16 v[16:17], v30 offset:18432
  ds_read_b64_tr_b16 v[18:19], v30 offset:19200
  s_waitcnt lgkmcnt(7)
  v_mfma_f32_32x32x16_bf16 v[96:111], v[20:23], v[8:11], v[96:111]
  ds_read_b64_tr_b16 v[20:21], v30 offset:6208
  ds_read_b64_tr_b16 v[22:23], v30 offset:6976
  s_waitcnt lgkmcnt(6)
  v_mfma_f32_32x32x16_bf16 v[112:127], v[24:27], v[8:11], v[112:127]
  ds_read_b64_tr_b16 v[24:25], v30 offset:18496
  ds_read_b64_tr_b16 v[26:27], v30 offset:19264
  s_waitcnt lgkmcnt(6)
  v_mfma_f32_32x32x16_bf16 v[32:47], v[12:15], v[4:7], v[32:47]
  ds_read_b64_tr_b16 v[12:13], v30 offset:6272
  ds_read_b64_tr_b16 v[14:15], v30 offset:7040
  s_waitcnt lgkmcnt(6)
  v_mfma_f32_32x32x16_bf16 v[48:63], v[16:19], v[4:7], v[48:63]
  ds_read_b128 v[8:11], v3 offset:0
  ds_read_b64_tr_b16 v[16:17], v30 offset:18560
  ds_read_b64_tr_b16 v[18:19], v30 offset:19328
  s_waitcnt lgkmcnt(7)
  v_mfma_f32_32x32x16_bf16 v[64:79], v[20:23], v[4:7], v[64:79]
  ds_read_b64_tr_b16 v[20:21], v30 offset:9216
  ds_read_b64_tr_b16 v[22:23], v30 offset:9984
  s_waitcnt lgkmcnt(7)
  v_mfma_f32_32x32x16_bf16 v[80:95], v[24:27], v[4:7], v[80:95]
  ds_read_b64_tr_b16 v[24:25], v30 offset:21504
  ds_read_b64_tr_b16 v[26:27], v30 offset:22272
  s_waitcnt lgkmcnt(7)
  v_mfma_f32_32x32x16_bf16 v[96:111], v[12:15], v[4:7], v[96:111]
  ds_read_b64_tr_b16 v[12:13], v30 offset:9280
  ds_read_b64_tr_b16 v[14:15], v30 offset:10048
  s_waitcnt lgkmcnt(6)
  v_mfma_f32_32x32x16_bf16 v[112:127], v[16:19], v[4:7], v[112:127]
  ds_read_b64_tr_b16 v[16:17], v30 offset:21568
  ds_read_b64_tr_b16 v[18:19], v30 offset:22336
  s_waitcnt lgkmcnt(6)
  v_mfma_f32_32x32x16_bf16 v[32:47], v[20:23], v[8:11], v[32:47]
  ds_read_b64_tr_b16 v[20:21], v30 offset:9344
  ds_read_b64_tr_b16 v[22:23], v30 offset:10112
  s_waitcnt lgkmcnt(6)
  v_mfma_f32_32x32x16_bf16 v[48:63], v[24:27], v[8:11], v[48:63]
  ds_read_b64_tr_b16 v[24:25], v30 offset:21632
  ds_read_b64_tr_b16 v[26:27], v30 offset:22400
  s_waitcnt lgkmcnt(6)
  v_mfma_f32_32x32x16_bf16 v[64:79], v[12:15], v[8:11], v[64:79]
  s_waitcnt lgkmcnt(0)
  s_barrier
  ds_read_b128 v[4:7], v28 offset:40960
  ds_read_b64_tr_b16 v[12:13], v31 offset:0
  ds_read_b64_tr_b16 v[14:15], v31 offset:768
  v_mfma_f32_32x32x16_bf16 v[80:95], v[16:19], v[8:11], v[80:95]
  ds_read_b64_tr_b16 v[16:17], v31 offset:12288
  ds_read_b64_tr_b16 v[18:19], v31 offset:13056
  v_mfma_f32_32x32x16_bf16 v[96:111], v[20:23], v[8:11], v[96:111]
  ds_read_b64_tr_b16 v[20:21], v31 offset:64
  ds_read_b64_tr_b16 v[22:23], v31 offset:832
  v_mfma_f32_32x32x16_bf16 v[112:127], v[24:27], v[8:11], v[112:127]
  ds_read_b64_tr_b16 v[24:25], v31 offset:12352
  ds_read_b64_tr_b16 v[26:27], v31 offset:13120
  s_waitcnt lgkmcnt(6)
  v_mfma_f32_32x32x16_bf16 v[32:47], v[12:15], v[4:7], v[32:47]
  ds_read_b64_tr_b16 v[12:13], v31 offset:128
  ds_read_b64_tr_b16 v[14:15], v31 offset:896
  s_waitcnt lgkmcnt(6)
  v_mfma_f32_32x32x16_bf16 v[48:63], v[16:19], v[4:7], v[48:63]
  ds_read_b128 v[8:11], v29 offset:40960
  ds_read_b64_tr_b16 v[16:17], v31 offset:12416
  ds_read_b64_tr_b16 v[18:19], v31 offset:13184
  s_waitcnt lgkmcnt(7)
  v_mfma_f32_32x32x16_bf16 v[64:79], v[20:23], v[4:7], v[64:79]
  ds_read_b64_tr_b16 v[20:21], v31 offset:3072
  ds_read_b64_tr_b16 v[22:23], v31 offset:3840
  s_waitcnt lgkmcnt(7)
  v_mfma_f32_32x32x16_bf16 v[80:95], v[24:27], v[4:7], v[80:95]
  ds_read_b64_tr_b16 v[24:25], v31 offset:15360
  ds_read_b64_tr_b16 v[26:27], v31 offset:16128
  s_waitcnt lgkmcnt(7)
  v_mfma_f32_32x32x16_bf16 v[96:111], v[12:15], v[4:7], v[96:111]
  ds_read_b64_tr_b16 v[12:13], v31 offset:3136
  ds_read_b64_tr_b16 v[14:15], v31 offset:3904
  s_waitcnt lgkmcnt(6)
  v_mfma_f32_32x32x16_bf16 v[112:127], v[16:19], v[4:7], v[112:127]
  ds_read_b64_tr_b16 v[16:17], v31 offset:15424
  ds_read_b64_tr_b16 v[18:19], v31 offset:16192
  s_waitcnt lgkmcnt(6)
  v_mfma_f32_32x32x16_bf16 v[32:47], v[20:23], v[8:11], v[32:47]
  ds_read_b64_tr_b16 v[20:21], v31 offset:3200
  ds_read_b64_tr_b16 v[22:23], v31 offset:3968
  s_waitcnt lgkmcnt(6)
  v_mfma_f32_32x32x16_bf16 v[48:63], v[24:27], v[8:11], v[48:63]
  ds_read_b128 v[4:7], v2 offset:40960
  ds_read_b64_tr_b16 v[24:25], v31 offset:15488
  ds_read_b64_tr_b16 v[26:27], v31 offset:16256
  s_waitcnt lgkmcnt(7)
  v_mfma_f32_32x32x16_bf16 v[64:79], v[12:15], v[8:11], v[64:79]
  ds_read_b64_tr_b16 v[12:13], v31 offset:6144
  ds_read_b64_tr_b16 v[14:15], v31 offset:6912
  s_waitcnt lgkmcnt(7)
  v_mfma_f32_32x32x16_bf16 v[80:95], v[16:19], v[8:11], v[80:95]
  ds_read_b64_tr_b16 v[16:17], v31 offset:18432
  ds_read_b64_tr_b16 v[18:19], v31 offset:19200
  s_waitcnt lgkmcnt(7)
  v_mfma_f32_32x32x16_bf16 v[96:111], v[20:23], v[8:11], v[96:111]
  ds_read_b64_tr_b16 v[20:21], v31 offset:6208
  ds_read_b64_tr_b16 v[22:23], v31 offset:6976
  s_waitcnt lgkmcnt(6)
  v_mfma_f32_32x32x16_bf16 v[112:127], v[24:27], v[8:11], v[112:127]
  ds_read_b64_tr_b16 v[24:25], v31 offset:18496
  ds_read_b64_tr_b16 v[26:27], v31 offset:19264
  s_waitcnt lgkmcnt(6)
  v_mfma_f32_32x32x16_bf16 v[32:47], v[12:15], v[4:7], v[32:47]
  ds_read_b64_tr_b16 v[12:13], v31 offset:6272
  ds_read_b64_tr_b16 v[14:15], v31 offset:7040
  s_waitcnt lgkmcnt(6)
  v_mfma_f32_32x32x16_bf16 v[48:63], v[16:19], v[4:7], v[48:63]
  ds_read_b128 v[8:11], v3 offset:40960
  ds_read_b64_tr_b16 v[16:17], v31 offset:18560
  ds_read_b64_tr_b16 v[18:19], v31 offset:19328
  s_waitcnt lgkmcnt(7)
  v_mfma_f32_32x32x16_bf16 v[64:79], v[20:23], v[4:7], v[64:79]
  ds_read_b64_tr_b16 v[20:21], v31 offset:9216
  ds_read_b64_tr_b16 v[22:23], v31 offset:9984
  s_waitcnt lgkmcnt(7)
  v_mfma_f32_32x32x16_bf16 v[80:95], v[24:27], v[4:7], v[80:95]
  ds_read_b64_tr_b16 v[24:25], v31 offset:21504
  ds_read_b64_tr_b16 v[26:27], v31 offset:22272
  s_waitcnt lgkmcnt(7)
  v_mfma_f32_32x32x16_bf16 v[96:111], v[12:15], v[4:7], v[96:111]
  ds_read_b64_tr_b16 v[12:13], v31 offset:9280
  ds_read_b64_tr_b16 v[14:15], v31 offset:10048
  s_waitcnt lgkmcnt(6)
  v_mfma_f32_32x32x16_bf16 v[112:127], v[16:19], v[4:7], v[112:127]
  ds_read_b64_tr_b16 v[16:17], v31 offset:21568
  ds_read_b64_tr_b16 v[18:19], v31 offset:22336
  s_waitcnt lgkmcnt(6)
  v_mfma_f32_32x32x16_bf16 v[32:47], v[20:23], v[8:11], v[32:47]
  ds_read_b64_tr_b16 v[20:21], v31 offset:9344
  ds_read_b64_tr_b16 v[22:23], v31 offset:10112
  s_waitcnt lgkmcnt(6)
  v_mfma_f32_32x32x16_bf16 v[48:63], v[24:27], v[8:11], v[48:63]
  ds_read_b64_tr_b16 v[24:25], v31 offset:21632
  ds_read_b64_tr_b16 v[26:27], v31 offset:22400
  s_waitcnt lgkmcnt(6)
  v_mfma_f32_32x32x16_bf16 v[64:79], v[12:15], v[8:11], v[64:79]
  s_waitcnt lgkmcnt(0)
  s_barrier
  ds_read_b128 v[4:7], v28 offset:0
  ds_read_b64_tr_b16 v[12:13], v30 offset:0
  ds_read_b64_tr_b16 v[14:15], v30 offset:768
  v_mfma_f32_32x32x16_bf16 v[80:95], v[16:19], v[8:11], v[80:95]
  ds_read_b64_tr_b16 v[16:17], v30 offset:12288
  ds_read_b64_tr_b16 v[18:19], v30 offset:13056
  v_mfma_f32_32x32x16_bf16 v[96:111], v[20:23], v[8:11], v[96:111]
  ds_read_b64_tr_b16 v[20:21], v30 offset:64
  ds_read_b64_tr_b16 v[22:23], v30 offset:832
  v_mfma_f32_32x32x16_bf16 v[112:127], v[24:27], v[8:11], v[112:127]
  ds_read_b64_tr_b16 v[24:25], v30 offset:12352
  ds_read_b64_tr_b16 v[26:27], v30 offset:13120
  s_waitcnt lgkmcnt(6)
  v_mfma_f32_32x32x16_bf16 v[32:47], v[12:15], v[4:7], v[32:47]
  ds_read_b64_tr_b16 v[12:13], v30 offset:128
  ds_read_b64_tr_b16 v[14:15], v30 offset:896
  s_waitcnt lgkmcnt(6)
  v_mfma_f32_32x32x16_bf16 v[48:63], v[16:19], v[4:7], v[48:63]
  ds_read_b128 v[8:11], v29 offset:0
  ds_read_b64_tr_b16 v[16:17], v30 offset:12416
  ds_read_b64_tr_b16 v[18:19], v30 offset:13184
  s_waitcnt lgkmcnt(7)
  v_mfma_f32_32x32x16_bf16 v[64:79], v[20:23], v[4:7], v[64:79]
  ds_read_b64_tr_b16 v[20:21], v30 offset:3072
  ds_read_b64_tr_b16 v[22:23], v30 offset:3840
  s_waitcnt lgkmcnt(7)
  v_mfma_f32_32x32x16_bf16 v[80:95], v[24:27], v[4:7], v[80:95]
  ds_read_b64_tr_b16 v[24:25], v30 offset:15360
  ds_read_b64_tr_b16 v[26:27], v30 offset:16128
  s_waitcnt lgkmcnt(7)
  v_mfma_f32_32x32x16_bf16 v[96:111], v[12:15], v[4:7], v[96:111]
  ds_read_b64_tr_b16 v[12:13], v30 offset:3136
  ds_read_b64_tr_b16 v[14:15], v30 offset:3904
  s_waitcnt lgkmcnt(6)
  v_mfma_f32_32x32x16_bf16 v[112:127], v[16:19], v[4:7], v[112:127]
  ds_read_b64_tr_b16 v[16:17], v30 offset:15424
  ds_read_b64_tr_b16 v[18:19], v30 offset:16192
  s_waitcnt lgkmcnt(6)
  v_mfma_f32_32x32x16_bf16 v[32:47], v[20:23], v[8:11], v[32:47]
  ds_read_b64_tr_b16 v[20:21], v30 offset:3200
  ds_read_b64_tr_b16 v[22:23], v30 offset:3968
  s_waitcnt lgkmcnt(6)
  v_mfma_f32_32x32x16_bf16 v[48:63], v[24:27], v[8:11], v[48:63]
  ds_read_b128 v[4:7], v2 offset:0
  ds_read_b64_tr_b16 v[24:25], v30 offset:15488
  ds_read_b64_tr_b16 v[26:27], v30 offset:16256
  s_waitcnt lgkmcnt(7)
  v_mfma_f32_32x32x16_bf16 v[64:79], v[12:15], v[8:11], v[64:79]
  ds_read_b64_tr_b16 v[12:13], v30 offset:6144
  ds_read_b64_tr_b16 v[14:15], v30 offset:6912
  s_waitcnt lgkmcnt(7)
  v_mfma_f32_32x32x16_bf16 v[80:95], v[16:19], v[8:11], v[80:95]
  ds_read_b64_tr_b16 v[16:17], v30 offset:18432
  ds_read_b64_tr_b16 v[18:19], v30 offset:19200
  s_waitcnt lgkmcnt(7)
  v_mfma_f32_32x32x16_bf16 v[96:111], v[20:23], v[8:11], v[96:111]
  ds_read_b64_tr_b16 v[20:21], v30 offset:6208
  ds_read_b64_tr_b16 v[22:23], v30 offset:6976
  s_waitcnt lgkmcnt(6)
  v_mfma_f32_32x32x16_bf16 v[112:127], v[24:27], v[8:11], v[112:127]
  ds_read_b64_tr_b16 v[24:25], v30 offset:18496
  ds_read_b64_tr_b16 v[26:27], v30 offset:19264
  s_waitcnt lgkmcnt(6)
  v_mfma_f32_32x32x16_bf16 v[32:47], v[12:15], v[4:7], v[32:47]
  ds_read_b64_tr_b16 v[12:13], v30 offset:6272
  ds_read_b64_tr_b16 v[14:15], v30 offset:7040
  s_waitcnt lgkmcnt(6)
  v_mfma_f32_32x32x16_bf16 v[48:63], v[16:19], v[4:7], v[48:63]
  ds_read_b128 v[8:11], v3 offset:0
  ds_read_b64_tr_b16 v[16:17], v30 offset:18560
  ds_read_b64_tr_b16 v[18:19], v30 offset:19328
  s_waitcnt lgkmcnt(7)
  v_mfma_f32_32x32x16_bf16 v[64:79], v[20:23], v[4:7], v[64:79]
  ds_read_b64_tr_b16 v[20:21], v30 offset:9216
  ds_read_b64_tr_b16 v[22:23], v30 offset:9984
  s_waitcnt lgkmcnt(7)
  v_mfma_f32_32x32x16_bf16 v[80:95], v[24:27], v[4:7], v[80:95]
  ds_read_b64_tr_b16 v[24:25], v30 offset:21504
  ds_read_b64_tr_b16 v[26:27], v30 offset:22272
  s_waitcnt lgkmcnt(7)
  v_mfma_f32_32x32x16_bf16 v[96:111], v[12:15], v[4:7], v[96:111]
  ds_read_b64_tr_b16 v[12:13], v30 offset:9280
  ds_read_b64_tr_b16 v[14:15], v30 offset:10048
  s_waitcnt lgkmcnt(6)
  v_mfma_f32_32x32x16_bf16 v[112:127], v[16:19], v[4:7], v[112:127]
  ds_read_b64_tr_b16 v[16:17], v30 offset:21568
  ds_read_b64_tr_b16 v[18:19], v30 offset:22336
  s_waitcnt lgkmcnt(6)
  v_mfma_f32_32x32x16_bf16 v[32:47], v[20:23], v[8:11], v[32:47]
  ds_read_b64_tr_b16 v[20:21], v30 offset:9344
  ds_read_b64_tr_b16 v[22:23], v30 offset:10112
  s_waitcnt lgkmcnt(6)
  v_mfma_f32_32x32x16_bf16 v[48:63], v[24:27], v[8:11], v[48:63]
  ds_read_b64_tr_b16 v[24:25], v30 offset:21632
  ds_read_b64_tr_b16 v[26:27], v30 offset:22400
  s_waitcnt lgkmcnt(6)
  v_mfma_f32_32x32x16_bf16 v[64:79], v[12:15], v[8:11], v[64:79]
  s_waitcnt lgkmcnt(0)
  s_barrier
  ds_read_b128 v[4:7], v28 offset:40960
  ds_read_b64_tr_b16 v[12:13], v31 offset:0
  ds_read_b64_tr_b16 v[14:15], v31 offset:768
  v_mfma_f32_32x32x16_bf16 v[80:95], v[16:19], v[8:11], v[80:95]
  ds_read_b64_tr_b16 v[16:17], v31 offset:12288
  ds_read_b64_tr_b16 v[18:19], v31 offset:13056
  v_mfma_f32_32x32x16_bf16 v[96:111], v[20:23], v[8:11], v[96:111]
  ds_read_b64_tr_b16 v[20:21], v31 offset:64
  ds_read_b64_tr_b16 v[22:23], v31 offset:832
  v_mfma_f32_32x32x16_bf16 v[112:127], v[24:27], v[8:11], v[112:127]
  ds_read_b64_tr_b16 v[24:25], v31 offset:12352
  ds_read_b64_tr_b16 v[26:27], v31 offset:13120
  s_waitcnt lgkmcnt(6)
  v_mfma_f32_32x32x16_bf16 v[32:47], v[12:15], v[4:7], v[32:47]
  ds_read_b64_tr_b16 v[12:13], v31 offset:128
  ds_read_b64_tr_b16 v[14:15], v31 offset:896
  s_waitcnt lgkmcnt(6)
  v_mfma_f32_32x32x16_bf16 v[48:63], v[16:19], v[4:7], v[48:63]
  ds_read_b128 v[8:11], v29 offset:40960
  ds_read_b64_tr_b16 v[16:17], v31 offset:12416
  ds_read_b64_tr_b16 v[18:19], v31 offset:13184
  s_waitcnt lgkmcnt(7)
  v_mfma_f32_32x32x16_bf16 v[64:79], v[20:23], v[4:7], v[64:79]
  ds_read_b64_tr_b16 v[20:21], v31 offset:3072
  ds_read_b64_tr_b16 v[22:23], v31 offset:3840
  s_waitcnt lgkmcnt(7)
  v_mfma_f32_32x32x16_bf16 v[80:95], v[24:27], v[4:7], v[80:95]
  ds_read_b64_tr_b16 v[24:25], v31 offset:15360
  ds_read_b64_tr_b16 v[26:27], v31 offset:16128
  s_waitcnt lgkmcnt(7)
  v_mfma_f32_32x32x16_bf16 v[96:111], v[12:15], v[4:7], v[96:111]
  ds_read_b64_tr_b16 v[12:13], v31 offset:3136
  ds_read_b64_tr_b16 v[14:15], v31 offset:3904
  s_waitcnt lgkmcnt(6)
  v_mfma_f32_32x32x16_bf16 v[112:127], v[16:19], v[4:7], v[112:127]
  ds_read_b64_tr_b16 v[16:17], v31 offset:15424
  ds_read_b64_tr_b16 v[18:19], v31 offset:16192
  s_waitcnt lgkmcnt(6)
  v_mfma_f32_32x32x16_bf16 v[32:47], v[20:23], v[8:11], v[32:47]
  ds_read_b64_tr_b16 v[20:21], v31 offset:3200
  ds_read_b64_tr_b16 v[22:23], v31 offset:3968
  s_waitcnt lgkmcnt(6)
  v_mfma_f32_32x32x16_bf16 v[48:63], v[24:27], v[8:11], v[48:63]
  ds_read_b128 v[4:7], v2 offset:40960
  ds_read_b64_tr_b16 v[24:25], v31 offset:15488
  ds_read_b64_tr_b16 v[26:27], v31 offset:16256
  s_waitcnt lgkmcnt(7)
  v_mfma_f32_32x32x16_bf16 v[64:79], v[12:15], v[8:11], v[64:79]
  ds_read_b64_tr_b16 v[12:13], v31 offset:6144
  ds_read_b64_tr_b16 v[14:15], v31 offset:6912
  s_waitcnt lgkmcnt(7)
  v_mfma_f32_32x32x16_bf16 v[80:95], v[16:19], v[8:11], v[80:95]
  ds_read_b64_tr_b16 v[16:17], v31 offset:18432
  ds_read_b64_tr_b16 v[18:19], v31 offset:19200
  s_waitcnt lgkmcnt(7)
  v_mfma_f32_32x32x16_bf16 v[96:111], v[20:23], v[8:11], v[96:111]
  ds_read_b64_tr_b16 v[20:21], v31 offset:6208
  ds_read_b64_tr_b16 v[22:23], v31 offset:6976
  s_waitcnt lgkmcnt(6)
  v_mfma_f32_32x32x16_bf16 v[112:127], v[24:27], v[8:11], v[112:127]
  ds_read_b64_tr_b16 v[24:25], v31 offset:18496
  ds_read_b64_tr_b16 v[26:27], v31 offset:19264
  s_waitcnt lgkmcnt(6)
  v_mfma_f32_32x32x16_bf16 v[32:47], v[12:15], v[4:7], v[32:47]
  ds_read_b64_tr_b16 v[12:13], v31 offset:6272
  ds_read_b64_tr_b16 v[14:15], v31 offset:7040
  s_waitcnt lgkmcnt(6)
  v_mfma_f32_32x32x16_bf16 v[48:63], v[16:19], v[4:7], v[48:63]
  ds_read_b128 v[8:11], v3 offset:40960
  ds_read_b64_tr_b16 v[16:17], v31 offset:18560
  ds_read_b64_tr_b16 v[18:19], v31 offset:19328
  s_waitcnt lgkmcnt(7)
  v_mfma_f32_32x32x16_bf16 v[64:79], v[20:23], v[4:7], v[64:79]
  ds_read_b64_tr_b16 v[20:21], v31 offset:9216
  ds_read_b64_tr_b16 v[22:23], v31 offset:9984
  s_waitcnt lgkmcnt(7)
  v_mfma_f32_32x32x16_bf16 v[80:95], v[24:27], v[4:7], v[80:95]
  ds_read_b64_tr_b16 v[24:25], v31 offset:21504
  ds_read_b64_tr_b16 v[26:27], v31 offset:22272
  s_waitcnt lgkmcnt(7)
  v_mfma_f32_32x32x16_bf16 v[96:111], v[12:15], v[4:7], v[96:111]
  ds_read_b64_tr_b16 v[12:13], v31 offset:9280
  ds_read_b64_tr_b16 v[14:15], v31 offset:10048
  s_waitcnt lgkmcnt(6)
  v_mfma_f32_32x32x16_bf16 v[112:127], v[16:19], v[4:7], v[112:127]
  ds_read_b64_tr_b16 v[16:17], v31 offset:21568
  ds_read_b64_tr_b16 v[18:19], v31 offset:22336
  s_waitcnt lgkmcnt(6)
  v_mfma_f32_32x32x16_bf16 v[32:47], v[20:23], v[8:11], v[32:47]
  ds_read_b64_tr_b16 v[20:21], v31 offset:9344
  ds_read_b64_tr_b16 v[22:23], v31 offset:10112
  s_waitcnt lgkmcnt(6)
  v_mfma_f32_32x32x16_bf16 v[48:63], v[24:27], v[8:11], v[48:63]
  ds_read_b64_tr_b16 v[24:25], v31 offset:21632
  ds_read_b64_tr_b16 v[26:27], v31 offset:22400
  s_waitcnt lgkmcnt(6)
  v_mfma_f32_32x32x16_bf16 v[64:79], v[12:15], v[8:11], v[64:79]
  s_waitcnt lgkmcnt(0)
  s_barrier
  ds_read_b128 v[4:7], v28 offset:0
  ds_read_b64_tr_b16 v[12:13], v30 offset:0
  ds_read_b64_tr_b16 v[14:15], v30 offset:768
  v_mfma_f32_32x32x16_bf16 v[80:95], v[16:19], v[8:11], v[80:95]
  ds_read_b64_tr_b16 v[16:17], v30 offset:12288
  ds_read_b64_tr_b16 v[18:19], v30 offset:13056
  v_mfma_f32_32x32x16_bf16 v[96:111], v[20:23], v[8:11], v[96:111]
  ds_read_b64_tr_b16 v[20:21], v30 offset:64
  ds_read_b64_tr_b16 v[22:23], v30 offset:832
  v_mfma_f32_32x32x16_bf16 v[112:127], v[24:27], v[8:11], v[112:127]
  ds_read_b64_tr_b16 v[24:25], v30 offset:12352
  ds_read_b64_tr_b16 v[26:27], v30 offset:13120
  s_waitcnt lgkmcnt(6)
  v_mfma_f32_32x32x16_bf16 v[32:47], v[12:15], v[4:7], v[32:47]
  ds_read_b64_tr_b16 v[12:13], v30 offset:128
  ds_read_b64_tr_b16 v[14:15], v30 offset:896
  s_waitcnt lgkmcnt(6)
  v_mfma_f32_32x32x16_bf16 v[48:63], v[16:19], v[4:7], v[48:63]
  ds_read_b128 v[8:11], v29 offset:0
  ds_read_b64_tr_b16 v[16:17], v30 offset:12416
  ds_read_b64_tr_b16 v[18:19], v30 offset:13184
  s_waitcnt lgkmcnt(7)
  v_mfma_f32_32x32x16_bf16 v[64:79], v[20:23], v[4:7], v[64:79]
  ds_read_b64_tr_b16 v[20:21], v30 offset:3072
  ds_read_b64_tr_b16 v[22:23], v30 offset:3840
  s_waitcnt lgkmcnt(7)
  v_mfma_f32_32x32x16_bf16 v[80:95], v[24:27], v[4:7], v[80:95]
  ds_read_b64_tr_b16 v[24:25], v30 offset:15360
  ds_read_b64_tr_b16 v[26:27], v30 offset:16128
  s_waitcnt lgkmcnt(7)
  v_mfma_f32_32x32x16_bf16 v[96:111], v[12:15], v[4:7], v[96:111]
  ds_read_b64_tr_b16 v[12:13], v30 offset:3136
  ds_read_b64_tr_b16 v[14:15], v30 offset:3904
  s_waitcnt lgkmcnt(6)
  v_mfma_f32_32x32x16_bf16 v[112:127], v[16:19], v[4:7], v[112:127]
  ds_read_b64_tr_b16 v[16:17], v30 offset:15424
  ds_read_b64_tr_b16 v[18:19], v30 offset:16192
  s_waitcnt lgkmcnt(6)
  v_mfma_f32_32x32x16_bf16 v[32:47], v[20:23], v[8:11], v[32:47]
  ds_read_b64_tr_b16 v[20:21], v30 offset:3200
  ds_read_b64_tr_b16 v[22:23], v30 offset:3968
  s_waitcnt lgkmcnt(6)
  v_mfma_f32_32x32x16_bf16 v[48:63], v[24:27], v[8:11], v[48:63]
  ds_read_b128 v[4:7], v2 offset:0
  ds_read_b64_tr_b16 v[24:25], v30 offset:15488
  ds_read_b64_tr_b16 v[26:27], v30 offset:16256
  s_waitcnt lgkmcnt(7)
  v_mfma_f32_32x32x16_bf16 v[64:79], v[12:15], v[8:11], v[64:79]
  ds_read_b64_tr_b16 v[12:13], v30 offset:6144
  ds_read_b64_tr_b16 v[14:15], v30 offset:6912
  s_waitcnt lgkmcnt(7)
  v_mfma_f32_32x32x16_bf16 v[80:95], v[16:19], v[8:11], v[80:95]
  ds_read_b64_tr_b16 v[16:17], v30 offset:18432
  ds_read_b64_tr_b16 v[18:19], v30 offset:19200
  s_waitcnt lgkmcnt(7)
  v_mfma_f32_32x32x16_bf16 v[96:111], v[20:23], v[8:11], v[96:111]
  ds_read_b64_tr_b16 v[20:21], v30 offset:6208
  ds_read_b64_tr_b16 v[22:23], v30 offset:6976
  s_waitcnt lgkmcnt(6)
  v_mfma_f32_32x32x16_bf16 v[112:127], v[24:27], v[8:11], v[112:127]
  ds_read_b64_tr_b16 v[24:25], v30 offset:18496
  ds_read_b64_tr_b16 v[26:27], v30 offset:19264
  s_waitcnt lgkmcnt(6)
  v_mfma_f32_32x32x16_bf16 v[32:47], v[12:15], v[4:7], v[32:47]
  ds_read_b64_tr_b16 v[12:13], v30 offset:6272
  ds_read_b64_tr_b16 v[14:15], v30 offset:7040
  s_waitcnt lgkmcnt(6)
  v_mfma_f32_32x32x16_bf16 v[48:63], v[16:19], v[4:7], v[48:63]
  ds_read_b128 v[8:11], v3 offset:0
  ds_read_b64_tr_b16 v[16:17], v30 offset:18560
  ds_read_b64_tr_b16 v[18:19], v30 offset:19328
  s_waitcnt lgkmcnt(7)
  v_mfma_f32_32x32x16_bf16 v[64:79], v[20:23], v[4:7], v[64:79]
  ds_read_b64_tr_b16 v[20:21], v30 offset:9216
  ds_read_b64_tr_b16 v[22:23], v30 offset:9984
  s_waitcnt lgkmcnt(7)
  v_mfma_f32_32x32x16_bf16 v[80:95], v[24:27], v[4:7], v[80:95]
  ds_read_b64_tr_b16 v[24:25], v30 offset:21504
  ds_read_b64_tr_b16 v[26:27], v30 offset:22272
  s_waitcnt lgkmcnt(7)
  v_mfma_f32_32x32x16_bf16 v[96:111], v[12:15], v[4:7], v[96:111]
  ds_read_b64_tr_b16 v[12:13], v30 offset:9280
  ds_read_b64_tr_b16 v[14:15], v30 offset:10048
  s_waitcnt lgkmcnt(6)
  v_mfma_f32_32x32x16_bf16 v[112:127], v[16:19], v[4:7], v[112:127]
  ds_read_b64_tr_b16 v[16:17], v30 offset:21568
  ds_read_b64_tr_b16 v[18:19], v30 offset:22336
  s_waitcnt lgkmcnt(6)
  v_mfma_f32_32x32x16_bf16 v[32:47], v[20:23], v[8:11], v[32:47]
  ds_read_b64_tr_b16 v[20:21], v30 offset:9344
  ds_read_b64_tr_b16 v[22:23], v30 offset:10112
  s_waitcnt lgkmcnt(6)
  v_mfma_f32_32x32x16_bf16 v[48:63], v[24:27], v[8:11], v[48:63]
  ds_read_b64_tr_b16 v[24:25], v30 offset:21632
  ds_read_b64_tr_b16 v[26:27], v30 offset:22400
  s_waitcnt lgkmcnt(6)
  v_mfma_f32_32x32x16_bf16 v[64:79], v[12:15], v[8:11], v[64:79]
  s_waitcnt lgkmcnt(0)
  s_barrier
  ds_read_b128 v[4:7], v28 offset:40960
  ds_read_b64_tr_b16 v[12:13], v31 offset:0
  ds_read_b64_tr_b16 v[14:15], v31 offset:768
  v_mfma_f32_32x32x16_bf16 v[80:95], v[16:19], v[8:11], v[80:95]
  ds_read_b64_tr_b16 v[16:17], v31 offset:12288
  ds_read_b64_tr_b16 v[18:19], v31 offset:13056
  v_mfma_f32_32x32x16_bf16 v[96:111], v[20:23], v[8:11], v[96:111]
  ds_read_b64_tr_b16 v[20:21], v31 offset:64
  ds_read_b64_tr_b16 v[22:23], v31 offset:832
  v_mfma_f32_32x32x16_bf16 v[112:127], v[24:27], v[8:11], v[112:127]
  ds_read_b64_tr_b16 v[24:25], v31 offset:12352
  ds_read_b64_tr_b16 v[26:27], v31 offset:13120
  s_waitcnt lgkmcnt(6)
  v_mfma_f32_32x32x16_bf16 v[32:47], v[12:15], v[4:7], v[32:47]
  ds_read_b64_tr_b16 v[12:13], v31 offset:128
  ds_read_b64_tr_b16 v[14:15], v31 offset:896
  s_waitcnt lgkmcnt(6)
  v_mfma_f32_32x32x16_bf16 v[48:63], v[16:19], v[4:7], v[48:63]
  ds_read_b128 v[8:11], v29 offset:40960
  ds_read_b64_tr_b16 v[16:17], v31 offset:12416
  ds_read_b64_tr_b16 v[18:19], v31 offset:13184
  s_waitcnt lgkmcnt(7)
  v_mfma_f32_32x32x16_bf16 v[64:79], v[20:23], v[4:7], v[64:79]
  ds_read_b64_tr_b16 v[20:21], v31 offset:3072
  ds_read_b64_tr_b16 v[22:23], v31 offset:3840
  s_waitcnt lgkmcnt(7)
  v_mfma_f32_32x32x16_bf16 v[80:95], v[24:27], v[4:7], v[80:95]
  ds_read_b64_tr_b16 v[24:25], v31 offset:15360
  ds_read_b64_tr_b16 v[26:27], v31 offset:16128
  s_waitcnt lgkmcnt(7)
  v_mfma_f32_32x32x16_bf16 v[96:111], v[12:15], v[4:7], v[96:111]
  ds_read_b64_tr_b16 v[12:13], v31 offset:3136
  ds_read_b64_tr_b16 v[14:15], v31 offset:3904
  s_waitcnt lgkmcnt(6)
  v_mfma_f32_32x32x16_bf16 v[112:127], v[16:19], v[4:7], v[112:127]
  ds_read_b64_tr_b16 v[16:17], v31 offset:15424
  ds_read_b64_tr_b16 v[18:19], v31 offset:16192
  s_waitcnt lgkmcnt(6)
  v_mfma_f32_32x32x16_bf16 v[32:47], v[20:23], v[8:11], v[32:47]
  ds_read_b64_tr_b16 v[20:21], v31 offset:3200
  ds_read_b64_tr_b16 v[22:23], v31 offset:3968
  s_waitcnt lgkmcnt(6)
  v_mfma_f32_32x32x16_bf16 v[48:63], v[24:27], v[8:11], v[48:63]
  ds_read_b128 v[4:7], v2 offset:40960
  ds_read_b64_tr_b16 v[24:25], v31 offset:15488
  ds_read_b64_tr_b16 v[26:27], v31 offset:16256
  s_waitcnt lgkmcnt(7)
  v_mfma_f32_32x32x16_bf16 v[64:79], v[12:15], v[8:11], v[64:79]
  ds_read_b64_tr_b16 v[12:13], v31 offset:6144
  ds_read_b64_tr_b16 v[14:15], v31 offset:6912
  s_waitcnt lgkmcnt(7)
  v_mfma_f32_32x32x16_bf16 v[80:95], v[16:19], v[8:11], v[80:95]
  ds_read_b64_tr_b16 v[16:17], v31 offset:18432
  ds_read_b64_tr_b16 v[18:19], v31 offset:19200
  s_waitcnt lgkmcnt(7)
  v_mfma_f32_32x32x16_bf16 v[96:111], v[20:23], v[8:11], v[96:111]
  ds_read_b64_tr_b16 v[20:21], v31 offset:6208
  ds_read_b64_tr_b16 v[22:23], v31 offset:6976
  s_waitcnt lgkmcnt(6)
  v_mfma_f32_32x32x16_bf16 v[112:127], v[24:27], v[8:11], v[112:127]
  ds_read_b64_tr_b16 v[24:25], v31 offset:18496
  ds_read_b64_tr_b16 v[26:27], v31 offset:19264
  s_waitcnt lgkmcnt(6)
  v_mfma_f32_32x32x16_bf16 v[32:47], v[12:15], v[4:7], v[32:47]
  ds_read_b64_tr_b16 v[12:13], v31 offset:6272
  ds_read_b64_tr_b16 v[14:15], v31 offset:7040
  s_waitcnt lgkmcnt(6)
  v_mfma_f32_32x32x16_bf16 v[48:63], v[16:19], v[4:7], v[48:63]
  ds_read_b128 v[8:11], v3 offset:40960
  ds_read_b64_tr_b16 v[16:17], v31 offset:18560
  ds_read_b64_tr_b16 v[18:19], v31 offset:19328
  s_waitcnt lgkmcnt(7)
  v_mfma_f32_32x32x16_bf16 v[64:79], v[20:23], v[4:7], v[64:79]
  ds_read_b64_tr_b16 v[20:21], v31 offset:9216
  ds_read_b64_tr_b16 v[22:23], v31 offset:9984
  s_waitcnt lgkmcnt(7)
  v_mfma_f32_32x32x16_bf16 v[80:95], v[24:27], v[4:7], v[80:95]
  ds_read_b64_tr_b16 v[24:25], v31 offset:21504
  ds_read_b64_tr_b16 v[26:27], v31 offset:22272
  s_waitcnt lgkmcnt(7)
  v_mfma_f32_32x32x16_bf16 v[96:111], v[12:15], v[4:7], v[96:111]
  ds_read_b64_tr_b16 v[12:13], v31 offset:9280
  ds_read_b64_tr_b16 v[14:15], v31 offset:10048
  s_waitcnt lgkmcnt(6)
  v_mfma_f32_32x32x16_bf16 v[112:127], v[16:19], v[4:7], v[112:127]
  ds_read_b64_tr_b16 v[16:17], v31 offset:21568
  ds_read_b64_tr_b16 v[18:19], v31 offset:22336
  s_waitcnt lgkmcnt(6)
  v_mfma_f32_32x32x16_bf16 v[32:47], v[20:23], v[8:11], v[32:47]
  ds_read_b64_tr_b16 v[20:21], v31 offset:9344
  ds_read_b64_tr_b16 v[22:23], v31 offset:10112
  s_waitcnt lgkmcnt(6)
  v_mfma_f32_32x32x16_bf16 v[48:63], v[24:27], v[8:11], v[48:63]
  ds_read_b64_tr_b16 v[24:25], v31 offset:21632
  ds_read_b64_tr_b16 v[26:27], v31 offset:22400
  s_waitcnt lgkmcnt(6)
  v_mfma_f32_32x32x16_bf16 v[64:79], v[12:15], v[8:11], v[64:79]
  s_waitcnt lgkmcnt(0)
  s_barrier
  ds_read_b128 v[4:7], v28 offset:0
  ds_read_b64_tr_b16 v[12:13], v30 offset:0
  ds_read_b64_tr_b16 v[14:15], v30 offset:768
  v_mfma_f32_32x32x16_bf16 v[80:95], v[16:19], v[8:11], v[80:95]
  ds_read_b64_tr_b16 v[16:17], v30 offset:12288
  ds_read_b64_tr_b16 v[18:19], v30 offset:13056
  v_mfma_f32_32x32x16_bf16 v[96:111], v[20:23], v[8:11], v[96:111]
  ds_read_b64_tr_b16 v[20:21], v30 offset:64
  ds_read_b64_tr_b16 v[22:23], v30 offset:832
  v_mfma_f32_32x32x16_bf16 v[112:127], v[24:27], v[8:11], v[112:127]
  ds_read_b64_tr_b16 v[24:25], v30 offset:12352
  ds_read_b64_tr_b16 v[26:27], v30 offset:13120
  s_waitcnt lgkmcnt(6)
  v_mfma_f32_32x32x16_bf16 v[32:47], v[12:15], v[4:7], v[32:47]
  ds_read_b64_tr_b16 v[12:13], v30 offset:128
  ds_read_b64_tr_b16 v[14:15], v30 offset:896
  s_waitcnt lgkmcnt(6)
  v_mfma_f32_32x32x16_bf16 v[48:63], v[16:19], v[4:7], v[48:63]
  ds_read_b128 v[8:11], v29 offset:0
  ds_read_b64_tr_b16 v[16:17], v30 offset:12416
  ds_read_b64_tr_b16 v[18:19], v30 offset:13184
  s_waitcnt lgkmcnt(7)
  v_mfma_f32_32x32x16_bf16 v[64:79], v[20:23], v[4:7], v[64:79]
  ds_read_b64_tr_b16 v[20:21], v30 offset:3072
  ds_read_b64_tr_b16 v[22:23], v30 offset:3840
  s_waitcnt lgkmcnt(7)
  v_mfma_f32_32x32x16_bf16 v[80:95], v[24:27], v[4:7], v[80:95]
  ds_read_b64_tr_b16 v[24:25], v30 offset:15360
  ds_read_b64_tr_b16 v[26:27], v30 offset:16128
  s_waitcnt lgkmcnt(7)
  v_mfma_f32_32x32x16_bf16 v[96:111], v[12:15], v[4:7], v[96:111]
  ds_read_b64_tr_b16 v[12:13], v30 offset:3136
  ds_read_b64_tr_b16 v[14:15], v30 offset:3904
  s_waitcnt lgkmcnt(6)
  v_mfma_f32_32x32x16_bf16 v[112:127], v[16:19], v[4:7], v[112:127]
  ds_read_b64_tr_b16 v[16:17], v30 offset:15424
  ds_read_b64_tr_b16 v[18:19], v30 offset:16192
  s_waitcnt lgkmcnt(6)
  v_mfma_f32_32x32x16_bf16 v[32:47], v[20:23], v[8:11], v[32:47]
  ds_read_b64_tr_b16 v[20:21], v30 offset:3200
  ds_read_b64_tr_b16 v[22:23], v30 offset:3968
  s_waitcnt lgkmcnt(6)
  v_mfma_f32_32x32x16_bf16 v[48:63], v[24:27], v[8:11], v[48:63]
  ds_read_b128 v[4:7], v2 offset:0
  ds_read_b64_tr_b16 v[24:25], v30 offset:15488
  ds_read_b64_tr_b16 v[26:27], v30 offset:16256
  s_waitcnt lgkmcnt(7)
  v_mfma_f32_32x32x16_bf16 v[64:79], v[12:15], v[8:11], v[64:79]
  ds_read_b64_tr_b16 v[12:13], v30 offset:6144
  ds_read_b64_tr_b16 v[14:15], v30 offset:6912
  s_waitcnt lgkmcnt(7)
  v_mfma_f32_32x32x16_bf16 v[80:95], v[16:19], v[8:11], v[80:95]
  ds_read_b64_tr_b16 v[16:17], v30 offset:18432
  ds_read_b64_tr_b16 v[18:19], v30 offset:19200
  s_waitcnt lgkmcnt(7)
  v_mfma_f32_32x32x16_bf16 v[96:111], v[20:23], v[8:11], v[96:111]
  ds_read_b64_tr_b16 v[20:21], v30 offset:6208
  ds_read_b64_tr_b16 v[22:23], v30 offset:6976
  s_waitcnt lgkmcnt(6)
  v_mfma_f32_32x32x16_bf16 v[112:127], v[24:27], v[8:11], v[112:127]
  ds_read_b64_tr_b16 v[24:25], v30 offset:18496
  ds_read_b64_tr_b16 v[26:27], v30 offset:19264
  s_waitcnt lgkmcnt(6)
  v_mfma_f32_32x32x16_bf16 v[32:47], v[12:15], v[4:7], v[32:47]
  ds_read_b64_tr_b16 v[12:13], v30 offset:6272
  ds_read_b64_tr_b16 v[14:15], v30 offset:7040
  s_waitcnt lgkmcnt(6)
  v_mfma_f32_32x32x16_bf16 v[48:63], v[16:19], v[4:7], v[48:63]
  ds_read_b128 v[8:11], v3 offset:0
  ds_read_b64_tr_b16 v[16:17], v30 offset:18560
  ds_read_b64_tr_b16 v[18:19], v30 offset:19328
  s_waitcnt lgkmcnt(7)
  v_mfma_f32_32x32x16_bf16 v[64:79], v[20:23], v[4:7], v[64:79]
  ds_read_b64_tr_b16 v[20:21], v30 offset:9216
  ds_read_b64_tr_b16 v[22:23], v30 offset:9984
  s_waitcnt lgkmcnt(7)
  v_mfma_f32_32x32x16_bf16 v[80:95], v[24:27], v[4:7], v[80:95]
  ds_read_b64_tr_b16 v[24:25], v30 offset:21504
  ds_read_b64_tr_b16 v[26:27], v30 offset:22272
  s_waitcnt lgkmcnt(7)
  v_mfma_f32_32x32x16_bf16 v[96:111], v[12:15], v[4:7], v[96:111]
  ds_read_b64_tr_b16 v[12:13], v30 offset:9280
  ds_read_b64_tr_b16 v[14:15], v30 offset:10048
  s_waitcnt lgkmcnt(6)
  v_mfma_f32_32x32x16_bf16 v[112:127], v[16:19], v[4:7], v[112:127]
  ds_read_b64_tr_b16 v[16:17], v30 offset:21568
  ds_read_b64_tr_b16 v[18:19], v30 offset:22336
  s_waitcnt lgkmcnt(6)
  v_mfma_f32_32x32x16_bf16 v[32:47], v[20:23], v[8:11], v[32:47]
  ds_read_b64_tr_b16 v[20:21], v30 offset:9344
  ds_read_b64_tr_b16 v[22:23], v30 offset:10112
  s_waitcnt lgkmcnt(6)
  v_mfma_f32_32x32x16_bf16 v[48:63], v[24:27], v[8:11], v[48:63]
  ds_read_b64_tr_b16 v[24:25], v30 offset:21632
  ds_read_b64_tr_b16 v[26:27], v30 offset:22400
  s_waitcnt lgkmcnt(6)
  v_mfma_f32_32x32x16_bf16 v[64:79], v[12:15], v[8:11], v[64:79]
  s_waitcnt lgkmcnt(0)
  s_barrier
  ds_read_b128 v[4:7], v28 offset:40960
  ds_read_b64_tr_b16 v[12:13], v31 offset:0
  ds_read_b64_tr_b16 v[14:15], v31 offset:768
  v_mfma_f32_32x32x16_bf16 v[80:95], v[16:19], v[8:11], v[80:95]
  ds_read_b64_tr_b16 v[16:17], v31 offset:12288
  ds_read_b64_tr_b16 v[18:19], v31 offset:13056
  v_mfma_f32_32x32x16_bf16 v[96:111], v[20:23], v[8:11], v[96:111]
  ds_read_b64_tr_b16 v[20:21], v31 offset:64
  ds_read_b64_tr_b16 v[22:23], v31 offset:832
  v_mfma_f32_32x32x16_bf16 v[112:127], v[24:27], v[8:11], v[112:127]
  ds_read_b64_tr_b16 v[24:25], v31 offset:12352
  ds_read_b64_tr_b16 v[26:27], v31 offset:13120
  s_waitcnt lgkmcnt(6)
  v_mfma_f32_32x32x16_bf16 v[32:47], v[12:15], v[4:7], v[32:47]
  ds_read_b64_tr_b16 v[12:13], v31 offset:128
  ds_read_b64_tr_b16 v[14:15], v31 offset:896
  s_waitcnt lgkmcnt(6)
  v_mfma_f32_32x32x16_bf16 v[48:63], v[16:19], v[4:7], v[48:63]
  ds_read_b128 v[8:11], v29 offset:40960
  ds_read_b64_tr_b16 v[16:17], v31 offset:12416
  ds_read_b64_tr_b16 v[18:19], v31 offset:13184
  s_waitcnt lgkmcnt(7)
  v_mfma_f32_32x32x16_bf16 v[64:79], v[20:23], v[4:7], v[64:79]
  ds_read_b64_tr_b16 v[20:21], v31 offset:3072
  ds_read_b64_tr_b16 v[22:23], v31 offset:3840
  s_waitcnt lgkmcnt(7)
  v_mfma_f32_32x32x16_bf16 v[80:95], v[24:27], v[4:7], v[80:95]
  ds_read_b64_tr_b16 v[24:25], v31 offset:15360
  ds_read_b64_tr_b16 v[26:27], v31 offset:16128
  s_waitcnt lgkmcnt(7)
  v_mfma_f32_32x32x16_bf16 v[96:111], v[12:15], v[4:7], v[96:111]
  ds_read_b64_tr_b16 v[12:13], v31 offset:3136
  ds_read_b64_tr_b16 v[14:15], v31 offset:3904
  s_waitcnt lgkmcnt(6)
  v_mfma_f32_32x32x16_bf16 v[112:127], v[16:19], v[4:7], v[112:127]
  ds_read_b64_tr_b16 v[16:17], v31 offset:15424
  ds_read_b64_tr_b16 v[18:19], v31 offset:16192
  s_waitcnt lgkmcnt(6)
  v_mfma_f32_32x32x16_bf16 v[32:47], v[20:23], v[8:11], v[32:47]
  ds_read_b64_tr_b16 v[20:21], v31 offset:3200
  ds_read_b64_tr_b16 v[22:23], v31 offset:3968
  s_waitcnt lgkmcnt(6)
  v_mfma_f32_32x32x16_bf16 v[48:63], v[24:27], v[8:11], v[48:63]
  ds_read_b128 v[4:7], v2 offset:40960
  ds_read_b64_tr_b16 v[24:25], v31 offset:15488
  ds_read_b64_tr_b16 v[26:27], v31 offset:16256
  s_waitcnt lgkmcnt(7)
  v_mfma_f32_32x32x16_bf16 v[64:79], v[12:15], v[8:11], v[64:79]
  ds_read_b64_tr_b16 v[12:13], v31 offset:6144
  ds_read_b64_tr_b16 v[14:15], v31 offset:6912
  s_waitcnt lgkmcnt(7)
  v_mfma_f32_32x32x16_bf16 v[80:95], v[16:19], v[8:11], v[80:95]
  ds_read_b64_tr_b16 v[16:17], v31 offset:18432
  ds_read_b64_tr_b16 v[18:19], v31 offset:19200
  s_waitcnt lgkmcnt(7)
  v_mfma_f32_32x32x16_bf16 v[96:111], v[20:23], v[8:11], v[96:111]
  ds_read_b64_tr_b16 v[20:21], v31 offset:6208
  ds_read_b64_tr_b16 v[22:23], v31 offset:6976
  s_waitcnt lgkmcnt(6)
  v_mfma_f32_32x32x16_bf16 v[112:127], v[24:27], v[8:11], v[112:127]
  ds_read_b64_tr_b16 v[24:25], v31 offset:18496
  ds_read_b64_tr_b16 v[26:27], v31 offset:19264
  s_waitcnt lgkmcnt(6)
  v_mfma_f32_32x32x16_bf16 v[32:47], v[12:15], v[4:7], v[32:47]
  ds_read_b64_tr_b16 v[12:13], v31 offset:6272
  ds_read_b64_tr_b16 v[14:15], v31 offset:7040
  s_waitcnt lgkmcnt(6)
  v_mfma_f32_32x32x16_bf16 v[48:63], v[16:19], v[4:7], v[48:63]
  ds_read_b128 v[8:11], v3 offset:40960
  ds_read_b64_tr_b16 v[16:17], v31 offset:18560
  ds_read_b64_tr_b16 v[18:19], v31 offset:19328
  s_waitcnt lgkmcnt(7)
  v_mfma_f32_32x32x16_bf16 v[64:79], v[20:23], v[4:7], v[64:79]
  ds_read_b64_tr_b16 v[20:21], v31 offset:9216
  ds_read_b64_tr_b16 v[22:23], v31 offset:9984
  s_waitcnt lgkmcnt(7)
  v_mfma_f32_32x32x16_bf16 v[80:95], v[24:27], v[4:7], v[80:95]
  ds_read_b64_tr_b16 v[24:25], v31 offset:21504
  ds_read_b64_tr_b16 v[26:27], v31 offset:22272
  s_waitcnt lgkmcnt(7)
  v_mfma_f32_32x32x16_bf16 v[96:111], v[12:15], v[4:7], v[96:111]
  ds_read_b64_tr_b16 v[12:13], v31 offset:9280
  ds_read_b64_tr_b16 v[14:15], v31 offset:10048
  s_waitcnt lgkmcnt(6)
  v_mfma_f32_32x32x16_bf16 v[112:127], v[16:19], v[4:7], v[112:127]
  ds_read_b64_tr_b16 v[16:17], v31 offset:21568
  ds_read_b64_tr_b16 v[18:19], v31 offset:22336
  s_waitcnt lgkmcnt(6)
  v_mfma_f32_32x32x16_bf16 v[32:47], v[20:23], v[8:11], v[32:47]
  ds_read_b64_tr_b16 v[20:21], v31 offset:9344
  ds_read_b64_tr_b16 v[22:23], v31 offset:10112
  s_waitcnt lgkmcnt(6)
  v_mfma_f32_32x32x16_bf16 v[48:63], v[24:27], v[8:11], v[48:63]
  ds_read_b64_tr_b16 v[24:25], v31 offset:21632
  ds_read_b64_tr_b16 v[26:27], v31 offset:22400
  s_waitcnt lgkmcnt(6)
  v_mfma_f32_32x32x16_bf16 v[64:79], v[12:15], v[8:11], v[64:79]
  s_waitcnt lgkmcnt(4)
  v_mfma_f32_32x32x16_bf16 v[80:95], v[16:19], v[8:11], v[80:95]
  s_waitcnt lgkmcnt(2)
  v_mfma_f32_32x32x16_bf16 v[96:111], v[20:23], v[8:11], v[96:111]
  s_waitcnt lgkmcnt(0)
  v_mfma_f32_32x32x16_bf16 v[112:127], v[24:27], v[8:11], v[112:127]
  s_setprio 3
  s_nop 7
  s_nop 7
  v_and_b32 v1, 63, v0
  s_mov_b32 s26, 0xbfb8aa3b
  v_and_b32 v12, 31, v1
  s_lshl_b32 s27, s22, 7
  s_lshl_b32 s28, s20, 5
  s_add_u32 s27, s27, s28
  v_add_u32 v12, s27, v12
  v_lshrrev_b32 v13, 4, v12
  s_mov_b32 s28, 49152
  v_mul_lo_u32 v13, v13, s28
  v_and_b32 v12, 15, v12
  v_lshlrev_b32 v12, 4, v12
  v_add_u32 v13, v13, v12
  v_lshrrev_b32 v12, 5, v1
  v_lshlrev_b32 v12, 8, v12
  v_add_u32 v28, v13, v12
  s_mul_i32 s27, s21, 3072
  s_add_u32 s27, s27, 4194304
  v_mul_f32 v4, s26, v32
  v_mul_f32 v5, s26, v33
  v_mul_f32 v6, s26, v34
  v_mul_f32 v7, s26, v35
  v_mul_f32 v8, s26, v36
  v_mul_f32 v9, s26, v37
  v_mul_f32 v10, s26, v38
  v_mul_f32 v11, s26, v39
  v_exp_f32 v4, v4
  v_exp_f32 v5, v5
  v_exp_f32 v6, v6
  v_exp_f32 v7, v7
  v_exp_f32 v8, v8
  v_exp_f32 v9, v9
  v_exp_f32 v10, v10
  v_exp_f32 v11, v11
  v_mul_f32 v32, v32, v48
  v_mul_f32 v33, v33, v49
  v_mul_f32 v34, v34, v50
  v_mul_f32 v35, v35, v51
  v_mul_f32 v36, v36, v52
  v_mul_f32 v37, v37, v53
  v_mul_f32 v38, v38, v54
  v_mul_f32 v39, v39, v55
  v_add_f32 v4, 1.0, v4
  v_add_f32 v5, 1.0, v5
  v_add_f32 v6, 1.0, v6
  v_add_f32 v7, 1.0, v7
  v_add_f32 v8, 1.0, v8
  v_add_f32 v9, 1.0, v9
  v_add_f32 v10, 1.0, v10
  v_add_f32 v11, 1.0, v11
  v_rcp_f32 v4, v4
  v_rcp_f32 v5, v5
  v_rcp_f32 v6, v6
  v_rcp_f32 v7, v7
  v_rcp_f32 v8, v8
  v_rcp_f32 v9, v9
  v_rcp_f32 v10, v10
  v_rcp_f32 v11, v11
  s_nop 0
  v_mul_f32 v32, v32, v4
  v_mul_f32 v33, v33, v5
  v_mul_f32 v34, v34, v6
  v_mul_f32 v35, v35, v7
  v_mul_f32 v36, v36, v8
  v_mul_f32 v37, v37, v9
  v_mul_f32 v38, v38, v10
  v_mul_f32 v39, v39, v11
  v_mul_f32 v4, s26, v40
  v_mul_f32 v5, s26, v41
  v_mul_f32 v6, s26, v42
  v_mul_f32 v7, s26, v43
  v_mul_f32 v8, s26, v44
  v_mul_f32 v9, s26, v45
  v_mul_f32 v10, s26, v46
  v_mul_f32 v11, s26, v47
  v_exp_f32 v4, v4
  v_exp_f32 v5, v5
  v_exp_f32 v6, v6
  v_exp_f32 v7, v7
  v_exp_f32 v8, v8
  v_exp_f32 v9, v9
  v_exp_f32 v10, v10
  v_exp_f32 v11, v11
  v_mul_f32 v40, v40, v56
  v_mul_f32 v41, v41, v57
  v_mul_f32 v42, v42, v58
  v_mul_f32 v43, v43, v59
  v_mul_f32 v44, v44, v60
  v_mul_f32 v45, v45, v61
  v_mul_f32 v46, v46, v62
  v_mul_f32 v47, v47, v63
  v_add_f32 v4, 1.0, v4
  v_add_f32 v5, 1.0, v5
  v_add_f32 v6, 1.0, v6
  v_add_f32 v7, 1.0, v7
  v_add_f32 v8, 1.0, v8
  v_add_f32 v9, 1.0, v9
  v_add_f32 v10, 1.0, v10
  v_add_f32 v11, 1.0, v11
  v_rcp_f32 v4, v4
  v_rcp_f32 v5, v5
  v_rcp_f32 v6, v6
  v_rcp_f32 v7, v7
  v_rcp_f32 v8, v8
  v_rcp_f32 v9, v9
  v_rcp_f32 v10, v10
  v_rcp_f32 v11, v11
  s_nop 0
  v_mul_f32 v40, v40, v4
  v_mul_f32 v41, v41, v5
  v_mul_f32 v42, v42, v6
  v_mul_f32 v43, v43, v7
  v_mul_f32 v44, v44, v8
  v_mul_f32 v45, v45, v9
  v_mul_f32 v46, v46, v10
  v_mul_f32 v47, v47, v11
  v_cvt_pk_bf16_f32 v48, v32, v33
  v_cvt_pk_bf16_f32 v49, v34, v35
  v_cvt_pk_bf16_f32 v50, v40, v41
  v_cvt_pk_bf16_f32 v51, v42, v43
  v_cvt_pk_bf16_f32 v52, v36, v37
  v_cvt_pk_bf16_f32 v53, v38, v39
  v_cvt_pk_bf16_f32 v54, v44, v45
  v_cvt_pk_bf16_f32 v55, v46, v47
  buffer_store_dwordx4 v[48:51], v28, s[12:15], s27 offen offset:0 sc1
  buffer_store_dwordx4 v[52:55], v28, s[12:15], s27 offen offset:512 sc1
  v_mul_f32 v4, s26, v64
  v_mul_f32 v5, s26, v65
  v_mul_f32 v6, s26, v66
  v_mul_f32 v7, s26, v67
  v_mul_f32 v8, s26, v68
  v_mul_f32 v9, s26, v69
  v_mul_f32 v10, s26, v70
  v_mul_f32 v11, s26, v71
  v_exp_f32 v4, v4
  v_exp_f32 v5, v5
  v_exp_f32 v6, v6
  v_exp_f32 v7, v7
  v_exp_f32 v8, v8
  v_exp_f32 v9, v9
  v_exp_f32 v10, v10
  v_exp_f32 v11, v11
  v_mul_f32 v64, v64, v80
  v_mul_f32 v65, v65, v81
  v_mul_f32 v66, v66, v82
  v_mul_f32 v67, v67, v83
  v_mul_f32 v68, v68, v84
  v_mul_f32 v69, v69, v85
  v_mul_f32 v70, v70, v86
  v_mul_f32 v71, v71, v87
  v_add_f32 v4, 1.0, v4
  v_add_f32 v5, 1.0, v5
  v_add_f32 v6, 1.0, v6
  v_add_f32 v7, 1.0, v7
  v_add_f32 v8, 1.0, v8
  v_add_f32 v9, 1.0, v9
  v_add_f32 v10, 1.0, v10
  v_add_f32 v11, 1.0, v11
  v_rcp_f32 v4, v4
  v_rcp_f32 v5, v5
  v_rcp_f32 v6, v6
  v_rcp_f32 v7, v7
  v_rcp_f32 v8, v8
  v_rcp_f32 v9, v9
  v_rcp_f32 v10, v10
  v_rcp_f32 v11, v11
  s_nop 0
  v_mul_f32 v64, v64, v4
  v_mul_f32 v65, v65, v5
  v_mul_f32 v66, v66, v6
  v_mul_f32 v67, v67, v7
  v_mul_f32 v68, v68, v8
  v_mul_f32 v69, v69, v9
  v_mul_f32 v70, v70, v10
  v_mul_f32 v71, v71, v11
  v_mul_f32 v4, s26, v72
  v_mul_f32 v5, s26, v73
  v_mul_f32 v6, s26, v74
  v_mul_f32 v7, s26, v75
  v_mul_f32 v8, s26, v76
  v_mul_f32 v9, s26, v77
  v_mul_f32 v10, s26, v78
  v_mul_f32 v11, s26, v79
  v_exp_f32 v4, v4
  v_exp_f32 v5, v5
  v_exp_f32 v6, v6
  v_exp_f32 v7, v7
  v_exp_f32 v8, v8
  v_exp_f32 v9, v9
  v_exp_f32 v10, v10
  v_exp_f32 v11, v11
  v_mul_f32 v72, v72, v88
  v_mul_f32 v73, v73, v89
  v_mul_f32 v74, v74, v90
  v_mul_f32 v75, v75, v91
  v_mul_f32 v76, v76, v92
  v_mul_f32 v77, v77, v93
  v_mul_f32 v78, v78, v94
  v_mul_f32 v79, v79, v95
  v_add_f32 v4, 1.0, v4
  v_add_f32 v5, 1.0, v5
  v_add_f32 v6, 1.0, v6
  v_add_f32 v7, 1.0, v7
  v_add_f32 v8, 1.0, v8
  v_add_f32 v9, 1.0, v9
  v_add_f32 v10, 1.0, v10
  v_add_f32 v11, 1.0, v11
  v_rcp_f32 v4, v4
  v_rcp_f32 v5, v5
  v_rcp_f32 v6, v6
  v_rcp_f32 v7, v7
  v_rcp_f32 v8, v8
  v_rcp_f32 v9, v9
  v_rcp_f32 v10, v10
  v_rcp_f32 v11, v11
  s_nop 0
  v_mul_f32 v72, v72, v4
  v_mul_f32 v73, v73, v5
  v_mul_f32 v74, v74, v6
  v_mul_f32 v75, v75, v7
  v_mul_f32 v76, v76, v8
  v_mul_f32 v77, v77, v9
  v_mul_f32 v78, v78, v10
  v_mul_f32 v79, v79, v11
  v_cvt_pk_bf16_f32 v80, v64, v65
  v_cvt_pk_bf16_f32 v81, v66, v67
  v_cvt_pk_bf16_f32 v82, v72, v73
  v_cvt_pk_bf16_f32 v83, v74, v75
  v_cvt_pk_bf16_f32 v84, v68, v69
  v_cvt_pk_bf16_f32 v85, v70, v71
  v_cvt_pk_bf16_f32 v86, v76, v77
  v_cvt_pk_bf16_f32 v87, v78, v79
  buffer_store_dwordx4 v[80:83], v28, s[12:15], s27 offen offset:1024 sc1
  buffer_store_dwordx4 v[84:87], v28, s[12:15], s27 offen offset:1536 sc1
  v_mul_f32 v4, s26, v96
  v_mul_f32 v5, s26, v97
  v_mul_f32 v6, s26, v98
  v_mul_f32 v7, s26, v99
  v_mul_f32 v8, s26, v100
  v_mul_f32 v9, s26, v101
  v_mul_f32 v10, s26, v102
  v_mul_f32 v11, s26, v103
  v_exp_f32 v4, v4
  v_exp_f32 v5, v5
  v_exp_f32 v6, v6
  v_exp_f32 v7, v7
  v_exp_f32 v8, v8
  v_exp_f32 v9, v9
  v_exp_f32 v10, v10
  v_exp_f32 v11, v11
  v_mul_f32 v96, v96, v112
  v_mul_f32 v97, v97, v113
  v_mul_f32 v98, v98, v114
  v_mul_f32 v99, v99, v115
  v_mul_f32 v100, v100, v116
  v_mul_f32 v101, v101, v117
  v_mul_f32 v102, v102, v118
  v_mul_f32 v103, v103, v119
  v_add_f32 v4, 1.0, v4
  v_add_f32 v5, 1.0, v5
  v_add_f32 v6, 1.0, v6
  v_add_f32 v7, 1.0, v7
  v_add_f32 v8, 1.0, v8
  v_add_f32 v9, 1.0, v9
  v_add_f32 v10, 1.0, v10
  v_add_f32 v11, 1.0, v11
  v_rcp_f32 v4, v4
  v_rcp_f32 v5, v5
  v_rcp_f32 v6, v6
  v_rcp_f32 v7, v7
  v_rcp_f32 v8, v8
  v_rcp_f32 v9, v9
  v_rcp_f32 v10, v10
  v_rcp_f32 v11, v11
  s_nop 0
  v_mul_f32 v96, v96, v4
  v_mul_f32 v97, v97, v5
  v_mul_f32 v98, v98, v6
  v_mul_f32 v99, v99, v7
  v_mul_f32 v100, v100, v8
  v_mul_f32 v101, v101, v9
  v_mul_f32 v102, v102, v10
  v_mul_f32 v103, v103, v11
  v_mul_f32 v4, s26, v104
  v_mul_f32 v5, s26, v105
  v_mul_f32 v6, s26, v106
  v_mul_f32 v7, s26, v107
  v_mul_f32 v8, s26, v108
  v_mul_f32 v9, s26, v109
  v_mul_f32 v10, s26, v110
  v_mul_f32 v11, s26, v111
  v_exp_f32 v4, v4
  v_exp_f32 v5, v5
  v_exp_f32 v6, v6
  v_exp_f32 v7, v7
  v_exp_f32 v8, v8
  v_exp_f32 v9, v9
  v_exp_f32 v10, v10
  v_exp_f32 v11, v11
  v_mul_f32 v104, v104, v120
  v_mul_f32 v105, v105, v121
  v_mul_f32 v106, v106, v122
  v_mul_f32 v107, v107, v123
  v_mul_f32 v108, v108, v124
  v_mul_f32 v109, v109, v125
  v_mul_f32 v110, v110, v126
  v_mul_f32 v111, v111, v127
  v_add_f32 v4, 1.0, v4
  v_add_f32 v5, 1.0, v5
  v_add_f32 v6, 1.0, v6
  v_add_f32 v7, 1.0, v7
  v_add_f32 v8, 1.0, v8
  v_add_f32 v9, 1.0, v9
  v_add_f32 v10, 1.0, v10
  v_add_f32 v11, 1.0, v11
  v_rcp_f32 v4, v4
  v_rcp_f32 v5, v5
  v_rcp_f32 v6, v6
  v_rcp_f32 v7, v7
  v_rcp_f32 v8, v8
  v_rcp_f32 v9, v9
  v_rcp_f32 v10, v10
  v_rcp_f32 v11, v11
  s_nop 0
  v_mul_f32 v104, v104, v4
  v_mul_f32 v105, v105, v5
  v_mul_f32 v106, v106, v6
  v_mul_f32 v107, v107, v7
  v_mul_f32 v108, v108, v8
  v_mul_f32 v109, v109, v9
  v_mul_f32 v110, v110, v10
  v_mul_f32 v111, v111, v11
  v_cvt_pk_bf16_f32 v112, v96, v97
  v_cvt_pk_bf16_f32 v113, v98, v99
  v_cvt_pk_bf16_f32 v114, v104, v105
  v_cvt_pk_bf16_f32 v115, v106, v107
  v_cvt_pk_bf16_f32 v116, v100, v101
  v_cvt_pk_bf16_f32 v117, v102, v103
  v_cvt_pk_bf16_f32 v118, v108, v109
  v_cvt_pk_bf16_f32 v119, v110, v111
  buffer_store_dwordx4 v[112:115], v28, s[12:15], s27 offen offset:2048 sc1
  buffer_store_dwordx4 v[116:119], v28, s[12:15], s27 offen offset:2560 sc1
  s_waitcnt vmcnt(0)
  s_branch sa_end_54
sa_load_53:
  s_setprio 3
  s_sub_u32 s24, s20, 4
  s_lshl_b32 s26, s22, 2
  s_add_u32 s26, s26, s24
  s_mul_i32 s26, s26, 40960
  v_lshrrev_b32 v2, 3, v1
  v_lshrrev_b32 v3, 4, v1
  v_mul_u32_u24 v2, 1280, v2
  v_xor_b32 v3, v3, v1
  v_and_b32 v3, 7, v3
  v_lshlrev_b32 v3, 4, v3
  v_add3_u32 v4, v2, v3, s26
  v_xor_b32 v5, 64, v4
  s_and_b32 s26, s24, 1
  s_mul_i32 s26, s26, 98304
  s_mul_i32 s27, s21, 192
  s_add_u32 s26, s26, s27
  s_movk_i32 s28, 2880
  v_lshlrev_b32 v2, 4, v1
  v_add_u32 v2, s26, v2
  v_add_u32 v3, 0, v1
  v_mul_u32_u24 v3, 5462, v3
  v_lshrrev_b32 v3, 16, v3
  v_mad_u32_u24 v14, v3, s28, v2
  v_add_u32 v3, 64, v1
  v_mul_u32_u24 v3, 5462, v3
  v_lshrrev_b32 v3, 16, v3
  v_mad_u32_u24 v15, v3, s28, v2
  v_add_u32 v15, 1024, v15
  v_add_u32 v3, 128, v1
  v_mul_u32_u24 v3, 5462, v3
  v_lshrrev_b32 v3, 16, v3
  v_mad_u32_u24 v16, v3, s28, v2
  v_add_u32 v16, 2048, v16
  s_cmp_ge_u32 s24, 2
  s_cselect_b32 s48, s16, s8
  s_cselect_b32 s49, s17, s9
  s_cselect_b32 s50, s18, s10
  s_mov_b32 s51, 0x00020000
  s_lshl_b32 s31, s24, 12
  s_mul_i32 s32, s24, 6144
  s_add_u32 s32, s32, 16384
  s_add_u32 m0, s31, 0
  s_mov_b32 s33, 0
  buffer_load_dwordx4 v4, s[4:7], s33 offen lds
  s_add_u32 m0, s31, 1024
  s_mov_b32 s33, 10240
  buffer_load_dwordx4 v5, s[4:7], s33 offen lds
  s_add_u32 m0, s31, 2048
  s_mov_b32 s33, 20480
  buffer_load_dwordx4 v4, s[4:7], s33 offen lds
  s_add_u32 m0, s31, 3072
  s_mov_b32 s33, 30720
  buffer_load_dwordx4 v5, s[4:7], s33 offen lds
  s_add_u32 m0, s32, 0
  s_mov_b32 s33, 0
  buffer_load_dwordx4 v14, s[48:51], s33 offen lds
  s_add_u32 m0, s32, 1024
  s_mov_b32 s33, 0
  buffer_load_dwordx4 v15, s[48:51], s33 offen lds
  s_add_u32 m0, s32, 2048
  s_mov_b32 s33, 0
  buffer_load_dwordx4 v16, s[48:51], s33 offen lds
  s_add_u32 m0, s32, 3072
  s_mov_b32 s33, 49152
  buffer_load_dwordx4 v14, s[48:51], s33 offen lds
  s_add_u32 m0, s32, 4096
  s_mov_b32 s33, 49152
  buffer_load_dwordx4 v15, s[48:51], s33 offen lds
  s_add_u32 m0, s32, 5120
  s_mov_b32 s33, 49152
  buffer_load_dwordx4 v16, s[48:51], s33 offen lds
  s_add_u32 m0, s31, 40960
  s_mov_b32 s33, 128
  buffer_load_dwordx4 v4, s[4:7], s33 offen lds
  s_add_u32 m0, s31, 41984
  s_mov_b32 s33, 10368
  buffer_load_dwordx4 v5, s[4:7], s33 offen lds
  s_add_u32 m0, s31, 43008
  s_mov_b32 s33, 20608
  buffer_load_dwordx4 v4, s[4:7], s33 offen lds
  s_add_u32 m0, s31, 44032
  s_mov_b32 s33, 30848
  buffer_load_dwordx4 v5, s[4:7], s33 offen lds
  s_add_u32 m0, s32, 40960
  s_mov_b32 s33, 196608
  buffer_load_dwordx4 v14, s[48:51], s33 offen lds
  s_add_u32 m0, s32, 41984
  s_mov_b32 s33, 196608
  buffer_load_dwordx4 v15, s[48:51], s33 offen lds
  s_add_u32 m0, s32, 43008
  s_mov_b32 s33, 196608
  buffer_load_dwordx4 v16, s[48:51], s33 offen lds
  s_add_u32 m0, s32, 44032
  s_mov_b32 s33, 245760
  buffer_load_dwordx4 v14, s[48:51], s33 offen lds
  s_add_u32 m0, s32, 45056
  s_mov_b32 s33, 245760
  buffer_load_dwordx4 v15, s[48:51], s33 offen lds
  s_add_u32 m0, s32, 46080
  s_mov_b32 s33, 245760
  buffer_load_dwordx4 v16, s[48:51], s33 offen lds
  s_lshr_b32 s41, s2, 3
  s_cmp_lt_u32 s24, 2
  s_cbranch_scc1 pfx_55
  v_mul_u32_u24 v22, 5462, v1
  v_lshrrev_b32 v22, 16, v22
  v_mul_u32_u24 v23, 12, v22
  v_sub_u32 v23, v1, v23
  v_cmp_lt_u32 vcc, 5, v23
  v_lshlrev_b32 v22, 6, v22
  v_addc_co_u32 v22, vcc, 0, v22, vcc
  v_cmp_lt_u32 vcc, 5, v23
  v_subrev_u32 v20, 6, v23
  v_cndmask_b32 v23, v23, v20, vcc
  v_mul_u32_u24 v22, 3072, v22
  v_lshlrev_b32 v23, 7, v23
  s_mul_i32 s40, s41, 6144
  s_and_b32 s42, s2, 3
  s_mul_i32 s42, s42, 768
  s_add_u32 s40, s40, s42
  v_add3_u32 v20, v22, v23, s40
  v_cmp_gt_u32 vcc, 60, v1
  s_and_saveexec_b64 s[42:43], vcc
  buffer_load_dword v21, v20, s[48:51], 0 offen
  s_mov_b64 exec, -1
  s_branch pfe_56
pfx_55:
  v_and_b32 v22, 31, v1
  v_mul_u32_u24 v22, 1280, v22
  v_lshrrev_b32 v23, 5, v1
  v_lshlrev_b32 v23, 7, v23
  s_bfe_u32 s40, s2, 0x10002
  s_lshl_b32 s40, s40, 5
  s_add_u32 s40, s40, s41
  s_mul_i32 s40, s40, 40960
  s_lshl_b32 s42, s24, 8
  s_add_u32 s40, s40, s42
  s_add_u32 s40, s40, 256
  v_add3_u32 v20, v22, v23, s40
  buffer_load_dword v21, v20, s[4:7], 0 offen
pfe_56:
  s_waitcnt vmcnt(11)
  s_barrier
  s_waitcnt vmcnt(1)
  s_barrier
  s_add_u32 m0, s31, 0
  s_mov_b32 s33, 256
  buffer_load_dwordx4 v4, s[4:7], s33 offen lds
  s_add_u32 m0, s31, 1024
  s_mov_b32 s33, 10496
  buffer_load_dwordx4 v5, s[4:7], s33 offen lds
  s_add_u32 m0, s31, 2048
  s_mov_b32 s33, 20736
  buffer_load_dwordx4 v4, s[4:7], s33 offen lds
  s_add_u32 m0, s31, 3072
  s_mov_b32 s33, 30976
  buffer_load_dwordx4 v5, s[4:7], s33 offen lds
  s_add_u32 m0, s32, 0
  s_mov_b32 s33, 393216
  buffer_load_dwordx4 v14, s[48:51], s33 offen lds
  s_add_u32 m0, s32, 1024
  s_mov_b32 s33, 393216
  buffer_load_dwordx4 v15, s[48:51], s33 offen lds
  s_add_u32 m0, s32, 2048
  s_mov_b32 s33, 393216
  buffer_load_dwordx4 v16, s[48:51], s33 offen lds
  s_add_u32 m0, s32, 3072
  s_mov_b32 s33, 442368
  buffer_load_dwordx4 v14, s[48:51], s33 offen lds
  s_add_u32 m0, s32, 4096
  s_mov_b32 s33, 442368
  buffer_load_dwordx4 v15, s[48:51], s33 offen lds
  s_add_u32 m0, s32, 5120
  s_mov_b32 s33, 442368
  buffer_load_dwordx4 v16, s[48:51], s33 offen lds
  s_cmp_lt_u32 s24, 2
  s_cbranch_scc1 pfx_57
  s_mov_b32 s40, 983040
  v_cmp_gt_u32 vcc, 60, v1
  s_and_saveexec_b64 s[42:43], vcc
  buffer_load_dword v21, v20, s[48:51], s40 offen
  s_mov_b64 exec, -1
  s_branch pfe_58
pfx_57:
  buffer_load_dword v21, v20, s[4:7], 0 offen offset:512
pfe_58:
  s_waitcnt vmcnt(1)
  s_barrier
  s_add_u32 m0, s31, 40960
  s_mov_b32 s33, 384
  buffer_load_dwordx4 v4, s[4:7], s33 offen lds
  s_add_u32 m0, s31, 41984
  s_mov_b32 s33, 10624
  buffer_load_dwordx4 v5, s[4:7], s33 offen lds
  s_add_u32 m0, s31, 43008
  s_mov_b32 s33, 20864
  buffer_load_dwordx4 v4, s[4:7], s33 offen lds
  s_add_u32 m0, s31, 44032
  s_mov_b32 s33, 31104
  buffer_load_dwordx4 v5, s[4:7], s33 offen lds
  s_add_u32 m0, s32, 40960
  s_mov_b32 s33, 589824
  buffer_load_dwordx4 v14, s[48:51], s33 offen lds
  s_add_u32 m0, s32, 41984
  s_mov_b32 s33, 589824
  buffer_load_dwordx4 v15, s[48:51], s33 offen lds
  s_add_u32 m0, s32, 43008
  s_mov_b32 s33, 589824
  buffer_load_dwordx4 v16, s[48:51], s33 offen lds
  s_add_u32 m0, s32, 44032
  s_mov_b32 s33, 638976
  buffer_load_dwordx4 v14, s[48:51], s33 offen lds
  s_add_u32 m0, s32, 45056
  s_mov_b32 s33, 638976
  buffer_load_dwordx4 v15, s[48:51], s33 offen lds
  s_add_u32 m0, s32, 46080
  s_mov_b32 s33, 638976
  buffer_load_dwordx4 v16, s[48:51], s33 offen lds
  s_waitcnt vmcnt(0)
  s_barrier
  s_add_u32 m0, s31, 0
  s_mov_b32 s33, 512
  buffer_load_dwordx4 v4, s[4:7], s33 offen lds
  s_add_u32 m0, s31, 1024
  s_mov_b32 s33, 10752
  buffer_load_dwordx4 v5, s[4:7], s33 offen lds
  s_add_u32 m0, s31, 2048
  s_mov_b32 s33, 20992
  buffer_load_dwordx4 v4, s[4:7], s33 offen lds
  s_add_u32 m0, s31, 3072
  s_mov_b32 s33, 31232
  buffer_load_dwordx4 v5, s[4:7], s33 offen lds
  s_add_u32 m0, s32, 0
  s_mov_b32 s33, 786432
  buffer_load_dwordx4 v14, s[48:51], s33 offen lds
  s_add_u32 m0, s32, 1024
  s_mov_b32 s33, 786432
  buffer_load_dwordx4 v15, s[48:51], s33 offen lds
  s_add_u32 m0, s32, 2048
  s_mov_b32 s33, 786432
  buffer_load_dwordx4 v16, s[48:51], s33 offen lds
  s_add_u32 m0, s32, 3072
  s_mov_b32 s33, 835584
  buffer_load_dwordx4 v14, s[48:51], s33 offen lds
  s_add_u32 m0, s32, 4096
  s_mov_b32 s33, 835584
  buffer_load_dwordx4 v15, s[48:51], s33 offen lds
  s_add_u32 m0, s32, 5120
  s_mov_b32 s33, 835584
  buffer_load_dwordx4 v16, s[48:51], s33 offen lds
  s_waitcnt vmcnt(0)
  s_barrier
  s_add_u32 m0, s31, 40960
  s_mov_b32 s33, 640
  buffer_load_dwordx4 v4, s[4:7], s33 offen lds
  s_add_u32 m0, s31, 41984
  s_mov_b32 s33, 10880
  buffer_load_dwordx4 v5, s[4:7], s33 offen lds
  s_add_u32 m0, s31, 43008
  s_mov_b32 s33, 21120
  buffer_load_dwordx4 v4, s[4:7], s33 offen lds
  s_add_u32 m0, s31, 44032
  s_mov_b32 s33, 31360
  buffer_load_dwordx4 v5, s[4:7], s33 offen lds
  s_add_u32 m0, s32, 40960
  s_mov_b32 s33, 983040
  buffer_load_dwordx4 v14, s[48:51], s33 offen lds
  s_add_u32 m0, s32, 41984
  s_mov_b32 s33, 983040
  buffer_load_dwordx4 v15, s[48:51], s33 offen lds
  s_add_u32 m0, s32, 43008
  s_mov_b32 s33, 983040
  buffer_load_dwordx4 v16, s[48:51], s33 offen lds
  s_add_u32 m0, s32, 44032
  s_mov_b32 s33, 1032192
  buffer_load_dwordx4 v14, s[48:51], s33 offen lds
  s_add_u32 m0, s32, 45056
  s_mov_b32 s33, 1032192
  buffer_load_dwordx4 v15, s[48:51], s33 offen lds
  s_add_u32 m0, s32, 46080
  s_mov_b32 s33, 1032192
  buffer_load_dwordx4 v16, s[48:51], s33 offen lds
  s_cmp_lg_u32 s20, 7
  s_cbranch_scc1 nn_59
  v_mov_b32 v20, 0
  s_mov_b32 s29, 0
ng_60:
  global_load_dword v21, v20, s[52:53] sc1
  s_waitcnt vmcnt(0)
  v_readfirstlane_b32 s57, v21
  s_add_u32 s29, s29, 1
  s_cmp_ge_u32 s29, 200000
  s_cbranch_scc1 ngd_61
  s_cmp_eq_u32 s57, 0
  s_cbranch_scc1 ng_60
ngd_61:
nn_59:
  s_waitcnt vmcnt(0)
  s_barrier
  s_add_u32 m0, s31, 0
  s_mov_b32 s33, 768
  buffer_load_dwordx4 v4, s[4:7], s33 offen lds
  s_add_u32 m0, s31, 1024
  s_mov_b32 s33, 11008
  buffer_load_dwordx4 v5, s[4:7], s33 offen lds
  s_add_u32 m0, s31, 2048
  s_mov_b32 s33, 21248
  buffer_load_dwordx4 v4, s[4:7], s33 offen lds
  s_add_u32 m0, s31, 3072
  s_mov_b32 s33, 31488
  buffer_load_dwordx4 v5, s[4:7], s33 offen lds
  s_add_u32 m0, s32, 0
  s_mov_b32 s33, 1179648
  buffer_load_dwordx4 v14, s[48:51], s33 offen lds
  s_add_u32 m0, s32, 1024
  s_mov_b32 s33, 1179648
  buffer_load_dwordx4 v15, s[48:51], s33 offen lds
  s_add_u32 m0, s32, 2048
  s_mov_b32 s33, 1179648
  buffer_load_dwordx4 v16, s[48:51], s33 offen lds
  s_add_u32 m0, s32, 3072
  s_mov_b32 s33, 1228800
  buffer_load_dwordx4 v14, s[48:51], s33 offen lds
  s_add_u32 m0, s32, 4096
  s_mov_b32 s33, 1228800
  buffer_load_dwordx4 v15, s[48:51], s33 offen lds
  s_add_u32 m0, s32, 5120
  s_mov_b32 s33, 1228800
  buffer_load_dwordx4 v16, s[48:51], s33 offen lds
  s_mov_b32 s40, s96
  s_mov_b32 s41, s97
  s_mov_b32 s42, 0x1e0000
  s_mov_b32 s43, 0x00020000
  s_mov_b32 s44, s90
  s_mov_b32 s45, s91
  s_mov_b32 s46, 0xc8000
  s_mov_b32 s47, 0x00020000
  s_and_b32 s56, s2, 7
  s_lshr_b32 s58, s2, 3
  s_lshl_b32 s59, s24, 7
  v_add_u32 v39, s59, v1
  v_mul_u32_u24 v45, 6554, v39
  v_lshrrev_b32 v45, 16, v45
  v_mul_u32_u24 v46, 10, v45
  v_sub_u32 v46, v39, v46
  s_mul_i32 s59, s58, 48
  v_add_u32 v45, s59, v45
  v_mul_u32_u24 v45, 1280, v45
  v_lshlrev_b32 v46, 4, v46
  s_mul_i32 s59, s56, 160
  v_add3_u32 v36, v45, v46, s59
  s_movk_i32 s59, 480
  v_cmp_gt_u32 vcc, s59, v39
  s_and_saveexec_b64 s[58:59], vcc
  buffer_load_dwordx4 v[24:27], v36, s[40:43], 0 offen
  s_mov_b64 exec, -1
  s_lshr_b32 s58, s2, 3
  s_lshl_b32 s59, s24, 7
  s_add_u32 s59, s59, 64
  v_add_u32 v40, s59, v1
  v_mul_u32_u24 v45, 6554, v40
  v_lshrrev_b32 v45, 16, v45
  v_mul_u32_u24 v46, 10, v45
  v_sub_u32 v46, v40, v46
  s_mul_i32 s59, s58, 48
  v_add_u32 v45, s59, v45
  v_mul_u32_u24 v45, 1280, v45
  v_lshlrev_b32 v46, 4, v46
  s_mul_i32 s59, s56, 160
  v_add3_u32 v37, v45, v46, s59
  s_movk_i32 s59, 480
  v_cmp_gt_u32 vcc, s59, v40
  s_and_saveexec_b64 s[58:59], vcc
  buffer_load_dwordx4 v[28:31], v37, s[40:43], 0 offen
  s_mov_b64 exec, -1
  s_lshr_b32 s58, s2, 3
  s_lshl_b32 s59, s24, 6
  v_add_u32 v41, s59, v1
  v_mul_u32_u24 v45, 6554, v41
  v_lshrrev_b32 v45, 16, v45
  v_mul_u32_u24 v46, 10, v45
  v_sub_u32 v46, v41, v46
  s_mul_i32 s59, s58, 20
  v_add_u32 v45, s59, v45
  v_and_b32 v47, 0xc, v45
  v_lshlrev_b32 v47, 1, v47
  v_and_b32 v48, 0x10, v45
  v_lshrrev_b32 v48, 2, v48
  v_or_b32 v47, v47, v48
  v_and_b32 v45, 0xffffffe3, v45
  v_or_b32 v45, v45, v47
  v_mul_u32_u24 v45, 1280, v45
  v_lshlrev_b32 v46, 4, v46
  s_mul_i32 s59, s56, 160
  v_add3_u32 v38, v45, v46, s59
  s_movk_i32 s59, 200
  v_cmp_gt_u32 vcc, s59, v41
  s_and_saveexec_b64 s[58:59], vcc
  buffer_load_dwordx4 v[32:35], v38, s[44:47], 0 offen
  s_mov_b64 exec, -1
  s_lshr_b32 s58, s2, 3
  s_waitcnt vmcnt(3)
  s_barrier
  s_add_u32 m0, s31, 40960
  s_mov_b32 s33, 896
  buffer_load_dwordx4 v4, s[4:7], s33 offen lds
  s_add_u32 m0, s31, 41984
  s_mov_b32 s33, 11136
  buffer_load_dwordx4 v5, s[4:7], s33 offen lds
  s_add_u32 m0, s31, 43008
  s_mov_b32 s33, 21376
  buffer_load_dwordx4 v4, s[4:7], s33 offen lds
  s_add_u32 m0, s31, 44032
  s_mov_b32 s33, 31616
  buffer_load_dwordx4 v5, s[4:7], s33 offen lds
  s_add_u32 m0, s32, 40960
  s_mov_b32 s33, 1376256
  buffer_load_dwordx4 v14, s[48:51], s33 offen lds
  s_add_u32 m0, s32, 41984
  s_mov_b32 s33, 1376256
  buffer_load_dwordx4 v15, s[48:51], s33 offen lds
  s_add_u32 m0, s32, 43008
  s_mov_b32 s33, 1376256
  buffer_load_dwordx4 v16, s[48:51], s33 offen lds
  s_add_u32 m0, s32, 44032
  s_mov_b32 s33, 1425408
  buffer_load_dwordx4 v14, s[48:51], s33 offen lds
  s_add_u32 m0, s32, 45056
  s_mov_b32 s33, 1425408
  buffer_load_dwordx4 v15, s[48:51], s33 offen lds
  s_add_u32 m0, s32, 46080
  s_mov_b32 s33, 1425408
  buffer_load_dwordx4 v16, s[48:51], s33 offen lds
  s_waitcnt vmcnt(10)
  s_and_b32 s56, s2, 7
  s_mul_i32 s56, s56, 348160
  s_add_u32 s56, s56, 1048576
  s_lshr_b32 s58, s2, 3
  s_mul_i32 s58, s58, 7680
  s_add_u32 s42, s56, s58
  s_movk_i32 s43, 480
  v_cmp_gt_u32 vcc, s43, v39
  v_lshlrev_b32 v45, 4, v39
  s_and_saveexec_b64 s[58:59], vcc
  buffer_store_dwordx4 v[24:27], v45, s[12:15], s42 offen sc1
  s_mov_b64 exec, -1
  s_nop 1
  s_lshr_b32 s58, s2, 3
  s_mul_i32 s58, s58, 7680
  s_add_u32 s42, s56, s58
  s_movk_i32 s43, 480
  v_cmp_gt_u32 vcc, s43, v40
  v_lshlrev_b32 v45, 4, v40
  s_and_saveexec_b64 s[58:59], vcc
  buffer_store_dwordx4 v[28:31], v45, s[12:15], s42 offen sc1
  s_mov_b64 exec, -1
  s_nop 1
  s_lshr_b32 s58, s2, 3
  s_mul_i32 s58, s58, 3200
  s_add_u32 s58, s58, 245760
  s_add_u32 s42, s56, s58
  s_movk_i32 s43, 200
  v_cmp_gt_u32 vcc, s43, v41
  v_lshlrev_b32 v45, 4, v41
  s_and_saveexec_b64 s[58:59], vcc
  buffer_store_dwordx4 v[32:35], v45, s[12:15], s42 offen sc1
  s_mov_b64 exec, -1
  s_nop 1
  s_waitcnt vmcnt(3)
  s_barrier
  s_add_u32 m0, s31, 0
  s_mov_b32 s33, 1024
  buffer_load_dwordx4 v4, s[4:7], s33 offen lds
  s_add_u32 m0, s31, 1024
  s_mov_b32 s33, 11264
  buffer_load_dwordx4 v5, s[4:7], s33 offen lds
  s_add_u32 m0, s31, 2048
  s_mov_b32 s33, 21504
  buffer_load_dwordx4 v4, s[4:7], s33 offen lds
  s_add_u32 m0, s31, 3072
  s_mov_b32 s33, 31744
  buffer_load_dwordx4 v5, s[4:7], s33 offen lds
  s_add_u32 m0, s32, 0
  s_mov_b32 s33, 1572864
  buffer_load_dwordx4 v14, s[48:51], s33 offen lds
  s_add_u32 m0, s32, 1024
  s_mov_b32 s33, 1572864
  buffer_load_dwordx4 v15, s[48:51], s33 offen lds
  s_add_u32 m0, s32, 2048
  s_mov_b32 s33, 1572864
  buffer_load_dwordx4 v16, s[48:51], s33 offen lds
  s_add_u32 m0, s32, 3072
  s_mov_b32 s33, 1622016
  buffer_load_dwordx4 v14, s[48:51], s33 offen lds
  s_add_u32 m0, s32, 4096
  s_mov_b32 s33, 1622016
  buffer_load_dwordx4 v15, s[48:51], s33 offen lds
  s_add_u32 m0, s32, 5120
  s_mov_b32 s33, 1622016
  buffer_load_dwordx4 v16, s[48:51], s33 offen lds
  s_waitcnt vmcnt(0)
  s_barrier
  s_add_u32 m0, s31, 40960
  s_mov_b32 s33, 1152
  buffer_load_dwordx4 v4, s[4:7], s33 offen lds
  s_add_u32 m0, s31, 41984
  s_mov_b32 s33, 11392
  buffer_load_dwordx4 v5, s[4:7], s33 offen lds
  s_add_u32 m0, s31, 43008
  s_mov_b32 s33, 21632
  buffer_load_dwordx4 v4, s[4:7], s33 offen lds
  s_add_u32 m0, s31, 44032
  s_mov_b32 s33, 31872
  buffer_load_dwordx4 v5, s[4:7], s33 offen lds
  s_add_u32 m0, s32, 40960
  s_mov_b32 s33, 1769472
  buffer_load_dwordx4 v14, s[48:51], s33 offen lds
  s_add_u32 m0, s32, 41984
  s_mov_b32 s33, 1769472
  buffer_load_dwordx4 v15, s[48:51], s33 offen lds
  s_add_u32 m0, s32, 43008
  s_mov_b32 s33, 1769472
  buffer_load_dwordx4 v16, s[48:51], s33 offen lds
  s_add_u32 m0, s32, 44032
  s_mov_b32 s33, 1818624
  buffer_load_dwordx4 v14, s[48:51], s33 offen lds
  s_add_u32 m0, s32, 45056
  s_mov_b32 s33, 1818624
  buffer_load_dwordx4 v15, s[48:51], s33 offen lds
  s_add_u32 m0, s32, 46080
  s_mov_b32 s33, 1818624
  buffer_load_dwordx4 v16, s[48:51], s33 offen lds
  s_cmp_lg_u32 s20, 7
  s_cbranch_scc1 rpf_62
  s_and_b32 s58, s2, 7
  s_lshl_b32 s58, s58, 5
  s_lshr_b32 s59, s2, 3
  s_add_u32 s58, s58, s59
  s_lshl_b32 s58, s58, 3
  s_add_u32 s58, s58, 4149248
  v_mov_b32 v46, 0
  v_mov_b32 v47, s57
  s_mov_b64 exec, 1
  buffer_store_dword v47, v46, s[12:15], s58 offen sc1
  s_mov_b64 exec, -1
rpf_62:
  s_waitcnt vmcnt(0)
  s_barrier
  s_waitcnt vmcnt(0)
sa_end_54:
  s_barrier
  s_cmp_lg_u32 s20, 7
  s_cbranch_scc1 hf_63
  s_lshl_b32 s26, s22, 7
  s_lshl_b32 s27, s21, 3
  s_add_u32 s26, s26, s27
  s_add_u32 s26, s26, 4132864
  v_mov_b32 v12, 0
  v_mov_b32 v13, s57
  s_mov_b64 exec, 1
  buffer_store_dword v13, v12, s[12:15], s26 offen sc1
  s_mov_b64 exec, -1
hf_63:
  s_and_b32 s26, s2, 7
  s_lshl_b32 s26, s26, 2
  s_lshr_b32 s27, s2, 6
  s_add_u32 s21, s26, s27
  s_bfe_u32 s23, s2, 0x30003
  s_mov_b32 s8, s96
  s_mov_b32 s9, s97
  s_mov_b32 s10, 0x1e0000
  s_mov_b32 s11, 0x00020000
  s_mov_b32 s16, s90
  s_mov_b32 s17, s91
  s_mov_b32 s18, 0xc8000
  s_mov_b32 s19, 0x00020000
  s_mov_b32 s44, s100
  s_mov_b32 s45, s101
  s_mov_b32 s46, 0x280000
  s_mov_b32 s47, 0x00020000
  s_setprio 0
  v_and_b32 v1, 63, v0
  s_and_b32 s24, s20, 1
  s_lshr_b32 s25, s20, 1
  s_movk_i32 s28, 1280
  s_movk_i32 s29, 6554
  s_mul_i32 s40, s23, 348160
  s_lshl_b32 s41, s20, 10
  s_add_u32 s40, s40, s41
  s_add_u32 s40, s40, 1048576
  v_lshlrev_b32 v7, 4, v1
  v_lshrrev_b32 v2, 4, v1
  v_lshlrev_b32 v2, 2, v2
  v_bfe_u32 v3, v1, 2, 2
  v_add_u32 v2, v2, v3
  s_lshl_b32 s26, s25, 5
  v_add_u32 v2, s26, v2
  v_mul_u32_u24 v2, 160, v2
  v_and_b32 v3, 3, v1
  v_mul_u32_u24 v3, 40, v3
  v_add_u32 v8, v2, v3
  v_add_u32 v9, 40960, v8
  s_lshl_b32 s26, s21, 2
  s_lshl_b32 s27, s24, 1
  s_add_u32 s26, s26, s27
  s_lshl_b32 s27, s25, 10
  s_mul_i32 s36, s26, 49152
  s_add_u32 s36, s36, s27
  s_add_u32 s36, s36, 4194304
  s_mul_i32 s37, s26, 20480
  s_add_u32 s37, s37, s27
  s_add_u32 s37, s37, 10485760
  s_lshl_b32 s38, s26, 4
  s_lshl_b32 s34, s20, 10
  s_lshl_b32 s26, s21, 6
  s_lshl_b32 s27, s24, 5
  s_add_u32 s26, s26, s27
  v_and_b32 v14, 15, v1
  v_add_u32 v14, s26, v14
  v_mul_u32_u24 v14, 1280, v14
  v_lshrrev_b32 v15, 4, v1
  v_mul_u32_u24 v15, 40, v15
  s_mul_i32 s26, s23, 160
  v_add3_u32 v14, v14, v15, s26
  s_mul_i32 s26, s24, 30720
  s_add_u32 s26, s26, 20480
  v_lshlrev_b32 v15, 4, v1
  v_add_u32 v15, s26, v15
  s_cmp_lt_u32 s20, 4
  s_cbranch_scc1 fg3_64
  s_lshl_b32 s42, s23, 8
  s_add_u32 s42, s42, 4149248
  s_lshr_b32 s26, s21, 1
  s_lshl_b32 s26, s26, 7
  s_add_u32 s39, s26, 4132864
  s_cmp_lg_u32 s20, 7
  s_cbranch_scc1 fw_done_66
  v_lshlrev_b32 v72, 4, v1
  s_mov_b32 s29, 0
fw_loop_67:
  v_mul_u32_u24 v73, 8, v1
  v_cmp_gt_u32 vcc, 32, v1
  v_mov_b32 v74, s57
  s_and_saveexec_b64 s[58:59], vcc
  buffer_load_dword v74, v73, s[12:15], s42 offen sc1
  s_mov_b64 exec, -1
  v_mul_u32_u24 v73, 8, v1
  v_cmp_gt_u32 vcc, 16, v1
  v_mov_b32 v75, s57
  s_and_saveexec_b64 s[58:59], vcc
  buffer_load_dword v75, v73, s[12:15], s39 offen sc1
  s_mov_b64 exec, -1
  s_mov_b32 s28, 4128768
  buffer_load_dwordx4 v[76:79], v72, s[12:15], s28 offen sc1
  buffer_load_dwordx4 v[80:83], v72, s[12:15], s28 offen offset:1024 sc1
  s_waitcnt vmcnt(0)
  s_add_u32 s29, s29, 1
  s_cmp_ge_u32 s29, 200000
  s_cbranch_scc1 fw_done_66
  v_cmp_ne_u32 vcc, s57, v74
  s_cbranch_vccnz fw_loop_67
  v_cmp_ne_u32 vcc, s57, v75
  s_cbranch_vccnz fw_loop_67
  v_cmp_ne_u32 vcc, s57, v76
  s_cbranch_vccnz fw_loop_67
  v_cmp_ne_u32 vcc, s57, v78
  s_cbranch_vccnz fw_loop_67
  v_cmp_ne_u32 vcc, s57, v80
  s_cbranch_vccnz fw_loop_67
  v_cmp_ne_u32 vcc, s57, v82
  s_cbranch_vccnz fw_loop_67
fw_done_66:
  s_barrier
  v_and_b32 v2, 15, v1
  v_add_u32 v2, s38, v2
  v_lshlrev_b32 v2, 2, v2
  s_mov_b32 s27, 196608
  buffer_load_dword v10, v2, s[12:15], s27 offen sc1
  buffer_load_dword v11, v2, s[12:15], s27 offen offset:64 sc1
  s_add_u32 m0, s34, 0
  s_add_u32 s33, s40, 0
  buffer_load_dwordx4 v7, s[12:15], s33 offen sc1 lds
  s_add_u32 m0, s34, 8192
  s_add_u32 s33, s40, 8192
  buffer_load_dwordx4 v7, s[12:15], s33 offen sc1 lds
  s_add_u32 s33, s36, 0
  buffer_load_dwordx4 v[72:75], v7, s[12:15], s33 offen sc1
  s_add_u32 s33, s36, 49152
  buffer_load_dwordx4 v[76:79], v7, s[12:15], s33 offen sc1
  s_add_u32 m0, s34, 20480
  s_add_u32 s33, s40, 20480
  buffer_load_dwordx4 v7, s[12:15], s33 offen sc1 lds
  s_add_u32 m0, s34, 28672
  s_add_u32 s33, s40, 28672
  buffer_load_dwordx4 v7, s[12:15], s33 offen sc1 lds
  s_add_u32 s33, s36, 4096
  buffer_load_dwordx4 v[80:83], v7, s[12:15], s33 offen sc1
  s_add_u32 s33, s36, 53248
  buffer_load_dwordx4 v[84:87], v7, s[12:15], s33 offen sc1
  s_add_u32 m0, s34, 40960
  s_add_u32 s33, s40, 40960
  buffer_load_dwordx4 v7, s[12:15], s33 offen sc1 lds
  s_add_u32 m0, s34, 49152
  s_add_u32 s33, s40, 49152
  buffer_load_dwordx4 v7, s[12:15], s33 offen sc1 lds
  s_add_u32 s33, s36, 8192
  buffer_load_dwordx4 v[88:91], v7, s[12:15], s33 offen sc1
  s_add_u32 s33, s36, 57344
  buffer_load_dwordx4 v[92:95], v7, s[12:15], s33 offen sc1
  s_waitcnt vmcnt(8)
  s_barrier
  s_add_u32 m0, s34, 61440
  s_add_u32 s33, s40, 61440
  buffer_load_dwordx4 v7, s[12:15], s33 offen sc1 lds
  s_add_u32 m0, s34, 69632
  s_add_u32 s33, s40, 69632
  buffer_load_dwordx4 v7, s[12:15], s33 offen sc1 lds
  s_add_u32 s33, s36, 12288
  buffer_load_dwordx4 v[96:99], v7, s[12:15], s33 offen sc1
  s_add_u32 s33, s36, 61440
  buffer_load_dwordx4 v[100:103], v7, s[12:15], s33 offen sc1
  ds_read_b64_tr_b16 v[104:105], v8 offset:0
  ds_read_b64_tr_b16 v[106:107], v8 offset:2560
  ds_read_b64_tr_b16 v[108:109], v8 offset:8
  ds_read_b64_tr_b16 v[110:111], v8 offset:2568
  ds_read_b64_tr_b16 v[112:113], v8 offset:16
  ds_read_b64_tr_b16 v[114:115], v8 offset:2576
  ds_read_b64_tr_b16 v[116:117], v8 offset:24
  ds_read_b64_tr_b16 v[118:119], v8 offset:2584
  ds_read_b64_tr_b16 v[120:121], v8 offset:32
  ds_read_b64_tr_b16 v[122:123], v8 offset:2592
  s_waitcnt lgkmcnt(8)
  v_mfma_f32_16x16x32_bf16 v[32:35], v[104:107], v[72:75], 0
  v_mfma_f32_16x16x32_bf16 v[52:55], v[104:107], v[76:79], 0
  s_waitcnt lgkmcnt(6)
  v_mfma_f32_16x16x32_bf16 v[36:39], v[108:111], v[72:75], 0
  v_mfma_f32_16x16x32_bf16 v[56:59], v[108:111], v[76:79], 0
  s_waitcnt lgkmcnt(4)
  v_mfma_f32_16x16x32_bf16 v[40:43], v[112:115], v[72:75], 0
  v_mfma_f32_16x16x32_bf16 v[60:63], v[112:115], v[76:79], 0
  s_waitcnt lgkmcnt(2)
  v_mfma_f32_16x16x32_bf16 v[44:47], v[116:119], v[72:75], 0
  v_mfma_f32_16x16x32_bf16 v[64:67], v[116:119], v[76:79], 0
  s_waitcnt lgkmcnt(0)
  v_mfma_f32_16x16x32_bf16 v[48:51], v[120:123], v[72:75], 0
  v_mfma_f32_16x16x32_bf16 v[68:71], v[120:123], v[76:79], 0
  s_waitcnt vmcnt(8)
  s_barrier
  s_add_u32 m0, s34, 0
  s_add_u32 s33, s40, 81920
  buffer_load_dwordx4 v7, s[12:15], s33 offen sc1 lds
  s_add_u32 m0, s34, 8192
  s_add_u32 s33, s40, 90112
  buffer_load_dwordx4 v7, s[12:15], s33 offen sc1 lds
  s_add_u32 s33, s36, 16384
  buffer_load_dwordx4 v[72:75], v7, s[12:15], s33 offen sc1
  s_add_u32 s33, s36, 65536
  buffer_load_dwordx4 v[76:79], v7, s[12:15], s33 offen sc1
  ds_read_b64_tr_b16 v[104:105], v8 offset:20480
  ds_read_b64_tr_b16 v[106:107], v8 offset:23040
  ds_read_b64_tr_b16 v[108:109], v8 offset:20488
  ds_read_b64_tr_b16 v[110:111], v8 offset:23048
  ds_read_b64_tr_b16 v[112:113], v8 offset:20496
  ds_read_b64_tr_b16 v[114:115], v8 offset:23056
  ds_read_b64_tr_b16 v[116:117], v8 offset:20504
  ds_read_b64_tr_b16 v[118:119], v8 offset:23064
  ds_read_b64_tr_b16 v[120:121], v8 offset:20512
  ds_read_b64_tr_b16 v[122:123], v8 offset:23072
  s_waitcnt lgkmcnt(8)
  v_mfma_f32_16x16x32_bf16 v[32:35], v[104:107], v[80:83], v[32:35]
  v_mfma_f32_16x16x32_bf16 v[52:55], v[104:107], v[84:87], v[52:55]
  s_waitcnt lgkmcnt(6)
  v_mfma_f32_16x16x32_bf16 v[36:39], v[108:111], v[80:83], v[36:39]
  v_mfma_f32_16x16x32_bf16 v[56:59], v[108:111], v[84:87], v[56:59]
  s_waitcnt lgkmcnt(4)
  v_mfma_f32_16x16x32_bf16 v[40:43], v[112:115], v[80:83], v[40:43]
  v_mfma_f32_16x16x32_bf16 v[60:63], v[112:115], v[84:87], v[60:63]
  s_waitcnt lgkmcnt(2)
  v_mfma_f32_16x16x32_bf16 v[44:47], v[116:119], v[80:83], v[44:47]
  v_mfma_f32_16x16x32_bf16 v[64:67], v[116:119], v[84:87], v[64:67]
  s_waitcnt lgkmcnt(0)
  v_mfma_f32_16x16x32_bf16 v[48:51], v[120:123], v[80:83], v[48:51]
  v_mfma_f32_16x16x32_bf16 v[68:71], v[120:123], v[84:87], v[68:71]
  s_waitcnt vmcnt(8)
  s_barrier
  s_add_u32 m0, s34, 20480
  s_add_u32 s33, s40, 102400
  buffer_load_dwordx4 v7, s[12:15], s33 offen sc1 lds
  s_add_u32 m0, s34, 28672
  s_add_u32 s33, s40, 110592
  buffer_load_dwordx4 v7, s[12:15], s33 offen sc1 lds
  s_add_u32 s33, s36, 20480
  buffer_load_dwordx4 v[80:83], v7, s[12:15], s33 offen sc1
  s_add_u32 s33, s36, 69632
  buffer_load_dwordx4 v[84:87], v7, s[12:15], s33 offen sc1
  ds_read_b64_tr_b16 v[104:105], v9 offset:0
  ds_read_b64_tr_b16 v[106:107], v9 offset:2560
  ds_read_b64_tr_b16 v[108:109], v9 offset:8
  ds_read_b64_tr_b16 v[110:111], v9 offset:2568
  ds_read_b64_tr_b16 v[112:113], v9 offset:16
  ds_read_b64_tr_b16 v[114:115], v9 offset:2576
  ds_read_b64_tr_b16 v[116:117], v9 offset:24
  ds_read_b64_tr_b16 v[118:119], v9 offset:2584
  ds_read_b64_tr_b16 v[120:121], v9 offset:32
  ds_read_b64_tr_b16 v[122:123], v9 offset:2592
  s_waitcnt lgkmcnt(8)
  v_mfma_f32_16x16x32_bf16 v[32:35], v[104:107], v[88:91], v[32:35]
  v_mfma_f32_16x16x32_bf16 v[52:55], v[104:107], v[92:95], v[52:55]
  s_waitcnt lgkmcnt(6)
  v_mfma_f32_16x16x32_bf16 v[36:39], v[108:111], v[88:91], v[36:39]
  v_mfma_f32_16x16x32_bf16 v[56:59], v[108:111], v[92:95], v[56:59]
  s_waitcnt lgkmcnt(4)
  v_mfma_f32_16x16x32_bf16 v[40:43], v[112:115], v[88:91], v[40:43]
  v_mfma_f32_16x16x32_bf16 v[60:63], v[112:115], v[92:95], v[60:63]
  s_waitcnt lgkmcnt(2)
  v_mfma_f32_16x16x32_bf16 v[44:47], v[116:119], v[88:91], v[44:47]
  v_mfma_f32_16x16x32_bf16 v[64:67], v[116:119], v[92:95], v[64:67]
  s_waitcnt lgkmcnt(0)
  v_mfma_f32_16x16x32_bf16 v[48:51], v[120:123], v[88:91], v[48:51]
  v_mfma_f32_16x16x32_bf16 v[68:71], v[120:123], v[92:95], v[68:71]
  s_waitcnt vmcnt(8)
  s_barrier
  s_add_u32 m0, s34, 40960
  s_add_u32 s33, s40, 122880
  buffer_load_dwordx4 v7, s[12:15], s33 offen sc1 lds
  s_add_u32 m0, s34, 49152
  s_add_u32 s33, s40, 131072
  buffer_load_dwordx4 v7, s[12:15], s33 offen sc1 lds
  s_add_u32 s33, s36, 24576
  buffer_load_dwordx4 v[88:91], v7, s[12:15], s33 offen sc1
  s_add_u32 s33, s36, 73728
  buffer_load_dwordx4 v[92:95], v7, s[12:15], s33 offen sc1
  ds_read_b64_tr_b16 v[104:105], v9 offset:20480
  ds_read_b64_tr_b16 v[106:107], v9 offset:23040
  ds_read_b64_tr_b16 v[108:109], v9 offset:20488
  ds_read_b64_tr_b16 v[110:111], v9 offset:23048
  ds_read_b64_tr_b16 v[112:113], v9 offset:20496
  ds_read_b64_tr_b16 v[114:115], v9 offset:23056
  ds_read_b64_tr_b16 v[116:117], v9 offset:20504
  ds_read_b64_tr_b16 v[118:119], v9 offset:23064
  ds_read_b64_tr_b16 v[120:121], v9 offset:20512
  ds_read_b64_tr_b16 v[122:123], v9 offset:23072
  s_waitcnt lgkmcnt(8)
  v_mfma_f32_16x16x32_bf16 v[32:35], v[104:107], v[96:99], v[32:35]
  v_mfma_f32_16x16x32_bf16 v[52:55], v[104:107], v[100:103], v[52:55]
  s_waitcnt lgkmcnt(6)
  v_mfma_f32_16x16x32_bf16 v[36:39], v[108:111], v[96:99], v[36:39]
  v_mfma_f32_16x16x32_bf16 v[56:59], v[108:111], v[100:103], v[56:59]
  s_waitcnt lgkmcnt(4)
  v_mfma_f32_16x16x32_bf16 v[40:43], v[112:115], v[96:99], v[40:43]
  v_mfma_f32_16x16x32_bf16 v[60:63], v[112:115], v[100:103], v[60:63]
  s_waitcnt lgkmcnt(2)
  v_mfma_f32_16x16x32_bf16 v[44:47], v[116:119], v[96:99], v[44:47]
  v_mfma_f32_16x16x32_bf16 v[64:67], v[116:119], v[100:103], v[64:67]
  s_waitcnt lgkmcnt(0)
  v_mfma_f32_16x16x32_bf16 v[48:51], v[120:123], v[96:99], v[48:51]
  v_mfma_f32_16x16x32_bf16 v[68:71], v[120:123], v[100:103], v[68:71]
  s_waitcnt vmcnt(8)
  s_barrier
  s_add_u32 m0, s34, 61440
  s_add_u32 s33, s40, 143360
  buffer_load_dwordx4 v7, s[12:15], s33 offen sc1 lds
  s_add_u32 m0, s34, 69632
  s_add_u32 s33, s40, 151552
  buffer_load_dwordx4 v7, s[12:15], s33 offen sc1 lds
  s_add_u32 s33, s36, 28672
  buffer_load_dwordx4 v[96:99], v7, s[12:15], s33 offen sc1
  s_add_u32 s33, s36, 77824
  buffer_load_dwordx4 v[100:103], v7, s[12:15], s33 offen sc1
  ds_read_b64_tr_b16 v[104:105], v8 offset:0
  ds_read_b64_tr_b16 v[106:107], v8 offset:2560
  ds_read_b64_tr_b16 v[108:109], v8 offset:8
  ds_read_b64_tr_b16 v[110:111], v8 offset:2568
  ds_read_b64_tr_b16 v[112:113], v8 offset:16
  ds_read_b64_tr_b16 v[114:115], v8 offset:2576
  ds_read_b64_tr_b16 v[116:117], v8 offset:24
  ds_read_b64_tr_b16 v[118:119], v8 offset:2584
  ds_read_b64_tr_b16 v[120:121], v8 offset:32
  ds_read_b64_tr_b16 v[122:123], v8 offset:2592
  s_waitcnt lgkmcnt(8)
  v_mfma_f32_16x16x32_bf16 v[32:35], v[104:107], v[72:75], v[32:35]
  v_mfma_f32_16x16x32_bf16 v[52:55], v[104:107], v[76:79], v[52:55]
  s_waitcnt lgkmcnt(6)
  v_mfma_f32_16x16x32_bf16 v[36:39], v[108:111], v[72:75], v[36:39]
  v_mfma_f32_16x16x32_bf16 v[56:59], v[108:111], v[76:79], v[56:59]
  s_waitcnt lgkmcnt(4)
  v_mfma_f32_16x16x32_bf16 v[40:43], v[112:115], v[72:75], v[40:43]
  v_mfma_f32_16x16x32_bf16 v[60:63], v[112:115], v[76:79], v[60:63]
  s_waitcnt lgkmcnt(2)
  v_mfma_f32_16x16x32_bf16 v[44:47], v[116:119], v[72:75], v[44:47]
  v_mfma_f32_16x16x32_bf16 v[64:67], v[116:119], v[76:79], v[64:67]
  s_waitcnt lgkmcnt(0)
  v_mfma_f32_16x16x32_bf16 v[48:51], v[120:123], v[72:75], v[48:51]
  v_mfma_f32_16x16x32_bf16 v[68:71], v[120:123], v[76:79], v[68:71]
  s_waitcnt vmcnt(8)
  s_barrier
  s_add_u32 m0, s34, 0
  s_add_u32 s33, s40, 163840
  buffer_load_dwordx4 v7, s[12:15], s33 offen sc1 lds
  s_add_u32 m0, s34, 8192
  s_add_u32 s33, s40, 172032
  buffer_load_dwordx4 v7, s[12:15], s33 offen sc1 lds
  s_add_u32 s33, s36, 32768
  buffer_load_dwordx4 v[72:75], v7, s[12:15], s33 offen sc1
  s_add_u32 s33, s36, 81920
  buffer_load_dwordx4 v[76:79], v7, s[12:15], s33 offen sc1
  ds_read_b64_tr_b16 v[104:105], v8 offset:20480
  ds_read_b64_tr_b16 v[106:107], v8 offset:23040
  ds_read_b64_tr_b16 v[108:109], v8 offset:20488
  ds_read_b64_tr_b16 v[110:111], v8 offset:23048
  ds_read_b64_tr_b16 v[112:113], v8 offset:20496
  ds_read_b64_tr_b16 v[114:115], v8 offset:23056
  ds_read_b64_tr_b16 v[116:117], v8 offset:20504
  ds_read_b64_tr_b16 v[118:119], v8 offset:23064
  ds_read_b64_tr_b16 v[120:121], v8 offset:20512
  ds_read_b64_tr_b16 v[122:123], v8 offset:23072
  s_waitcnt lgkmcnt(8)
  v_mfma_f32_16x16x32_bf16 v[32:35], v[104:107], v[80:83], v[32:35]
  v_mfma_f32_16x16x32_bf16 v[52:55], v[104:107], v[84:87], v[52:55]
  s_waitcnt lgkmcnt(6)
  v_mfma_f32_16x16x32_bf16 v[36:39], v[108:111], v[80:83], v[36:39]
  v_mfma_f32_16x16x32_bf16 v[56:59], v[108:111], v[84:87], v[56:59]
  s_waitcnt lgkmcnt(4)
  v_mfma_f32_16x16x32_bf16 v[40:43], v[112:115], v[80:83], v[40:43]
  v_mfma_f32_16x16x32_bf16 v[60:63], v[112:115], v[84:87], v[60:63]
  s_waitcnt lgkmcnt(2)
  v_mfma_f32_16x16x32_bf16 v[44:47], v[116:119], v[80:83], v[44:47]
  v_mfma_f32_16x16x32_bf16 v[64:67], v[116:119], v[84:87], v[64:67]
  s_waitcnt lgkmcnt(0)
  v_mfma_f32_16x16x32_bf16 v[48:51], v[120:123], v[80:83], v[48:51]
  v_mfma_f32_16x16x32_bf16 v[68:71], v[120:123], v[84:87], v[68:71]
  s_waitcnt vmcnt(8)
  s_barrier
  s_add_u32 m0, s34, 20480
  s_add_u32 s33, s40, 184320
  buffer_load_dwordx4 v7, s[12:15], s33 offen sc1 lds
  s_add_u32 m0, s34, 28672
  s_add_u32 s33, s40, 192512
  buffer_load_dwordx4 v7, s[12:15], s33 offen sc1 lds
  s_add_u32 s33, s36, 36864
  buffer_load_dwordx4 v[80:83], v7, s[12:15], s33 offen sc1
  s_add_u32 s33, s36, 86016
  buffer_load_dwordx4 v[84:87], v7, s[12:15], s33 offen sc1
  ds_read_b64_tr_b16 v[104:105], v9 offset:0
  ds_read_b64_tr_b16 v[106:107], v9 offset:2560
  ds_read_b64_tr_b16 v[108:109], v9 offset:8
  ds_read_b64_tr_b16 v[110:111], v9 offset:2568
  ds_read_b64_tr_b16 v[112:113], v9 offset:16
  ds_read_b64_tr_b16 v[114:115], v9 offset:2576
  ds_read_b64_tr_b16 v[116:117], v9 offset:24
  ds_read_b64_tr_b16 v[118:119], v9 offset:2584
  ds_read_b64_tr_b16 v[120:121], v9 offset:32
  ds_read_b64_tr_b16 v[122:123], v9 offset:2592
  s_waitcnt lgkmcnt(8)
  v_mfma_f32_16x16x32_bf16 v[32:35], v[104:107], v[88:91], v[32:35]
  v_mfma_f32_16x16x32_bf16 v[52:55], v[104:107], v[92:95], v[52:55]
  s_waitcnt lgkmcnt(6)
  v_mfma_f32_16x16x32_bf16 v[36:39], v[108:111], v[88:91], v[36:39]
  v_mfma_f32_16x16x32_bf16 v[56:59], v[108:111], v[92:95], v[56:59]
  s_waitcnt lgkmcnt(4)
  v_mfma_f32_16x16x32_bf16 v[40:43], v[112:115], v[88:91], v[40:43]
  v_mfma_f32_16x16x32_bf16 v[60:63], v[112:115], v[92:95], v[60:63]
  s_waitcnt lgkmcnt(2)
  v_mfma_f32_16x16x32_bf16 v[44:47], v[116:119], v[88:91], v[44:47]
  v_mfma_f32_16x16x32_bf16 v[64:67], v[116:119], v[92:95], v[64:67]
  s_waitcnt lgkmcnt(0)
  v_mfma_f32_16x16x32_bf16 v[48:51], v[120:123], v[88:91], v[48:51]
  v_mfma_f32_16x16x32_bf16 v[68:71], v[120:123], v[92:95], v[68:71]
  s_waitcnt vmcnt(8)
  s_barrier
  s_add_u32 m0, s34, 40960
  s_add_u32 s33, s40, 204800
  buffer_load_dwordx4 v7, s[12:15], s33 offen sc1 lds
  s_add_u32 m0, s34, 49152
  s_add_u32 s33, s40, 212992
  buffer_load_dwordx4 v7, s[12:15], s33 offen sc1 lds
  s_add_u32 s33, s36, 40960
  buffer_load_dwordx4 v[88:91], v7, s[12:15], s33 offen sc1
  s_add_u32 s33, s36, 90112
  buffer_load_dwordx4 v[92:95], v7, s[12:15], s33 offen sc1
  ds_read_b64_tr_b16 v[104:105], v9 offset:20480
  ds_read_b64_tr_b16 v[106:107], v9 offset:23040
  ds_read_b64_tr_b16 v[108:109], v9 offset:20488
  ds_read_b64_tr_b16 v[110:111], v9 offset:23048
  ds_read_b64_tr_b16 v[112:113], v9 offset:20496
  ds_read_b64_tr_b16 v[114:115], v9 offset:23056
  ds_read_b64_tr_b16 v[116:117], v9 offset:20504
  ds_read_b64_tr_b16 v[118:119], v9 offset:23064
  ds_read_b64_tr_b16 v[120:121], v9 offset:20512
  ds_read_b64_tr_b16 v[122:123], v9 offset:23072
  s_waitcnt lgkmcnt(8)
  v_mfma_f32_16x16x32_bf16 v[32:35], v[104:107], v[96:99], v[32:35]
  v_mfma_f32_16x16x32_bf16 v[52:55], v[104:107], v[100:103], v[52:55]
  s_waitcnt lgkmcnt(6)
  v_mfma_f32_16x16x32_bf16 v[36:39], v[108:111], v[96:99], v[36:39]
  v_mfma_f32_16x16x32_bf16 v[56:59], v[108:111], v[100:103], v[56:59]
  s_waitcnt lgkmcnt(4)
  v_mfma_f32_16x16x32_bf16 v[40:43], v[112:115], v[96:99], v[40:43]
  v_mfma_f32_16x16x32_bf16 v[60:63], v[112:115], v[100:103], v[60:63]
  s_waitcnt lgkmcnt(2)
  v_mfma_f32_16x16x32_bf16 v[44:47], v[116:119], v[96:99], v[44:47]
  v_mfma_f32_16x16x32_bf16 v[64:67], v[116:119], v[100:103], v[64:67]
  s_waitcnt lgkmcnt(0)
  v_mfma_f32_16x16x32_bf16 v[48:51], v[120:123], v[96:99], v[48:51]
  v_mfma_f32_16x16x32_bf16 v[68:71], v[120:123], v[100:103], v[68:71]
  s_waitcnt vmcnt(8)
  s_barrier
  s_add_u32 m0, s34, 61440
  s_add_u32 s33, s40, 225280
  buffer_load_dwordx4 v7, s[12:15], s33 offen sc1 lds
  s_add_u32 m0, s34, 69632
  s_add_u32 s33, s40, 233472
  buffer_load_dwordx4 v7, s[12:15], s33 offen sc1 lds
  s_add_u32 s33, s36, 45056
  buffer_load_dwordx4 v[96:99], v7, s[12:15], s33 offen sc1
  s_add_u32 s33, s36, 94208
  buffer_load_dwordx4 v[100:103], v7, s[12:15], s33 offen sc1
  ds_read_b64_tr_b16 v[104:105], v8 offset:0
  ds_read_b64_tr_b16 v[106:107], v8 offset:2560
  ds_read_b64_tr_b16 v[108:109], v8 offset:8
  ds_read_b64_tr_b16 v[110:111], v8 offset:2568
  ds_read_b64_tr_b16 v[112:113], v8 offset:16
  ds_read_b64_tr_b16 v[114:115], v8 offset:2576
  ds_read_b64_tr_b16 v[116:117], v8 offset:24
  ds_read_b64_tr_b16 v[118:119], v8 offset:2584
  ds_read_b64_tr_b16 v[120:121], v8 offset:32
  ds_read_b64_tr_b16 v[122:123], v8 offset:2592
  s_waitcnt lgkmcnt(8)
  v_mfma_f32_16x16x32_bf16 v[32:35], v[104:107], v[72:75], v[32:35]
  v_mfma_f32_16x16x32_bf16 v[52:55], v[104:107], v[76:79], v[52:55]
  s_waitcnt lgkmcnt(6)
  v_mfma_f32_16x16x32_bf16 v[36:39], v[108:111], v[72:75], v[36:39]
  v_mfma_f32_16x16x32_bf16 v[56:59], v[108:111], v[76:79], v[56:59]
  s_waitcnt lgkmcnt(4)
  v_mfma_f32_16x16x32_bf16 v[40:43], v[112:115], v[72:75], v[40:43]
  v_mfma_f32_16x16x32_bf16 v[60:63], v[112:115], v[76:79], v[60:63]
  s_waitcnt lgkmcnt(2)
  v_mfma_f32_16x16x32_bf16 v[44:47], v[116:119], v[72:75], v[44:47]
  v_mfma_f32_16x16x32_bf16 v[64:67], v[116:119], v[76:79], v[64:67]
  s_waitcnt lgkmcnt(0)
  v_mfma_f32_16x16x32_bf16 v[48:51], v[120:123], v[72:75], v[48:51]
  v_mfma_f32_16x16x32_bf16 v[68:71], v[120:123], v[76:79], v[68:71]
  s_waitcnt vmcnt(8)
  s_barrier
  s_add_u32 m0, s34, 0
  s_add_u32 s33, s40, 245760
  buffer_load_dwordx4 v7, s[12:15], s33 offen sc1 lds
  s_add_u32 m0, s34, 8192
  s_add_u32 s33, s40, 253952
  buffer_load_dwordx4 v7, s[12:15], s33 offen sc1 lds
  ds_read_b64_tr_b16 v[104:105], v8 offset:20480
  ds_read_b64_tr_b16 v[106:107], v8 offset:23040
  ds_read_b64_tr_b16 v[108:109], v8 offset:20488
  ds_read_b64_tr_b16 v[110:111], v8 offset:23048
  ds_read_b64_tr_b16 v[112:113], v8 offset:20496
  ds_read_b64_tr_b16 v[114:115], v8 offset:23056
  ds_read_b64_tr_b16 v[116:117], v8 offset:20504
  ds_read_b64_tr_b16 v[118:119], v8 offset:23064
  ds_read_b64_tr_b16 v[120:121], v8 offset:20512
  ds_read_b64_tr_b16 v[122:123], v8 offset:23072
  s_waitcnt lgkmcnt(8)
  v_mfma_f32_16x16x32_bf16 v[32:35], v[104:107], v[80:83], v[32:35]
  v_mfma_f32_16x16x32_bf16 v[52:55], v[104:107], v[84:87], v[52:55]
  s_waitcnt lgkmcnt(6)
  v_mfma_f32_16x16x32_bf16 v[36:39], v[108:111], v[80:83], v[36:39]
  v_mfma_f32_16x16x32_bf16 v[56:59], v[108:111], v[84:87], v[56:59]
  s_waitcnt lgkmcnt(4)
  v_mfma_f32_16x16x32_bf16 v[40:43], v[112:115], v[80:83], v[40:43]
  v_mfma_f32_16x16x32_bf16 v[60:63], v[112:115], v[84:87], v[60:63]
  s_waitcnt lgkmcnt(2)
  v_mfma_f32_16x16x32_bf16 v[44:47], v[116:119], v[80:83], v[44:47]
  v_mfma_f32_16x16x32_bf16 v[64:67], v[116:119], v[84:87], v[64:67]
  s_waitcnt lgkmcnt(0)
  v_mfma_f32_16x16x32_bf16 v[48:51], v[120:123], v[80:83], v[48:51]
  v_mfma_f32_16x16x32_bf16 v[68:71], v[120:123], v[84:87], v[68:71]
  s_waitcnt vmcnt(6)
  s_barrier
  s_add_u32 m0, s34, 20480
  s_add_u32 s33, s40, 266240
  buffer_load_dwordx4 v7, s[12:15], s33 offen sc1 lds
  s_add_u32 m0, s34, 28672
  s_add_u32 s33, s40, 274432
  buffer_load_dwordx4 v7, s[12:15], s33 offen sc1 lds
  ds_read_b64_tr_b16 v[104:105], v9 offset:0
  ds_read_b64_tr_b16 v[106:107], v9 offset:2560
  ds_read_b64_tr_b16 v[108:109], v9 offset:8
  ds_read_b64_tr_b16 v[110:111], v9 offset:2568
  ds_read_b64_tr_b16 v[112:113], v9 offset:16
  ds_read_b64_tr_b16 v[114:115], v9 offset:2576
  ds_read_b64_tr_b16 v[116:117], v9 offset:24
  ds_read_b64_tr_b16 v[118:119], v9 offset:2584
  ds_read_b64_tr_b16 v[120:121], v9 offset:32
  ds_read_b64_tr_b16 v[122:123], v9 offset:2592
  s_waitcnt lgkmcnt(8)
  v_mfma_f32_16x16x32_bf16 v[32:35], v[104:107], v[88:91], v[32:35]
  v_mfma_f32_16x16x32_bf16 v[52:55], v[104:107], v[92:95], v[52:55]
  s_waitcnt lgkmcnt(6)
  v_mfma_f32_16x16x32_bf16 v[36:39], v[108:111], v[88:91], v[36:39]
  v_mfma_f32_16x16x32_bf16 v[56:59], v[108:111], v[92:95], v[56:59]
  s_waitcnt lgkmcnt(4)
  v_mfma_f32_16x16x32_bf16 v[40:43], v[112:115], v[88:91], v[40:43]
  v_mfma_f32_16x16x32_bf16 v[60:63], v[112:115], v[92:95], v[60:63]
  s_waitcnt lgkmcnt(2)
  v_mfma_f32_16x16x32_bf16 v[44:47], v[116:119], v[88:91], v[44:47]
  v_mfma_f32_16x16x32_bf16 v[64:67], v[116:119], v[92:95], v[64:67]
  s_waitcnt lgkmcnt(0)
  v_mfma_f32_16x16x32_bf16 v[48:51], v[120:123], v[88:91], v[48:51]
  v_mfma_f32_16x16x32_bf16 v[68:71], v[120:123], v[92:95], v[68:71]
  s_waitcnt vmcnt(4)
  s_barrier
  s_add_u32 m0, s34, 40960
  s_add_u32 s33, s40, 286720
  buffer_load_dwordx4 v7, s[12:15], s33 offen sc1 lds
  s_add_u32 m0, s34, 49152
  s_add_u32 s33, s40, 294912
  buffer_load_dwordx4 v7, s[12:15], s33 offen sc1 lds
  ds_read_b64_tr_b16 v[104:105], v9 offset:20480
  ds_read_b64_tr_b16 v[106:107], v9 offset:23040
  ds_read_b64_tr_b16 v[108:109], v9 offset:20488
  ds_read_b64_tr_b16 v[110:111], v9 offset:23048
  ds_read_b64_tr_b16 v[112:113], v9 offset:20496
  ds_read_b64_tr_b16 v[114:115], v9 offset:23056
  ds_read_b64_tr_b16 v[116:117], v9 offset:20504
  ds_read_b64_tr_b16 v[118:119], v9 offset:23064
  ds_read_b64_tr_b16 v[120:121], v9 offset:20512
  ds_read_b64_tr_b16 v[122:123], v9 offset:23072
  s_waitcnt lgkmcnt(8)
  v_mfma_f32_16x16x32_bf16 v[32:35], v[104:107], v[96:99], v[32:35]
  v_mfma_f32_16x16x32_bf16 v[52:55], v[104:107], v[100:103], v[52:55]
  s_waitcnt lgkmcnt(6)
  v_mfma_f32_16x16x32_bf16 v[36:39], v[108:111], v[96:99], v[36:39]
  v_mfma_f32_16x16x32_bf16 v[56:59], v[108:111], v[100:103], v[56:59]
  s_waitcnt lgkmcnt(4)
  v_mfma_f32_16x16x32_bf16 v[40:43], v[112:115], v[96:99], v[40:43]
  v_mfma_f32_16x16x32_bf16 v[60:63], v[112:115], v[100:103], v[60:63]
  s_waitcnt lgkmcnt(2)
  v_mfma_f32_16x16x32_bf16 v[44:47], v[116:119], v[96:99], v[44:47]
  v_mfma_f32_16x16x32_bf16 v[64:67], v[116:119], v[100:103], v[64:67]
  s_waitcnt lgkmcnt(0)
  v_mfma_f32_16x16x32_bf16 v[48:51], v[120:123], v[96:99], v[48:51]
  v_mfma_f32_16x16x32_bf16 v[68:71], v[120:123], v[100:103], v[68:71]
  s_setprio 3
  s_lshl_b32 s26, s21, 7
  s_add_u32 s39, s26, 4136960
  s_barrier
  s_add_u32 m0, s34, 61440
  s_add_u32 s33, s40, 307200
  buffer_load_dwordx4 v7, s[12:15], s33 offen sc1 lds
  s_add_u32 m0, s34, 69632
  s_add_u32 s33, s40, 315392
  buffer_load_dwordx4 v7, s[12:15], s33 offen sc1 lds
  s_waitcnt vmcnt(0)
  s_cmp_lg_u32 s20, 7
  s_cbranch_scc1 fw_done_68
  v_lshlrev_b32 v72, 4, v1
  s_mov_b32 s29, 0
fw_loop_69:
  v_mul_u32_u24 v73, 16, v1
  v_cmp_gt_u32 vcc, 8, v1
  v_mov_b32 v74, s57
  s_and_saveexec_b64 s[58:59], vcc
  buffer_load_dword v74, v73, s[12:15], s39 offen sc1
  s_mov_b64 exec, -1
  s_waitcnt vmcnt(0)
  s_add_u32 s29, s29, 1
  s_cmp_ge_u32 s29, 200000
  s_cbranch_scc1 fw_done_68
  v_cmp_ne_u32 vcc, s57, v74
  s_cbranch_vccnz fw_loop_69
fw_done_68:
  s_barrier
  s_add_u32 s33, s37, 0
  buffer_load_dwordx4 v[72:75], v7, s[12:15], s33 offen sc1
  s_add_u32 s33, s37, 20480
  buffer_load_dwordx4 v[76:79], v7, s[12:15], s33 offen sc1
  s_add_u32 s33, s37, 4096
  buffer_load_dwordx4 v[80:83], v7, s[12:15], s33 offen sc1
  s_add_u32 s33, s37, 24576
  buffer_load_dwordx4 v[84:87], v7, s[12:15], s33 offen sc1
  s_add_u32 s33, s37, 8192
  buffer_load_dwordx4 v[88:91], v7, s[12:15], s33 offen sc1
  s_add_u32 s33, s37, 28672
  buffer_load_dwordx4 v[92:95], v7, s[12:15], s33 offen sc1
  s_add_u32 s33, s37, 12288
  buffer_load_dwordx4 v[96:99], v7, s[12:15], s33 offen sc1
  s_add_u32 s33, s37, 32768
  buffer_load_dwordx4 v[100:103], v7, s[12:15], s33 offen sc1
  s_add_u32 s33, s37, 16384
  buffer_load_dwordx4 v[16:19], v7, s[12:15], s33 offen sc1
  s_add_u32 s33, s37, 36864
  buffer_load_dwordx4 v[20:23], v7, s[12:15], s33 offen sc1
  v_sub_f32 v10, 1.0, v10
  v_sub_f32 v11, 1.0, v11
  v_mul_f32 v32, v10, v32
  v_mul_f32 v33, v10, v33
  v_mul_f32 v34, v10, v34
  v_mul_f32 v35, v10, v35
  v_mul_f32 v36, v10, v36
  v_mul_f32 v37, v10, v37
  v_mul_f32 v38, v10, v38
  v_mul_f32 v39, v10, v39
  v_mul_f32 v40, v10, v40
  v_mul_f32 v41, v10, v41
  v_mul_f32 v42, v10, v42
  v_mul_f32 v43, v10, v43
  v_mul_f32 v44, v10, v44
  v_mul_f32 v45, v10, v45
  v_mul_f32 v46, v10, v46
  v_mul_f32 v47, v10, v47
  v_mul_f32 v48, v10, v48
  v_mul_f32 v49, v10, v49
  v_mul_f32 v50, v10, v50
  v_mul_f32 v51, v10, v51
  v_mul_f32 v52, v11, v52
  v_mul_f32 v53, v11, v53
  v_mul_f32 v54, v11, v54
  v_mul_f32 v55, v11, v55
  v_mul_f32 v56, v11, v56
  v_mul_f32 v57, v11, v57
  v_mul_f32 v58, v11, v58
  v_mul_f32 v59, v11, v59
  v_mul_f32 v60, v11, v60
  v_mul_f32 v61, v11, v61
  v_mul_f32 v62, v11, v62
  v_mul_f32 v63, v11, v63
  v_mul_f32 v64, v11, v64
  v_mul_f32 v65, v11, v65
  v_mul_f32 v66, v11, v66
  v_mul_f32 v67, v11, v67
  v_mul_f32 v68, v11, v68
  v_mul_f32 v69, v11, v69
  v_mul_f32 v70, v11, v70
  v_mul_f32 v71, v11, v71
  s_waitcnt vmcnt(8)
  ds_read_b64_tr_b16 v[104:105], v8 offset:0
  ds_read_b64_tr_b16 v[106:107], v8 offset:2560
  ds_read_b64_tr_b16 v[108:109], v8 offset:8
  ds_read_b64_tr_b16 v[110:111], v8 offset:2568
  ds_read_b64_tr_b16 v[112:113], v8 offset:16
  ds_read_b64_tr_b16 v[114:115], v8 offset:2576
  ds_read_b64_tr_b16 v[116:117], v8 offset:24
  ds_read_b64_tr_b16 v[118:119], v8 offset:2584
  ds_read_b64_tr_b16 v[120:121], v8 offset:32
  ds_read_b64_tr_b16 v[122:123], v8 offset:2592
  s_waitcnt lgkmcnt(8)
  v_mfma_f32_16x16x32_bf16 v[32:35], v[104:107], v[72:75], v[32:35]
  v_mfma_f32_16x16x32_bf16 v[52:55], v[104:107], v[76:79], v[52:55]
  s_waitcnt lgkmcnt(6)
  v_mfma_f32_16x16x32_bf16 v[36:39], v[108:111], v[72:75], v[36:39]
  v_mfma_f32_16x16x32_bf16 v[56:59], v[108:111], v[76:79], v[56:59]
  s_waitcnt lgkmcnt(4)
  v_mfma_f32_16x16x32_bf16 v[40:43], v[112:115], v[72:75], v[40:43]
  v_mfma_f32_16x16x32_bf16 v[60:63], v[112:115], v[76:79], v[60:63]
  s_waitcnt lgkmcnt(2)
  v_mfma_f32_16x16x32_bf16 v[44:47], v[116:119], v[72:75], v[44:47]
  v_mfma_f32_16x16x32_bf16 v[64:67], v[116:119], v[76:79], v[64:67]
  s_waitcnt lgkmcnt(0)
  v_mfma_f32_16x16x32_bf16 v[48:51], v[120:123], v[72:75], v[48:51]
  v_mfma_f32_16x16x32_bf16 v[68:71], v[120:123], v[76:79], v[68:71]
  s_waitcnt vmcnt(6)
  s_barrier
  s_add_u32 m0, s34, 0
  s_add_u32 s33, s40, 327680
  buffer_load_dwordx4 v7, s[12:15], s33 offen sc1 lds
  s_add_u32 m0, s34, 8192
  s_add_u32 s33, s40, 335872
  buffer_load_dwordx4 v7, s[12:15], s33 offen sc1 lds
  ds_read_b64_tr_b16 v[104:105], v8 offset:20480
  ds_read_b64_tr_b16 v[106:107], v8 offset:23040
  ds_read_b64_tr_b16 v[108:109], v8 offset:20488
  ds_read_b64_tr_b16 v[110:111], v8 offset:23048
  ds_read_b64_tr_b16 v[112:113], v8 offset:20496
  ds_read_b64_tr_b16 v[114:115], v8 offset:23056
  ds_read_b64_tr_b16 v[116:117], v8 offset:20504
  ds_read_b64_tr_b16 v[118:119], v8 offset:23064
  ds_read_b64_tr_b16 v[120:121], v8 offset:20512
  ds_read_b64_tr_b16 v[122:123], v8 offset:23072
  s_waitcnt lgkmcnt(8)
  v_mfma_f32_16x16x32_bf16 v[32:35], v[104:107], v[80:83], v[32:35]
  v_mfma_f32_16x16x32_bf16 v[52:55], v[104:107], v[84:87], v[52:55]
  s_waitcnt lgkmcnt(6)
  v_mfma_f32_16x16x32_bf16 v[36:39], v[108:111], v[80:83], v[36:39]
  v_mfma_f32_16x16x32_bf16 v[56:59], v[108:111], v[84:87], v[56:59]
  s_waitcnt lgkmcnt(4)
  v_mfma_f32_16x16x32_bf16 v[40:43], v[112:115], v[80:83], v[40:43]
  v_mfma_f32_16x16x32_bf16 v[60:63], v[112:115], v[84:87], v[60:63]
  s_waitcnt lgkmcnt(2)
  v_mfma_f32_16x16x32_bf16 v[44:47], v[116:119], v[80:83], v[44:47]
  v_mfma_f32_16x16x32_bf16 v[64:67], v[116:119], v[84:87], v[64:67]
  s_waitcnt lgkmcnt(0)
  v_mfma_f32_16x16x32_bf16 v[48:51], v[120:123], v[80:83], v[48:51]
  v_mfma_f32_16x16x32_bf16 v[68:71], v[120:123], v[84:87], v[68:71]
  s_waitcnt vmcnt(6)
  ds_read_b64_tr_b16 v[104:105], v9 offset:0
  ds_read_b64_tr_b16 v[106:107], v9 offset:2560
  ds_read_b64_tr_b16 v[108:109], v9 offset:8
  ds_read_b64_tr_b16 v[110:111], v9 offset:2568
  ds_read_b64_tr_b16 v[112:113], v9 offset:16
  ds_read_b64_tr_b16 v[114:115], v9 offset:2576
  ds_read_b64_tr_b16 v[116:117], v9 offset:24
  ds_read_b64_tr_b16 v[118:119], v9 offset:2584
  ds_read_b64_tr_b16 v[120:121], v9 offset:32
  ds_read_b64_tr_b16 v[122:123], v9 offset:2592
  s_waitcnt lgkmcnt(8)
  v_mfma_f32_16x16x32_bf16 v[32:35], v[104:107], v[88:91], v[32:35]
  v_mfma_f32_16x16x32_bf16 v[52:55], v[104:107], v[92:95], v[52:55]
  s_waitcnt lgkmcnt(6)
  v_mfma_f32_16x16x32_bf16 v[36:39], v[108:111], v[88:91], v[36:39]
  v_mfma_f32_16x16x32_bf16 v[56:59], v[108:111], v[92:95], v[56:59]
  s_waitcnt lgkmcnt(4)
  v_mfma_f32_16x16x32_bf16 v[40:43], v[112:115], v[88:91], v[40:43]
  v_mfma_f32_16x16x32_bf16 v[60:63], v[112:115], v[92:95], v[60:63]
  s_waitcnt lgkmcnt(2)
  v_mfma_f32_16x16x32_bf16 v[44:47], v[116:119], v[88:91], v[44:47]
  v_mfma_f32_16x16x32_bf16 v[64:67], v[116:119], v[92:95], v[64:67]
  s_waitcnt lgkmcnt(0)
  v_mfma_f32_16x16x32_bf16 v[48:51], v[120:123], v[88:91], v[48:51]
  v_mfma_f32_16x16x32_bf16 v[68:71], v[120:123], v[92:95], v[68:71]
  s_waitcnt vmcnt(4)
  ds_read_b64_tr_b16 v[104:105], v9 offset:20480
  ds_read_b64_tr_b16 v[106:107], v9 offset:23040
  ds_read_b64_tr_b16 v[108:109], v9 offset:20488
  ds_read_b64_tr_b16 v[110:111], v9 offset:23048
  ds_read_b64_tr_b16 v[112:113], v9 offset:20496
  ds_read_b64_tr_b16 v[114:115], v9 offset:23056
  ds_read_b64_tr_b16 v[116:117], v9 offset:20504
  ds_read_b64_tr_b16 v[118:119], v9 offset:23064
  ds_read_b64_tr_b16 v[120:121], v9 offset:20512
  ds_read_b64_tr_b16 v[122:123], v9 offset:23072
  s_waitcnt lgkmcnt(8)
  v_mfma_f32_16x16x32_bf16 v[32:35], v[104:107], v[96:99], v[32:35]
  v_mfma_f32_16x16x32_bf16 v[52:55], v[104:107], v[100:103], v[52:55]
  s_waitcnt lgkmcnt(6)
  v_mfma_f32_16x16x32_bf16 v[36:39], v[108:111], v[96:99], v[36:39]
  v_mfma_f32_16x16x32_bf16 v[56:59], v[108:111], v[100:103], v[56:59]
  s_waitcnt lgkmcnt(4)
  v_mfma_f32_16x16x32_bf16 v[40:43], v[112:115], v[96:99], v[40:43]
  v_mfma_f32_16x16x32_bf16 v[60:63], v[112:115], v[100:103], v[60:63]
  s_waitcnt lgkmcnt(2)
  v_mfma_f32_16x16x32_bf16 v[44:47], v[116:119], v[96:99], v[44:47]
  v_mfma_f32_16x16x32_bf16 v[64:67], v[116:119], v[100:103], v[64:67]
  s_waitcnt lgkmcnt(0)
  v_mfma_f32_16x16x32_bf16 v[48:51], v[120:123], v[96:99], v[48:51]
  v_mfma_f32_16x16x32_bf16 v[68:71], v[120:123], v[100:103], v[68:71]
  s_waitcnt vmcnt(0)
  s_barrier
  ds_read_b64_tr_b16 v[104:105], v8 offset:0
  ds_read_b64_tr_b16 v[106:107], v8 offset:2560
  ds_read_b64_tr_b16 v[108:109], v8 offset:8
  ds_read_b64_tr_b16 v[110:111], v8 offset:2568
  ds_read_b64_tr_b16 v[112:113], v8 offset:16
  ds_read_b64_tr_b16 v[114:115], v8 offset:2576
  ds_read_b64_tr_b16 v[116:117], v8 offset:24
  ds_read_b64_tr_b16 v[118:119], v8 offset:2584
  ds_read_b64_tr_b16 v[120:121], v8 offset:32
  ds_read_b64_tr_b16 v[122:123], v8 offset:2592
  s_waitcnt lgkmcnt(8)
  v_mfma_f32_16x16x32_bf16 v[32:35], v[104:107], v[16:19], v[32:35]
  v_mfma_f32_16x16x32_bf16 v[52:55], v[104:107], v[20:23], v[52:55]
  s_waitcnt lgkmcnt(6)
  v_mfma_f32_16x16x32_bf16 v[36:39], v[108:111], v[16:19], v[36:39]
  v_mfma_f32_16x16x32_bf16 v[56:59], v[108:111], v[20:23], v[56:59]
  s_waitcnt lgkmcnt(4)
  v_mfma_f32_16x16x32_bf16 v[40:43], v[112:115], v[16:19], v[40:43]
  v_mfma_f32_16x16x32_bf16 v[60:63], v[112:115], v[20:23], v[60:63]
  s_waitcnt lgkmcnt(2)
  v_mfma_f32_16x16x32_bf16 v[44:47], v[116:119], v[16:19], v[44:47]
  v_mfma_f32_16x16x32_bf16 v[64:67], v[116:119], v[20:23], v[64:67]
  s_waitcnt lgkmcnt(0)
  v_mfma_f32_16x16x32_bf16 v[48:51], v[120:123], v[16:19], v[48:51]
  v_mfma_f32_16x16x32_bf16 v[68:71], v[120:123], v[20:23], v[68:71]
  s_branch fgend_65
fg3_64:
  s_lshl_b32 s42, s23, 8
  s_add_u32 s42, s42, 4149248
  s_lshr_b32 s26, s21, 1
  s_lshl_b32 s26, s26, 7
  s_add_u32 s39, s26, 4132864
  s_cmp_lg_u32 s20, 7
  s_cbranch_scc1 fw_done_70
  v_lshlrev_b32 v72, 4, v1
  s_mov_b32 s29, 0
fw_loop_71:
  v_mul_u32_u24 v73, 8, v1
  v_cmp_gt_u32 vcc, 32, v1
  v_mov_b32 v74, s57
  s_and_saveexec_b64 s[58:59], vcc
  buffer_load_dword v74, v73, s[12:15], s42 offen sc1
  s_mov_b64 exec, -1
  v_mul_u32_u24 v73, 8, v1
  v_cmp_gt_u32 vcc, 16, v1
  v_mov_b32 v75, s57
  s_and_saveexec_b64 s[58:59], vcc
  buffer_load_dword v75, v73, s[12:15], s39 offen sc1
  s_mov_b64 exec, -1
  s_mov_b32 s28, 4128768
  buffer_load_dwordx4 v[76:79], v72, s[12:15], s28 offen sc1
  buffer_load_dwordx4 v[80:83], v72, s[12:15], s28 offen offset:1024 sc1
  s_waitcnt vmcnt(0)
  s_add_u32 s29, s29, 1
  s_cmp_ge_u32 s29, 200000
  s_cbranch_scc1 fw_done_70
  v_cmp_ne_u32 vcc, s57, v74
  s_cbranch_vccnz fw_loop_71
  v_cmp_ne_u32 vcc, s57, v75
  s_cbranch_vccnz fw_loop_71
  v_cmp_ne_u32 vcc, s57, v76
  s_cbranch_vccnz fw_loop_71
  v_cmp_ne_u32 vcc, s57, v78
  s_cbranch_vccnz fw_loop_71
  v_cmp_ne_u32 vcc, s57, v80
  s_cbranch_vccnz fw_loop_71
  v_cmp_ne_u32 vcc, s57, v82
  s_cbranch_vccnz fw_loop_71
fw_done_70:
  s_barrier
  v_and_b32 v2, 15, v1
  v_add_u32 v2, s38, v2
  v_lshlrev_b32 v2, 2, v2
  s_mov_b32 s27, 196608
  buffer_load_dword v10, v2, s[12:15], s27 offen sc1
  buffer_load_dword v11, v2, s[12:15], s27 offen offset:64 sc1
  s_add_u32 m0, s34, 0
  s_add_u32 s33, s40, 0
  buffer_load_dwordx4 v7, s[12:15], s33 offen sc1 lds
  s_add_u32 m0, s34, 8192
  s_add_u32 s33, s40, 8192
  buffer_load_dwordx4 v7, s[12:15], s33 offen sc1 lds
  s_add_u32 m0, s34, 16384
  s_add_u32 s33, s40, 16384
  buffer_load_dwordx4 v7, s[12:15], s33 offen sc1 lds
  s_add_u32 s33, s36, 0
  buffer_load_dwordx4 v[72:75], v7, s[12:15], s33 offen sc1
  s_add_u32 s33, s36, 49152
  buffer_load_dwordx4 v[76:79], v7, s[12:15], s33 offen sc1
  s_add_u32 m0, s34, 20480
  s_add_u32 s33, s40, 20480
  buffer_load_dwordx4 v7, s[12:15], s33 offen sc1 lds
  s_add_u32 m0, s34, 28672
  s_add_u32 s33, s40, 28672
  buffer_load_dwordx4 v7, s[12:15], s33 offen sc1 lds
  s_add_u32 m0, s34, 36864
  s_add_u32 s33, s40, 36864
  buffer_load_dwordx4 v7, s[12:15], s33 offen sc1 lds
  s_add_u32 s33, s36, 4096
  buffer_load_dwordx4 v[80:83], v7, s[12:15], s33 offen sc1
  s_add_u32 s33, s36, 53248
  buffer_load_dwordx4 v[84:87], v7, s[12:15], s33 offen sc1
  s_add_u32 m0, s34, 40960
  s_add_u32 s33, s40, 40960
  buffer_load_dwordx4 v7, s[12:15], s33 offen sc1 lds
  s_add_u32 m0, s34, 49152
  s_add_u32 s33, s40, 49152
  buffer_load_dwordx4 v7, s[12:15], s33 offen sc1 lds
  s_add_u32 m0, s34, 57344
  s_add_u32 s33, s40, 57344
  buffer_load_dwordx4 v7, s[12:15], s33 offen sc1 lds
  s_add_u32 s33, s36, 8192
  buffer_load_dwordx4 v[88:91], v7, s[12:15], s33 offen sc1
  s_add_u32 s33, s36, 57344
  buffer_load_dwordx4 v[92:95], v7, s[12:15], s33 offen sc1
  s_waitcnt vmcnt(10)
  s_barrier
  s_add_u32 m0, s34, 61440
  s_add_u32 s33, s40, 61440
  buffer_load_dwordx4 v7, s[12:15], s33 offen sc1 lds
  s_add_u32 m0, s34, 69632
  s_add_u32 s33, s40, 69632
  buffer_load_dwordx4 v7, s[12:15], s33 offen sc1 lds
  s_add_u32 m0, s34, 77824
  s_add_u32 s33, s40, 77824
  buffer_load_dwordx4 v7, s[12:15], s33 offen sc1 lds
  s_add_u32 s33, s36, 12288
  buffer_load_dwordx4 v[96:99], v7, s[12:15], s33 offen sc1
  s_add_u32 s33, s36, 61440
  buffer_load_dwordx4 v[100:103], v7, s[12:15], s33 offen sc1
  ds_read_b64_tr_b16 v[104:105], v8 offset:0
  ds_read_b64_tr_b16 v[106:107], v8 offset:2560
  ds_read_b64_tr_b16 v[108:109], v8 offset:8
  ds_read_b64_tr_b16 v[110:111], v8 offset:2568
  ds_read_b64_tr_b16 v[112:113], v8 offset:16
  ds_read_b64_tr_b16 v[114:115], v8 offset:2576
  ds_read_b64_tr_b16 v[116:117], v8 offset:24
  ds_read_b64_tr_b16 v[118:119], v8 offset:2584
  ds_read_b64_tr_b16 v[120:121], v8 offset:32
  ds_read_b64_tr_b16 v[122:123], v8 offset:2592
  s_waitcnt lgkmcnt(8)
  v_mfma_f32_16x16x32_bf16 v[32:35], v[104:107], v[72:75], 0
  v_mfma_f32_16x16x32_bf16 v[52:55], v[104:107], v[76:79], 0
  s_waitcnt lgkmcnt(6)
  v_mfma_f32_16x16x32_bf16 v[36:39], v[108:111], v[72:75], 0
  v_mfma_f32_16x16x32_bf16 v[56:59], v[108:111], v[76:79], 0
  s_waitcnt lgkmcnt(4)
  v_mfma_f32_16x16x32_bf16 v[40:43], v[112:115], v[72:75], 0
  v_mfma_f32_16x16x32_bf16 v[60:63], v[112:115], v[76:79], 0
  s_waitcnt lgkmcnt(2)
  v_mfma_f32_16x16x32_bf16 v[44:47], v[116:119], v[72:75], 0
  v_mfma_f32_16x16x32_bf16 v[64:67], v[116:119], v[76:79], 0
  s_waitcnt lgkmcnt(0)
  v_mfma_f32_16x16x32_bf16 v[48:51], v[120:123], v[72:75], 0
  v_mfma_f32_16x16x32_bf16 v[68:71], v[120:123], v[76:79], 0
  s_waitcnt vmcnt(10)
  s_barrier
  s_add_u32 m0, s34, 0
  s_add_u32 s33, s40, 81920
  buffer_load_dwordx4 v7, s[12:15], s33 offen sc1 lds
  s_add_u32 m0, s34, 8192
  s_add_u32 s33, s40, 90112
  buffer_load_dwordx4 v7, s[12:15], s33 offen sc1 lds
  s_add_u32 m0, s34, 16384
  s_add_u32 s33, s40, 98304
  buffer_load_dwordx4 v7, s[12:15], s33 offen sc1 lds
  s_add_u32 s33, s36, 16384
  buffer_load_dwordx4 v[72:75], v7, s[12:15], s33 offen sc1
  s_add_u32 s33, s36, 65536
  buffer_load_dwordx4 v[76:79], v7, s[12:15], s33 offen sc1
  ds_read_b64_tr_b16 v[104:105], v8 offset:20480
  ds_read_b64_tr_b16 v[106:107], v8 offset:23040
  ds_read_b64_tr_b16 v[108:109], v8 offset:20488
  ds_read_b64_tr_b16 v[110:111], v8 offset:23048
  ds_read_b64_tr_b16 v[112:113], v8 offset:20496
  ds_read_b64_tr_b16 v[114:115], v8 offset:23056
  ds_read_b64_tr_b16 v[116:117], v8 offset:20504
  ds_read_b64_tr_b16 v[118:119], v8 offset:23064
  ds_read_b64_tr_b16 v[120:121], v8 offset:20512
  ds_read_b64_tr_b16 v[122:123], v8 offset:23072
  s_waitcnt lgkmcnt(8)
  v_mfma_f32_16x16x32_bf16 v[32:35], v[104:107], v[80:83], v[32:35]
  v_mfma_f32_16x16x32_bf16 v[52:55], v[104:107], v[84:87], v[52:55]
  s_waitcnt lgkmcnt(6)
  v_mfma_f32_16x16x32_bf16 v[36:39], v[108:111], v[80:83], v[36:39]
  v_mfma_f32_16x16x32_bf16 v[56:59], v[108:111], v[84:87], v[56:59]
  s_waitcnt lgkmcnt(4)
  v_mfma_f32_16x16x32_bf16 v[40:43], v[112:115], v[80:83], v[40:43]
  v_mfma_f32_16x16x32_bf16 v[60:63], v[112:115], v[84:87], v[60:63]
  s_waitcnt lgkmcnt(2)
  v_mfma_f32_16x16x32_bf16 v[44:47], v[116:119], v[80:83], v[44:47]
  v_mfma_f32_16x16x32_bf16 v[64:67], v[116:119], v[84:87], v[64:67]
  s_waitcnt lgkmcnt(0)
  v_mfma_f32_16x16x32_bf16 v[48:51], v[120:123], v[80:83], v[48:51]
  v_mfma_f32_16x16x32_bf16 v[68:71], v[120:123], v[84:87], v[68:71]
  s_waitcnt vmcnt(10)
  s_barrier
  s_add_u32 m0, s34, 20480
  s_add_u32 s33, s40, 102400
  buffer_load_dwordx4 v7, s[12:15], s33 offen sc1 lds
  s_add_u32 m0, s34, 28672
  s_add_u32 s33, s40, 110592
  buffer_load_dwordx4 v7, s[12:15], s33 offen sc1 lds
  s_add_u32 m0, s34, 36864
  s_add_u32 s33, s40, 118784
  buffer_load_dwordx4 v7, s[12:15], s33 offen sc1 lds
  s_add_u32 s33, s36, 20480
  buffer_load_dwordx4 v[80:83], v7, s[12:15], s33 offen sc1
  s_add_u32 s33, s36, 69632
  buffer_load_dwordx4 v[84:87], v7, s[12:15], s33 offen sc1
  ds_read_b64_tr_b16 v[104:105], v9 offset:0
  ds_read_b64_tr_b16 v[106:107], v9 offset:2560
  ds_read_b64_tr_b16 v[108:109], v9 offset:8
  ds_read_b64_tr_b16 v[110:111], v9 offset:2568
  ds_read_b64_tr_b16 v[112:113], v9 offset:16
  ds_read_b64_tr_b16 v[114:115], v9 offset:2576
  ds_read_b64_tr_b16 v[116:117], v9 offset:24
  ds_read_b64_tr_b16 v[118:119], v9 offset:2584
  ds_read_b64_tr_b16 v[120:121], v9 offset:32
  ds_read_b64_tr_b16 v[122:123], v9 offset:2592
  s_waitcnt lgkmcnt(8)
  v_mfma_f32_16x16x32_bf16 v[32:35], v[104:107], v[88:91], v[32:35]
  v_mfma_f32_16x16x32_bf16 v[52:55], v[104:107], v[92:95], v[52:55]
  s_waitcnt lgkmcnt(6)
  v_mfma_f32_16x16x32_bf16 v[36:39], v[108:111], v[88:91], v[36:39]
  v_mfma_f32_16x16x32_bf16 v[56:59], v[108:111], v[92:95], v[56:59]
  s_waitcnt lgkmcnt(4)
  v_mfma_f32_16x16x32_bf16 v[40:43], v[112:115], v[88:91], v[40:43]
  v_mfma_f32_16x16x32_bf16 v[60:63], v[112:115], v[92:95], v[60:63]
  s_waitcnt lgkmcnt(2)
  v_mfma_f32_16x16x32_bf16 v[44:47], v[116:119], v[88:91], v[44:47]
  v_mfma_f32_16x16x32_bf16 v[64:67], v[116:119], v[92:95], v[64:67]
  s_waitcnt lgkmcnt(0)
  v_mfma_f32_16x16x32_bf16 v[48:51], v[120:123], v[88:91], v[48:51]
  v_mfma_f32_16x16x32_bf16 v[68:71], v[120:123], v[92:95], v[68:71]
  s_waitcnt vmcnt(10)
  s_barrier
  s_add_u32 m0, s34, 40960
  s_add_u32 s33, s40, 122880
  buffer_load_dwordx4 v7, s[12:15], s33 offen sc1 lds
  s_add_u32 m0, s34, 49152
  s_add_u32 s33, s40, 131072
  buffer_load_dwordx4 v7, s[12:15], s33 offen sc1 lds
  s_add_u32 m0, s34, 57344
  s_add_u32 s33, s40, 139264
  buffer_load_dwordx4 v7, s[12:15], s33 offen sc1 lds
  s_add_u32 s33, s36, 24576
  buffer_load_dwordx4 v[88:91], v7, s[12:15], s33 offen sc1
  s_add_u32 s33, s36, 73728
  buffer_load_dwordx4 v[92:95], v7, s[12:15], s33 offen sc1
  ds_read_b64_tr_b16 v[104:105], v9 offset:20480
  ds_read_b64_tr_b16 v[106:107], v9 offset:23040
  ds_read_b64_tr_b16 v[108:109], v9 offset:20488
  ds_read_b64_tr_b16 v[110:111], v9 offset:23048
  ds_read_b64_tr_b16 v[112:113], v9 offset:20496
  ds_read_b64_tr_b16 v[114:115], v9 offset:23056
  ds_read_b64_tr_b16 v[116:117], v9 offset:20504
  ds_read_b64_tr_b16 v[118:119], v9 offset:23064
  ds_read_b64_tr_b16 v[120:121], v9 offset:20512
  ds_read_b64_tr_b16 v[122:123], v9 offset:23072
  s_waitcnt lgkmcnt(8)
  v_mfma_f32_16x16x32_bf16 v[32:35], v[104:107], v[96:99], v[32:35]
  v_mfma_f32_16x16x32_bf16 v[52:55], v[104:107], v[100:103], v[52:55]
  s_waitcnt lgkmcnt(6)
  v_mfma_f32_16x16x32_bf16 v[36:39], v[108:111], v[96:99], v[36:39]
  v_mfma_f32_16x16x32_bf16 v[56:59], v[108:111], v[100:103], v[56:59]
  s_waitcnt lgkmcnt(4)
  v_mfma_f32_16x16x32_bf16 v[40:43], v[112:115], v[96:99], v[40:43]
  v_mfma_f32_16x16x32_bf16 v[60:63], v[112:115], v[100:103], v[60:63]
  s_waitcnt lgkmcnt(2)
  v_mfma_f32_16x16x32_bf16 v[44:47], v[116:119], v[96:99], v[44:47]
  v_mfma_f32_16x16x32_bf16 v[64:67], v[116:119], v[100:103], v[64:67]
  s_waitcnt lgkmcnt(0)
  v_mfma_f32_16x16x32_bf16 v[48:51], v[120:123], v[96:99], v[48:51]
  v_mfma_f32_16x16x32_bf16 v[68:71], v[120:123], v[100:103], v[68:71]
  s_waitcnt vmcnt(10)
  s_barrier
  s_add_u32 m0, s34, 61440
  s_add_u32 s33, s40, 143360
  buffer_load_dwordx4 v7, s[12:15], s33 offen sc1 lds
  s_add_u32 m0, s34, 69632
  s_add_u32 s33, s40, 151552
  buffer_load_dwordx4 v7, s[12:15], s33 offen sc1 lds
  s_add_u32 m0, s34, 77824
  s_add_u32 s33, s40, 159744
  buffer_load_dwordx4 v7, s[12:15], s33 offen sc1 lds
  s_add_u32 s33, s36, 28672
  buffer_load_dwordx4 v[96:99], v7, s[12:15], s33 offen sc1
  s_add_u32 s33, s36, 77824
  buffer_load_dwordx4 v[100:103], v7, s[12:15], s33 offen sc1
  ds_read_b64_tr_b16 v[104:105], v8 offset:0
  ds_read_b64_tr_b16 v[106:107], v8 offset:2560
  ds_read_b64_tr_b16 v[108:109], v8 offset:8
  ds_read_b64_tr_b16 v[110:111], v8 offset:2568
  ds_read_b64_tr_b16 v[112:113], v8 offset:16
  ds_read_b64_tr_b16 v[114:115], v8 offset:2576
  ds_read_b64_tr_b16 v[116:117], v8 offset:24
  ds_read_b64_tr_b16 v[118:119], v8 offset:2584
  ds_read_b64_tr_b16 v[120:121], v8 offset:32
  ds_read_b64_tr_b16 v[122:123], v8 offset:2592
  s_waitcnt lgkmcnt(8)
  v_mfma_f32_16x16x32_bf16 v[32:35], v[104:107], v[72:75], v[32:35]
  v_mfma_f32_16x16x32_bf16 v[52:55], v[104:107], v[76:79], v[52:55]
  s_waitcnt lgkmcnt(6)
  v_mfma_f32_16x16x32_bf16 v[36:39], v[108:111], v[72:75], v[36:39]
  v_mfma_f32_16x16x32_bf16 v[56:59], v[108:111], v[76:79], v[56:59]
  s_waitcnt lgkmcnt(4)
  v_mfma_f32_16x16x32_bf16 v[40:43], v[112:115], v[72:75], v[40:43]
  v_mfma_f32_16x16x32_bf16 v[60:63], v[112:115], v[76:79], v[60:63]
  s_waitcnt lgkmcnt(2)
  v_mfma_f32_16x16x32_bf16 v[44:47], v[116:119], v[72:75], v[44:47]
  v_mfma_f32_16x16x32_bf16 v[64:67], v[116:119], v[76:79], v[64:67]
  s_waitcnt lgkmcnt(0)
  v_mfma_f32_16x16x32_bf16 v[48:51], v[120:123], v[72:75], v[48:51]
  v_mfma_f32_16x16x32_bf16 v[68:71], v[120:123], v[76:79], v[68:71]
  s_waitcnt vmcnt(10)
  s_barrier
  s_add_u32 m0, s34, 0
  s_add_u32 s33, s40, 163840
  buffer_load_dwordx4 v7, s[12:15], s33 offen sc1 lds
  s_add_u32 m0, s34, 8192
  s_add_u32 s33, s40, 172032
  buffer_load_dwordx4 v7, s[12:15], s33 offen sc1 lds
  s_add_u32 m0, s34, 16384
  s_add_u32 s33, s40, 180224
  buffer_load_dwordx4 v7, s[12:15], s33 offen sc1 lds
  s_add_u32 s33, s36, 32768
  buffer_load_dwordx4 v[72:75], v7, s[12:15], s33 offen sc1
  s_add_u32 s33, s36, 81920
  buffer_load_dwordx4 v[76:79], v7, s[12:15], s33 offen sc1
  ds_read_b64_tr_b16 v[104:105], v8 offset:20480
  ds_read_b64_tr_b16 v[106:107], v8 offset:23040
  ds_read_b64_tr_b16 v[108:109], v8 offset:20488
  ds_read_b64_tr_b16 v[110:111], v8 offset:23048
  ds_read_b64_tr_b16 v[112:113], v8 offset:20496
  ds_read_b64_tr_b16 v[114:115], v8 offset:23056
  ds_read_b64_tr_b16 v[116:117], v8 offset:20504
  ds_read_b64_tr_b16 v[118:119], v8 offset:23064
  ds_read_b64_tr_b16 v[120:121], v8 offset:20512
  ds_read_b64_tr_b16 v[122:123], v8 offset:23072
  s_waitcnt lgkmcnt(8)
  v_mfma_f32_16x16x32_bf16 v[32:35], v[104:107], v[80:83], v[32:35]
  v_mfma_f32_16x16x32_bf16 v[52:55], v[104:107], v[84:87], v[52:55]
  s_waitcnt lgkmcnt(6)
  v_mfma_f32_16x16x32_bf16 v[36:39], v[108:111], v[80:83], v[36:39]
  v_mfma_f32_16x16x32_bf16 v[56:59], v[108:111], v[84:87], v[56:59]
  s_waitcnt lgkmcnt(4)
  v_mfma_f32_16x16x32_bf16 v[40:43], v[112:115], v[80:83], v[40:43]
  v_mfma_f32_16x16x32_bf16 v[60:63], v[112:115], v[84:87], v[60:63]
  s_waitcnt lgkmcnt(2)
  v_mfma_f32_16x16x32_bf16 v[44:47], v[116:119], v[80:83], v[44:47]
  v_mfma_f32_16x16x32_bf16 v[64:67], v[116:119], v[84:87], v[64:67]
  s_waitcnt lgkmcnt(0)
  v_mfma_f32_16x16x32_bf16 v[48:51], v[120:123], v[80:83], v[48:51]
  v_mfma_f32_16x16x32_bf16 v[68:71], v[120:123], v[84:87], v[68:71]
  s_waitcnt vmcnt(10)
  s_barrier
  s_add_u32 m0, s34, 20480
  s_add_u32 s33, s40, 184320
  buffer_load_dwordx4 v7, s[12:15], s33 offen sc1 lds
  s_add_u32 m0, s34, 28672
  s_add_u32 s33, s40, 192512
  buffer_load_dwordx4 v7, s[12:15], s33 offen sc1 lds
  s_add_u32 m0, s34, 36864
  s_add_u32 s33, s40, 200704
  buffer_load_dwordx4 v7, s[12:15], s33 offen sc1 lds
  s_add_u32 s33, s36, 36864
  buffer_load_dwordx4 v[80:83], v7, s[12:15], s33 offen sc1
  s_add_u32 s33, s36, 86016
  buffer_load_dwordx4 v[84:87], v7, s[12:15], s33 offen sc1
  ds_read_b64_tr_b16 v[104:105], v9 offset:0
  ds_read_b64_tr_b16 v[106:107], v9 offset:2560
  ds_read_b64_tr_b16 v[108:109], v9 offset:8
  ds_read_b64_tr_b16 v[110:111], v9 offset:2568
  ds_read_b64_tr_b16 v[112:113], v9 offset:16
  ds_read_b64_tr_b16 v[114:115], v9 offset:2576
  ds_read_b64_tr_b16 v[116:117], v9 offset:24
  ds_read_b64_tr_b16 v[118:119], v9 offset:2584
  ds_read_b64_tr_b16 v[120:121], v9 offset:32
  ds_read_b64_tr_b16 v[122:123], v9 offset:2592
  s_waitcnt lgkmcnt(8)
  v_mfma_f32_16x16x32_bf16 v[32:35], v[104:107], v[88:91], v[32:35]
  v_mfma_f32_16x16x32_bf16 v[52:55], v[104:107], v[92:95], v[52:55]
  s_waitcnt lgkmcnt(6)
  v_mfma_f32_16x16x32_bf16 v[36:39], v[108:111], v[88:91], v[36:39]
  v_mfma_f32_16x16x32_bf16 v[56:59], v[108:111], v[92:95], v[56:59]
  s_waitcnt lgkmcnt(4)
  v_mfma_f32_16x16x32_bf16 v[40:43], v[112:115], v[88:91], v[40:43]
  v_mfma_f32_16x16x32_bf16 v[60:63], v[112:115], v[92:95], v[60:63]
  s_waitcnt lgkmcnt(2)
  v_mfma_f32_16x16x32_bf16 v[44:47], v[116:119], v[88:91], v[44:47]
  v_mfma_f32_16x16x32_bf16 v[64:67], v[116:119], v[92:95], v[64:67]
  s_waitcnt lgkmcnt(0)
  v_mfma_f32_16x16x32_bf16 v[48:51], v[120:123], v[88:91], v[48:51]
  v_mfma_f32_16x16x32_bf16 v[68:71], v[120:123], v[92:95], v[68:71]
  s_waitcnt vmcnt(10)
  s_barrier
  s_add_u32 m0, s34, 40960
  s_add_u32 s33, s40, 204800
  buffer_load_dwordx4 v7, s[12:15], s33 offen sc1 lds
  s_add_u32 m0, s34, 49152
  s_add_u32 s33, s40, 212992
  buffer_load_dwordx4 v7, s[12:15], s33 offen sc1 lds
  s_add_u32 m0, s34, 57344
  s_add_u32 s33, s40, 221184
  buffer_load_dwordx4 v7, s[12:15], s33 offen sc1 lds
  s_add_u32 s33, s36, 40960
  buffer_load_dwordx4 v[88:91], v7, s[12:15], s33 offen sc1
  s_add_u32 s33, s36, 90112
  buffer_load_dwordx4 v[92:95], v7, s[12:15], s33 offen sc1
  ds_read_b64_tr_b16 v[104:105], v9 offset:20480
  ds_read_b64_tr_b16 v[106:107], v9 offset:23040
  ds_read_b64_tr_b16 v[108:109], v9 offset:20488
  ds_read_b64_tr_b16 v[110:111], v9 offset:23048
  ds_read_b64_tr_b16 v[112:113], v9 offset:20496
  ds_read_b64_tr_b16 v[114:115], v9 offset:23056
  ds_read_b64_tr_b16 v[116:117], v9 offset:20504
  ds_read_b64_tr_b16 v[118:119], v9 offset:23064
  ds_read_b64_tr_b16 v[120:121], v9 offset:20512
  ds_read_b64_tr_b16 v[122:123], v9 offset:23072
  s_waitcnt lgkmcnt(8)
  v_mfma_f32_16x16x32_bf16 v[32:35], v[104:107], v[96:99], v[32:35]
  v_mfma_f32_16x16x32_bf16 v[52:55], v[104:107], v[100:103], v[52:55]
  s_waitcnt lgkmcnt(6)
  v_mfma_f32_16x16x32_bf16 v[36:39], v[108:111], v[96:99], v[36:39]
  v_mfma_f32_16x16x32_bf16 v[56:59], v[108:111], v[100:103], v[56:59]
  s_waitcnt lgkmcnt(4)
  v_mfma_f32_16x16x32_bf16 v[40:43], v[112:115], v[96:99], v[40:43]
  v_mfma_f32_16x16x32_bf16 v[60:63], v[112:115], v[100:103], v[60:63]
  s_waitcnt lgkmcnt(2)
  v_mfma_f32_16x16x32_bf16 v[44:47], v[116:119], v[96:99], v[44:47]
  v_mfma_f32_16x16x32_bf16 v[64:67], v[116:119], v[100:103], v[64:67]
  s_waitcnt lgkmcnt(0)
  v_mfma_f32_16x16x32_bf16 v[48:51], v[120:123], v[96:99], v[48:51]
  v_mfma_f32_16x16x32_bf16 v[68:71], v[120:123], v[100:103], v[68:71]
  s_waitcnt vmcnt(10)
  s_barrier
  s_add_u32 m0, s34, 61440
  s_add_u32 s33, s40, 225280
  buffer_load_dwordx4 v7, s[12:15], s33 offen sc1 lds
  s_add_u32 m0, s34, 69632
  s_add_u32 s33, s40, 233472
  buffer_load_dwordx4 v7, s[12:15], s33 offen sc1 lds
  s_add_u32 m0, s34, 77824
  s_add_u32 s33, s40, 241664
  buffer_load_dwordx4 v7, s[12:15], s33 offen sc1 lds
  s_add_u32 s33, s36, 45056
  buffer_load_dwordx4 v[96:99], v7, s[12:15], s33 offen sc1
  s_add_u32 s33, s36, 94208
  buffer_load_dwordx4 v[100:103], v7, s[12:15], s33 offen sc1
  ds_read_b64_tr_b16 v[104:105], v8 offset:0
  ds_read_b64_tr_b16 v[106:107], v8 offset:2560
  ds_read_b64_tr_b16 v[108:109], v8 offset:8
  ds_read_b64_tr_b16 v[110:111], v8 offset:2568
  ds_read_b64_tr_b16 v[112:113], v8 offset:16
  ds_read_b64_tr_b16 v[114:115], v8 offset:2576
  ds_read_b64_tr_b16 v[116:117], v8 offset:24
  ds_read_b64_tr_b16 v[118:119], v8 offset:2584
  ds_read_b64_tr_b16 v[120:121], v8 offset:32
  ds_read_b64_tr_b16 v[122:123], v8 offset:2592
  s_waitcnt lgkmcnt(8)
  v_mfma_f32_16x16x32_bf16 v[32:35], v[104:107], v[72:75], v[32:35]
  v_mfma_f32_16x16x32_bf16 v[52:55], v[104:107], v[76:79], v[52:55]
  s_waitcnt lgkmcnt(6)
  v_mfma_f32_16x16x32_bf16 v[36:39], v[108:111], v[72:75], v[36:39]
  v_mfma_f32_16x16x32_bf16 v[56:59], v[108:111], v[76:79], v[56:59]
  s_waitcnt lgkmcnt(4)
  v_mfma_f32_16x16x32_bf16 v[40:43], v[112:115], v[72:75], v[40:43]
  v_mfma_f32_16x16x32_bf16 v[60:63], v[112:115], v[76:79], v[60:63]
  s_waitcnt lgkmcnt(2)
  v_mfma_f32_16x16x32_bf16 v[44:47], v[116:119], v[72:75], v[44:47]
  v_mfma_f32_16x16x32_bf16 v[64:67], v[116:119], v[76:79], v[64:67]
  s_waitcnt lgkmcnt(0)
  v_mfma_f32_16x16x32_bf16 v[48:51], v[120:123], v[72:75], v[48:51]
  v_mfma_f32_16x16x32_bf16 v[68:71], v[120:123], v[76:79], v[68:71]
  s_waitcnt vmcnt(10)
  s_barrier
  s_add_u32 m0, s34, 0
  s_add_u32 s33, s40, 245760
  buffer_load_dwordx4 v7, s[12:15], s33 offen sc1 lds
  s_add_u32 m0, s34, 8192
  s_add_u32 s33, s40, 253952
  buffer_load_dwordx4 v7, s[12:15], s33 offen sc1 lds
  s_add_u32 m0, s34, 16384
  s_add_u32 s33, s40, 262144
  buffer_load_dwordx4 v7, s[12:15], s33 offen sc1 lds
  ds_read_b64_tr_b16 v[104:105], v8 offset:20480
  ds_read_b64_tr_b16 v[106:107], v8 offset:23040
  ds_read_b64_tr_b16 v[108:109], v8 offset:20488
  ds_read_b64_tr_b16 v[110:111], v8 offset:23048
  ds_read_b64_tr_b16 v[112:113], v8 offset:20496
  ds_read_b64_tr_b16 v[114:115], v8 offset:23056
  ds_read_b64_tr_b16 v[116:117], v8 offset:20504
  ds_read_b64_tr_b16 v[118:119], v8 offset:23064
  ds_read_b64_tr_b16 v[120:121], v8 offset:20512
  ds_read_b64_tr_b16 v[122:123], v8 offset:23072
  s_waitcnt lgkmcnt(8)
  v_mfma_f32_16x16x32_bf16 v[32:35], v[104:107], v[80:83], v[32:35]
  v_mfma_f32_16x16x32_bf16 v[52:55], v[104:107], v[84:87], v[52:55]
  s_waitcnt lgkmcnt(6)
  v_mfma_f32_16x16x32_bf16 v[36:39], v[108:111], v[80:83], v[36:39]
  v_mfma_f32_16x16x32_bf16 v[56:59], v[108:111], v[84:87], v[56:59]
  s_waitcnt lgkmcnt(4)
  v_mfma_f32_16x16x32_bf16 v[40:43], v[112:115], v[80:83], v[40:43]
  v_mfma_f32_16x16x32_bf16 v[60:63], v[112:115], v[84:87], v[60:63]
  s_waitcnt lgkmcnt(2)
  v_mfma_f32_16x16x32_bf16 v[44:47], v[116:119], v[80:83], v[44:47]
  v_mfma_f32_16x16x32_bf16 v[64:67], v[116:119], v[84:87], v[64:67]
  s_waitcnt lgkmcnt(0)
  v_mfma_f32_16x16x32_bf16 v[48:51], v[120:123], v[80:83], v[48:51]
  v_mfma_f32_16x16x32_bf16 v[68:71], v[120:123], v[84:87], v[68:71]
  s_waitcnt vmcnt(8)
  s_barrier
  s_add_u32 m0, s34, 20480
  s_add_u32 s33, s40, 266240
  buffer_load_dwordx4 v7, s[12:15], s33 offen sc1 lds
  s_add_u32 m0, s34, 28672
  s_add_u32 s33, s40, 274432
  buffer_load_dwordx4 v7, s[12:15], s33 offen sc1 lds
  s_add_u32 m0, s34, 36864
  s_add_u32 s33, s40, 282624
  buffer_load_dwordx4 v7, s[12:15], s33 offen sc1 lds
  ds_read_b64_tr_b16 v[104:105], v9 offset:0
  ds_read_b64_tr_b16 v[106:107], v9 offset:2560
  ds_read_b64_tr_b16 v[108:109], v9 offset:8
  ds_read_b64_tr_b16 v[110:111], v9 offset:2568
  ds_read_b64_tr_b16 v[112:113], v9 offset:16
  ds_read_b64_tr_b16 v[114:115], v9 offset:2576
  ds_read_b64_tr_b16 v[116:117], v9 offset:24
  ds_read_b64_tr_b16 v[118:119], v9 offset:2584
  ds_read_b64_tr_b16 v[120:121], v9 offset:32
  ds_read_b64_tr_b16 v[122:123], v9 offset:2592
  s_waitcnt lgkmcnt(8)
  v_mfma_f32_16x16x32_bf16 v[32:35], v[104:107], v[88:91], v[32:35]
  v_mfma_f32_16x16x32_bf16 v[52:55], v[104:107], v[92:95], v[52:55]
  s_waitcnt lgkmcnt(6)
  v_mfma_f32_16x16x32_bf16 v[36:39], v[108:111], v[88:91], v[36:39]
  v_mfma_f32_16x16x32_bf16 v[56:59], v[108:111], v[92:95], v[56:59]
  s_waitcnt lgkmcnt(4)
  v_mfma_f32_16x16x32_bf16 v[40:43], v[112:115], v[88:91], v[40:43]
  v_mfma_f32_16x16x32_bf16 v[60:63], v[112:115], v[92:95], v[60:63]
  s_waitcnt lgkmcnt(2)
  v_mfma_f32_16x16x32_bf16 v[44:47], v[116:119], v[88:91], v[44:47]
  v_mfma_f32_16x16x32_bf16 v[64:67], v[116:119], v[92:95], v[64:67]
  s_waitcnt lgkmcnt(0)
  v_mfma_f32_16x16x32_bf16 v[48:51], v[120:123], v[88:91], v[48:51]
  v_mfma_f32_16x16x32_bf16 v[68:71], v[120:123], v[92:95], v[68:71]
  s_waitcnt vmcnt(6)
  s_barrier
  s_add_u32 m0, s34, 40960
  s_add_u32 s33, s40, 286720
  buffer_load_dwordx4 v7, s[12:15], s33 offen sc1 lds
  s_add_u32 m0, s34, 49152
  s_add_u32 s33, s40, 294912
  buffer_load_dwordx4 v7, s[12:15], s33 offen sc1 lds
  s_add_u32 m0, s34, 57344
  s_add_u32 s33, s40, 303104
  buffer_load_dwordx4 v7, s[12:15], s33 offen sc1 lds
  ds_read_b64_tr_b16 v[104:105], v9 offset:20480
  ds_read_b64_tr_b16 v[106:107], v9 offset:23040
  ds_read_b64_tr_b16 v[108:109], v9 offset:20488
  ds_read_b64_tr_b16 v[110:111], v9 offset:23048
  ds_read_b64_tr_b16 v[112:113], v9 offset:20496
  ds_read_b64_tr_b16 v[114:115], v9 offset:23056
  ds_read_b64_tr_b16 v[116:117], v9 offset:20504
  ds_read_b64_tr_b16 v[118:119], v9 offset:23064
  ds_read_b64_tr_b16 v[120:121], v9 offset:20512
  ds_read_b64_tr_b16 v[122:123], v9 offset:23072
  s_waitcnt lgkmcnt(8)
  v_mfma_f32_16x16x32_bf16 v[32:35], v[104:107], v[96:99], v[32:35]
  v_mfma_f32_16x16x32_bf16 v[52:55], v[104:107], v[100:103], v[52:55]
  s_waitcnt lgkmcnt(6)
  v_mfma_f32_16x16x32_bf16 v[36:39], v[108:111], v[96:99], v[36:39]
  v_mfma_f32_16x16x32_bf16 v[56:59], v[108:111], v[100:103], v[56:59]
  s_waitcnt lgkmcnt(4)
  v_mfma_f32_16x16x32_bf16 v[40:43], v[112:115], v[96:99], v[40:43]
  v_mfma_f32_16x16x32_bf16 v[60:63], v[112:115], v[100:103], v[60:63]
  s_waitcnt lgkmcnt(2)
  v_mfma_f32_16x16x32_bf16 v[44:47], v[116:119], v[96:99], v[44:47]
  v_mfma_f32_16x16x32_bf16 v[64:67], v[116:119], v[100:103], v[64:67]
  s_waitcnt lgkmcnt(0)
  v_mfma_f32_16x16x32_bf16 v[48:51], v[120:123], v[96:99], v[48:51]
  v_mfma_f32_16x16x32_bf16 v[68:71], v[120:123], v[100:103], v[68:71]
  s_setprio 3
  s_lshl_b32 s26, s21, 7
  s_add_u32 s39, s26, 4136960
  s_barrier
  s_add_u32 m0, s34, 61440
  s_add_u32 s33, s40, 307200
  buffer_load_dwordx4 v7, s[12:15], s33 offen sc1 lds
  s_add_u32 m0, s34, 69632
  s_add_u32 s33, s40, 315392
  buffer_load_dwordx4 v7, s[12:15], s33 offen sc1 lds
  s_add_u32 m0, s34, 77824
  s_add_u32 s33, s40, 323584
  buffer_load_dwordx4 v7, s[12:15], s33 offen sc1 lds
  s_waitcnt vmcnt(0)
  s_cmp_lg_u32 s20, 7
  s_cbranch_scc1 fw_done_72
  v_lshlrev_b32 v72, 4, v1
  s_mov_b32 s29, 0
fw_loop_73:
  v_mul_u32_u24 v73, 16, v1
  v_cmp_gt_u32 vcc, 8, v1
  v_mov_b32 v74, s57
  s_and_saveexec_b64 s[58:59], vcc
  buffer_load_dword v74, v73, s[12:15], s39 offen sc1
  s_mov_b64 exec, -1
  s_waitcnt vmcnt(0)
  s_add_u32 s29, s29, 1
  s_cmp_ge_u32 s29, 200000
  s_cbranch_scc1 fw_done_72
  v_cmp_ne_u32 vcc, s57, v74
  s_cbranch_vccnz fw_loop_73
fw_done_72:
  s_barrier
  s_add_u32 s33, s37, 0
  buffer_load_dwordx4 v[72:75], v7, s[12:15], s33 offen sc1
  s_add_u32 s33, s37, 20480
  buffer_load_dwordx4 v[76:79], v7, s[12:15], s33 offen sc1
  s_add_u32 s33, s37, 4096
  buffer_load_dwordx4 v[80:83], v7, s[12:15], s33 offen sc1
  s_add_u32 s33, s37, 24576
  buffer_load_dwordx4 v[84:87], v7, s[12:15], s33 offen sc1
  s_add_u32 s33, s37, 8192
  buffer_load_dwordx4 v[88:91], v7, s[12:15], s33 offen sc1
  s_add_u32 s33, s37, 28672
  buffer_load_dwordx4 v[92:95], v7, s[12:15], s33 offen sc1
  s_add_u32 s33, s37, 12288
  buffer_load_dwordx4 v[96:99], v7, s[12:15], s33 offen sc1
  s_add_u32 s33, s37, 32768
  buffer_load_dwordx4 v[100:103], v7, s[12:15], s33 offen sc1
  s_add_u32 s33, s37, 16384
  buffer_load_dwordx4 v[16:19], v7, s[12:15], s33 offen sc1
  s_add_u32 s33, s37, 36864
  buffer_load_dwordx4 v[20:23], v7, s[12:15], s33 offen sc1
  v_sub_f32 v10, 1.0, v10
  v_sub_f32 v11, 1.0, v11
  v_mul_f32 v32, v10, v32
  v_mul_f32 v33, v10, v33
  v_mul_f32 v34, v10, v34
  v_mul_f32 v35, v10, v35
  v_mul_f32 v36, v10, v36
  v_mul_f32 v37, v10, v37
  v_mul_f32 v38, v10, v38
  v_mul_f32 v39, v10, v39
  v_mul_f32 v40, v10, v40
  v_mul_f32 v41, v10, v41
  v_mul_f32 v42, v10, v42
  v_mul_f32 v43, v10, v43
  v_mul_f32 v44, v10, v44
  v_mul_f32 v45, v10, v45
  v_mul_f32 v46, v10, v46
  v_mul_f32 v47, v10, v47
  v_mul_f32 v48, v10, v48
  v_mul_f32 v49, v10, v49
  v_mul_f32 v50, v10, v50
  v_mul_f32 v51, v10, v51
  v_mul_f32 v52, v11, v52
  v_mul_f32 v53, v11, v53
  v_mul_f32 v54, v11, v54
  v_mul_f32 v55, v11, v55
  v_mul_f32 v56, v11, v56
  v_mul_f32 v57, v11, v57
  v_mul_f32 v58, v11, v58
  v_mul_f32 v59, v11, v59
  v_mul_f32 v60, v11, v60
  v_mul_f32 v61, v11, v61
  v_mul_f32 v62, v11, v62
  v_mul_f32 v63, v11, v63
  v_mul_f32 v64, v11, v64
  v_mul_f32 v65, v11, v65
  v_mul_f32 v66, v11, v66
  v_mul_f32 v67, v11, v67
  v_mul_f32 v68, v11, v68
  v_mul_f32 v69, v11, v69
  v_mul_f32 v70, v11, v70
  v_mul_f32 v71, v11, v71
  s_waitcnt vmcnt(8)
  ds_read_b64_tr_b16 v[104:105], v8 offset:0
  ds_read_b64_tr_b16 v[106:107], v8 offset:2560
  ds_read_b64_tr_b16 v[108:109], v8 offset:8
  ds_read_b64_tr_b16 v[110:111], v8 offset:2568
  ds_read_b64_tr_b16 v[112:113], v8 offset:16
  ds_read_b64_tr_b16 v[114:115], v8 offset:2576
  ds_read_b64_tr_b16 v[116:117], v8 offset:24
  ds_read_b64_tr_b16 v[118:119], v8 offset:2584
  ds_read_b64_tr_b16 v[120:121], v8 offset:32
  ds_read_b64_tr_b16 v[122:123], v8 offset:2592
  s_waitcnt lgkmcnt(8)
  v_mfma_f32_16x16x32_bf16 v[32:35], v[104:107], v[72:75], v[32:35]
  v_mfma_f32_16x16x32_bf16 v[52:55], v[104:107], v[76:79], v[52:55]
  s_waitcnt lgkmcnt(6)
  v_mfma_f32_16x16x32_bf16 v[36:39], v[108:111], v[72:75], v[36:39]
  v_mfma_f32_16x16x32_bf16 v[56:59], v[108:111], v[76:79], v[56:59]
  s_waitcnt lgkmcnt(4)
  v_mfma_f32_16x16x32_bf16 v[40:43], v[112:115], v[72:75], v[40:43]
  v_mfma_f32_16x16x32_bf16 v[60:63], v[112:115], v[76:79], v[60:63]
  s_waitcnt lgkmcnt(2)
  v_mfma_f32_16x16x32_bf16 v[44:47], v[116:119], v[72:75], v[44:47]
  v_mfma_f32_16x16x32_bf16 v[64:67], v[116:119], v[76:79], v[64:67]
  s_waitcnt lgkmcnt(0)
  v_mfma_f32_16x16x32_bf16 v[48:51], v[120:123], v[72:75], v[48:51]
  v_mfma_f32_16x16x32_bf16 v[68:71], v[120:123], v[76:79], v[68:71]
  s_waitcnt vmcnt(6)
  s_barrier
  s_add_u32 m0, s34, 0
  s_add_u32 s33, s40, 327680
  buffer_load_dwordx4 v7, s[12:15], s33 offen sc1 lds
  s_add_u32 m0, s34, 8192
  s_add_u32 s33, s40, 335872
  buffer_load_dwordx4 v7, s[12:15], s33 offen sc1 lds
  s_add_u32 m0, s34, 16384
  s_add_u32 s33, s40, 344064
  buffer_load_dwordx4 v7, s[12:15], s33 offen sc1 lds
  ds_read_b64_tr_b16 v[104:105], v8 offset:20480
  ds_read_b64_tr_b16 v[106:107], v8 offset:23040
  ds_read_b64_tr_b16 v[108:109], v8 offset:20488
  ds_read_b64_tr_b16 v[110:111], v8 offset:23048
  ds_read_b64_tr_b16 v[112:113], v8 offset:20496
  ds_read_b64_tr_b16 v[114:115], v8 offset:23056
  ds_read_b64_tr_b16 v[116:117], v8 offset:20504
  ds_read_b64_tr_b16 v[118:119], v8 offset:23064
  ds_read_b64_tr_b16 v[120:121], v8 offset:20512
  ds_read_b64_tr_b16 v[122:123], v8 offset:23072
  s_waitcnt lgkmcnt(8)
  v_mfma_f32_16x16x32_bf16 v[32:35], v[104:107], v[80:83], v[32:35]
  v_mfma_f32_16x16x32_bf16 v[52:55], v[104:107], v[84:87], v[52:55]
  s_waitcnt lgkmcnt(6)
  v_mfma_f32_16x16x32_bf16 v[36:39], v[108:111], v[80:83], v[36:39]
  v_mfma_f32_16x16x32_bf16 v[56:59], v[108:111], v[84:87], v[56:59]
  s_waitcnt lgkmcnt(4)
  v_mfma_f32_16x16x32_bf16 v[40:43], v[112:115], v[80:83], v[40:43]
  v_mfma_f32_16x16x32_bf16 v[60:63], v[112:115], v[84:87], v[60:63]
  s_waitcnt lgkmcnt(2)
  v_mfma_f32_16x16x32_bf16 v[44:47], v[116:119], v[80:83], v[44:47]
  v_mfma_f32_16x16x32_bf16 v[64:67], v[116:119], v[84:87], v[64:67]
  s_waitcnt lgkmcnt(0)
  v_mfma_f32_16x16x32_bf16 v[48:51], v[120:123], v[80:83], v[48:51]
  v_mfma_f32_16x16x32_bf16 v[68:71], v[120:123], v[84:87], v[68:71]
  s_waitcnt vmcnt(7)
  ds_read_b64_tr_b16 v[104:105], v9 offset:0
  ds_read_b64_tr_b16 v[106:107], v9 offset:2560
  ds_read_b64_tr_b16 v[108:109], v9 offset:8
  ds_read_b64_tr_b16 v[110:111], v9 offset:2568
  ds_read_b64_tr_b16 v[112:113], v9 offset:16
  ds_read_b64_tr_b16 v[114:115], v9 offset:2576
  ds_read_b64_tr_b16 v[116:117], v9 offset:24
  ds_read_b64_tr_b16 v[118:119], v9 offset:2584
  ds_read_b64_tr_b16 v[120:121], v9 offset:32
  ds_read_b64_tr_b16 v[122:123], v9 offset:2592
  s_waitcnt lgkmcnt(8)
  v_mfma_f32_16x16x32_bf16 v[32:35], v[104:107], v[88:91], v[32:35]
  v_mfma_f32_16x16x32_bf16 v[52:55], v[104:107], v[92:95], v[52:55]
  s_waitcnt lgkmcnt(6)
  v_mfma_f32_16x16x32_bf16 v[36:39], v[108:111], v[88:91], v[36:39]
  v_mfma_f32_16x16x32_bf16 v[56:59], v[108:111], v[92:95], v[56:59]
  s_waitcnt lgkmcnt(4)
  v_mfma_f32_16x16x32_bf16 v[40:43], v[112:115], v[88:91], v[40:43]
  v_mfma_f32_16x16x32_bf16 v[60:63], v[112:115], v[92:95], v[60:63]
  s_waitcnt lgkmcnt(2)
  v_mfma_f32_16x16x32_bf16 v[44:47], v[116:119], v[88:91], v[44:47]
  v_mfma_f32_16x16x32_bf16 v[64:67], v[116:119], v[92:95], v[64:67]
  s_waitcnt lgkmcnt(0)
  v_mfma_f32_16x16x32_bf16 v[48:51], v[120:123], v[88:91], v[48:51]
  v_mfma_f32_16x16x32_bf16 v[68:71], v[120:123], v[92:95], v[68:71]
  s_waitcnt vmcnt(5)
  ds_read_b64_tr_b16 v[104:105], v9 offset:20480
  ds_read_b64_tr_b16 v[106:107], v9 offset:23040
  ds_read_b64_tr_b16 v[108:109], v9 offset:20488
  ds_read_b64_tr_b16 v[110:111], v9 offset:23048
  ds_read_b64_tr_b16 v[112:113], v9 offset:20496
  ds_read_b64_tr_b16 v[114:115], v9 offset:23056
  ds_read_b64_tr_b16 v[116:117], v9 offset:20504
  ds_read_b64_tr_b16 v[118:119], v9 offset:23064
  ds_read_b64_tr_b16 v[120:121], v9 offset:20512
  ds_read_b64_tr_b16 v[122:123], v9 offset:23072
  s_waitcnt lgkmcnt(8)
  v_mfma_f32_16x16x32_bf16 v[32:35], v[104:107], v[96:99], v[32:35]
  v_mfma_f32_16x16x32_bf16 v[52:55], v[104:107], v[100:103], v[52:55]
  s_waitcnt lgkmcnt(6)
  v_mfma_f32_16x16x32_bf16 v[36:39], v[108:111], v[96:99], v[36:39]
  v_mfma_f32_16x16x32_bf16 v[56:59], v[108:111], v[100:103], v[56:59]
  s_waitcnt lgkmcnt(4)
  v_mfma_f32_16x16x32_bf16 v[40:43], v[112:115], v[96:99], v[40:43]
  v_mfma_f32_16x16x32_bf16 v[60:63], v[112:115], v[100:103], v[60:63]
  s_waitcnt lgkmcnt(2)
  v_mfma_f32_16x16x32_bf16 v[44:47], v[116:119], v[96:99], v[44:47]
  v_mfma_f32_16x16x32_bf16 v[64:67], v[116:119], v[100:103], v[64:67]
  s_waitcnt lgkmcnt(0)
  v_mfma_f32_16x16x32_bf16 v[48:51], v[120:123], v[96:99], v[48:51]
  v_mfma_f32_16x16x32_bf16 v[68:71], v[120:123], v[100:103], v[68:71]
  s_waitcnt vmcnt(0)
  s_barrier
  ds_read_b64_tr_b16 v[104:105], v8 offset:0
  ds_read_b64_tr_b16 v[106:107], v8 offset:2560
  ds_read_b64_tr_b16 v[108:109], v8 offset:8
  ds_read_b64_tr_b16 v[110:111], v8 offset:2568
  ds_read_b64_tr_b16 v[112:113], v8 offset:16
  ds_read_b64_tr_b16 v[114:115], v8 offset:2576
  ds_read_b64_tr_b16 v[116:117], v8 offset:24
  ds_read_b64_tr_b16 v[118:119], v8 offset:2584
  ds_read_b64_tr_b16 v[120:121], v8 offset:32
  ds_read_b64_tr_b16 v[122:123], v8 offset:2592
  s_waitcnt lgkmcnt(8)
  v_mfma_f32_16x16x32_bf16 v[32:35], v[104:107], v[16:19], v[32:35]
  v_mfma_f32_16x16x32_bf16 v[52:55], v[104:107], v[20:23], v[52:55]
  s_waitcnt lgkmcnt(6)
  v_mfma_f32_16x16x32_bf16 v[36:39], v[108:111], v[16:19], v[36:39]
  v_mfma_f32_16x16x32_bf16 v[56:59], v[108:111], v[20:23], v[56:59]
  s_waitcnt lgkmcnt(4)
  v_mfma_f32_16x16x32_bf16 v[40:43], v[112:115], v[16:19], v[40:43]
  v_mfma_f32_16x16x32_bf16 v[60:63], v[112:115], v[20:23], v[60:63]
  s_waitcnt lgkmcnt(2)
  v_mfma_f32_16x16x32_bf16 v[44:47], v[116:119], v[16:19], v[44:47]
  v_mfma_f32_16x16x32_bf16 v[64:67], v[116:119], v[20:23], v[64:67]
  s_waitcnt lgkmcnt(0)
  v_mfma_f32_16x16x32_bf16 v[48:51], v[120:123], v[16:19], v[48:51]
  v_mfma_f32_16x16x32_bf16 v[68:71], v[120:123], v[20:23], v[68:71]
fgend_65:
  s_nop 7
  s_nop 1
  s_cmp_eq_u32 s25, 1
  s_cbranch_scc1 red1_75
  s_cmp_eq_u32 s25, 2
  s_cbranch_scc1 red2_76
  s_cmp_eq_u32 s25, 3
  s_cbranch_scc1 red3_77
red0_74:
  ds_write_b128 v15, v[44:47] offset:13312
  ds_write_b128 v15, v[48:51] offset:14336
  ds_write_b128 v15, v[52:55] offset:18432
  ds_write_b128 v15, v[56:59] offset:19456
  ds_write_b128 v15, v[60:63] offset:20480
  ds_write_b128 v15, v[64:67] offset:24576
  ds_write_b128 v15, v[68:71] offset:25600
  s_waitcnt lgkmcnt(0)
  s_barrier
  ds_read_b128 v[72:75], v15 offset:0
  ds_read_b128 v[76:79], v15 offset:1024
  ds_read_b128 v[80:83], v15 offset:2048
  ds_read_b128 v[84:87], v15 offset:3072
  ds_read_b128 v[88:91], v15 offset:4096
  ds_read_b128 v[92:95], v15 offset:5120
  ds_read_b128 v[96:99], v15 offset:6144
  ds_read_b128 v[100:103], v15 offset:7168
  ds_read_b128 v[104:107], v15 offset:8192
  s_waitcnt lgkmcnt(0)
  v_add_f32 v32, v32, v72
  v_add_f32 v33, v33, v73
  v_add_f32 v34, v34, v74
  v_add_f32 v35, v35, v75
  v_add_f32 v36, v36, v76
  v_add_f32 v37, v37, v77
  v_add_f32 v38, v38, v78
  v_add_f32 v39, v39, v79
  v_add_f32 v40, v40, v80
  v_add_f32 v41, v41, v81
  v_add_f32 v42, v42, v82
  v_add_f32 v43, v43, v83
  v_add_f32 v32, v32, v84
  v_add_f32 v33, v33, v85
  v_add_f32 v34, v34, v86
  v_add_f32 v35, v35, v87
  v_add_f32 v36, v36, v88
  v_add_f32 v37, v37, v89
  v_add_f32 v38, v38, v90
  v_add_f32 v39, v39, v91
  v_add_f32 v40, v40, v92
  v_add_f32 v41, v41, v93
  v_add_f32 v42, v42, v94
  v_add_f32 v43, v43, v95
  v_add_f32 v32, v32, v96
  v_add_f32 v33, v33, v97
  v_add_f32 v34, v34, v98
  v_add_f32 v35, v35, v99
  v_add_f32 v36, v36, v100
  v_add_f32 v37, v37, v101
  v_add_f32 v38, v38, v102
  v_add_f32 v39, v39, v103
  v_add_f32 v40, v40, v104
  v_add_f32 v41, v41, v105
  v_add_f32 v42, v42, v106
  v_add_f32 v43, v43, v107
  v_cvt_pk_bf16_f32 v72, v32, v33
  v_cvt_pk_bf16_f32 v73, v34, v35
  v_cvt_pk_bf16_f32 v74, v36, v37
  v_cvt_pk_bf16_f32 v75, v38, v39
  v_cvt_pk_bf16_f32 v76, v40, v41
  v_cvt_pk_bf16_f32 v77, v42, v43
  s_movk_i32 s26, 0
  buffer_store_dwordx4 v[72:75], v14, s[44:47], s26 offen
  buffer_store_dwordx2 v[76:77], v14, s[44:47], s26 offen offset:16
  s_branch redend_78
red1_75:
  ds_write_b128 v15, v[32:35] offset:0
  ds_write_b128 v15, v[36:39] offset:1024
  ds_write_b128 v15, v[40:43] offset:2048
  ds_write_b128 v15, v[52:55] offset:21504
  ds_write_b128 v15, v[56:59] offset:22528
  ds_write_b128 v15, v[60:63] offset:23552
  ds_write_b128 v15, v[64:67] offset:26624
  ds_write_b128 v15, v[68:71] offset:27648
  s_waitcnt lgkmcnt(0)
  s_barrier
  ds_read_b128 v[72:75], v15 offset:9216
  ds_read_b128 v[76:79], v15 offset:10240
  ds_read_b128 v[80:83], v15 offset:11264
  ds_read_b128 v[84:87], v15 offset:12288
  ds_read_b128 v[88:91], v15 offset:13312
  ds_read_b128 v[92:95], v15 offset:14336
  s_waitcnt lgkmcnt(0)
  v_add_f32 v44, v44, v72
  v_add_f32 v45, v45, v73
  v_add_f32 v46, v46, v74
  v_add_f32 v47, v47, v75
  v_add_f32 v48, v48, v76
  v_add_f32 v49, v49, v77
  v_add_f32 v50, v50, v78
  v_add_f32 v51, v51, v79
  v_add_f32 v44, v44, v80
  v_add_f32 v45, v45, v81
  v_add_f32 v46, v46, v82
  v_add_f32 v47, v47, v83
  v_add_f32 v48, v48, v84
  v_add_f32 v49, v49, v85
  v_add_f32 v50, v50, v86
  v_add_f32 v51, v51, v87
  v_add_f32 v44, v44, v88
  v_add_f32 v45, v45, v89
  v_add_f32 v46, v46, v90
  v_add_f32 v47, v47, v91
  v_add_f32 v48, v48, v92
  v_add_f32 v49, v49, v93
  v_add_f32 v50, v50, v94
  v_add_f32 v51, v51, v95
  v_cvt_pk_bf16_f32 v72, v44, v45
  v_cvt_pk_bf16_f32 v73, v46, v47
  v_cvt_pk_bf16_f32 v74, v48, v49
  v_cvt_pk_bf16_f32 v75, v50, v51
  s_movk_i32 s26, 24
  buffer_store_dwordx4 v[72:75], v14, s[44:47], s26 offen
  s_branch redend_78
red2_76:
  ds_write_b128 v15, v[32:35] offset:3072
  ds_write_b128 v15, v[36:39] offset:4096
  ds_write_b128 v15, v[40:43] offset:5120
  ds_write_b128 v15, v[44:47] offset:9216
  ds_write_b128 v15, v[48:51] offset:10240
  ds_write_b128 v15, v[64:67] offset:28672
  ds_write_b128 v15, v[68:71] offset:29696
  s_waitcnt lgkmcnt(0)
  s_barrier
  ds_read_b128 v[72:75], v15 offset:15360
  ds_read_b128 v[76:79], v15 offset:16384
  ds_read_b128 v[80:83], v15 offset:17408
  ds_read_b128 v[84:87], v15 offset:18432
  ds_read_b128 v[88:91], v15 offset:19456
  ds_read_b128 v[92:95], v15 offset:20480
  ds_read_b128 v[96:99], v15 offset:21504
  ds_read_b128 v[100:103], v15 offset:22528
  ds_read_b128 v[104:107], v15 offset:23552
  s_waitcnt lgkmcnt(0)
  v_add_f32 v52, v52, v72
  v_add_f32 v53, v53, v73
  v_add_f32 v54, v54, v74
  v_add_f32 v55, v55, v75
  v_add_f32 v56, v56, v76
  v_add_f32 v57, v57, v77
  v_add_f32 v58, v58, v78
  v_add_f32 v59, v59, v79
  v_add_f32 v60, v60, v80
  v_add_f32 v61, v61, v81
  v_add_f32 v62, v62, v82
  v_add_f32 v63, v63, v83
  v_add_f32 v52, v52, v84
  v_add_f32 v53, v53, v85
  v_add_f32 v54, v54, v86
  v_add_f32 v55, v55, v87
  v_add_f32 v56, v56, v88
  v_add_f32 v57, v57, v89
  v_add_f32 v58, v58, v90
  v_add_f32 v59, v59, v91
  v_add_f32 v60, v60, v92
  v_add_f32 v61, v61, v93
  v_add_f32 v62, v62, v94
  v_add_f32 v63, v63, v95
  v_add_f32 v52, v52, v96
  v_add_f32 v53, v53, v97
  v_add_f32 v54, v54, v98
  v_add_f32 v55, v55, v99
  v_add_f32 v56, v56, v100
  v_add_f32 v57, v57, v101
  v_add_f32 v58, v58, v102
  v_add_f32 v59, v59, v103
  v_add_f32 v60, v60, v104
  v_add_f32 v61, v61, v105
  v_add_f32 v62, v62, v106
  v_add_f32 v63, v63, v107
  v_cvt_pk_bf16_f32 v72, v52, v53
  v_cvt_pk_bf16_f32 v73, v54, v55
  v_cvt_pk_bf16_f32 v74, v56, v57
  v_cvt_pk_bf16_f32 v75, v58, v59
  v_cvt_pk_bf16_f32 v76, v60, v61
  v_cvt_pk_bf16_f32 v77, v62, v63
  s_movk_i32 s26, 20480
  buffer_store_dwordx4 v[72:75], v14, s[44:47], s26 offen
  buffer_store_dwordx2 v[76:77], v14, s[44:47], s26 offen offset:16
  s_branch redend_78
red3_77:
  ds_write_b128 v15, v[32:35] offset:6144
  ds_write_b128 v15, v[36:39] offset:7168
  ds_write_b128 v15, v[40:43] offset:8192
  ds_write_b128 v15, v[44:47] offset:11264
  ds_write_b128 v15, v[48:51] offset:12288
  ds_write_b128 v15, v[52:55] offset:15360
  ds_write_b128 v15, v[56:59] offset:16384
  ds_write_b128 v15, v[60:63] offset:17408
  s_waitcnt lgkmcnt(0)
  s_barrier
  ds_read_b128 v[72:75], v15 offset:24576
  ds_read_b128 v[76:79], v15 offset:25600
  ds_read_b128 v[80:83], v15 offset:26624
  ds_read_b128 v[84:87], v15 offset:27648
  ds_read_b128 v[88:91], v15 offset:28672
  ds_read_b128 v[92:95], v15 offset:29696
  s_waitcnt lgkmcnt(0)
  v_add_f32 v64, v64, v72
  v_add_f32 v65, v65, v73
  v_add_f32 v66, v66, v74
  v_add_f32 v67, v67, v75
  v_add_f32 v68, v68, v76
  v_add_f32 v69, v69, v77
  v_add_f32 v70, v70, v78
  v_add_f32 v71, v71, v79
  v_add_f32 v64, v64, v80
  v_add_f32 v65, v65, v81
  v_add_f32 v66, v66, v82
  v_add_f32 v67, v67, v83
  v_add_f32 v68, v68, v84
  v_add_f32 v69, v69, v85
  v_add_f32 v70, v70, v86
  v_add_f32 v71, v71, v87
  v_add_f32 v64, v64, v88
  v_add_f32 v65, v65, v89
  v_add_f32 v66, v66, v90
  v_add_f32 v67, v67, v91
  v_add_f32 v68, v68, v92
  v_add_f32 v69, v69, v93
  v_add_f32 v70, v70, v94
  v_add_f32 v71, v71, v95
  v_cvt_pk_bf16_f32 v72, v64, v65
  v_cvt_pk_bf16_f32 v73, v66, v67
  v_cvt_pk_bf16_f32 v74, v68, v69
  v_cvt_pk_bf16_f32 v75, v70, v71
  s_movk_i32 s26, 20504
  buffer_store_dwordx4 v[72:75], v14, s[44:47], s26 offen
redend_78:
  s_waitcnt vmcnt(0)
done:

  s_endpgm
.section .rodata,"a"
.p2align 6
.amdhsa_kernel gated_mix__grouped_kv_mqa__glu_gated_swiglu__prompt_kernel
  .amdhsa_next_free_vgpr 128
  .amdhsa_next_free_sgpr 102
  .amdhsa_accum_offset 128
  .amdhsa_group_segment_fixed_size 0
  .amdhsa_kernarg_size 104
  .amdhsa_user_sgpr_count 2
  .amdhsa_user_sgpr_kernarg_segment_ptr 1
  .amdhsa_system_sgpr_workgroup_id_x 1
.end_amdhsa_kernel
```
